```python
import torch

def _softmax(x, axis=-1):
    return torch.softmax(x, dim=axis)

def _gelu(x):
    return torch.nn.functional.gelu(x, approximate='tanh')

def _silu(x):
    return torch.nn.functional.silu(x)

def _sigmoid(x):
    return torch.sigmoid(x)

def _layernorm(x, axis=-1, eps=1e-05):
    m = x.mean(dim=axis, keepdim=True)
    v = x.var(dim=axis, keepdim=True, unbiased=False)
    return (x - m) / torch.sqrt(v + eps)

def _scatter_add(tgt, idx, src, axis=0):
    return tgt.clone().index_add_(axis, idx, src)

def _segment_sum(src, seg, n):
    out = torch.zeros((n,) + src.shape[1:], dtype=src.dtype)
    return out.index_add_(0, seg, src)

def _pad(x, pw):
    flat = tuple((v for pair in reversed(pw) for v in pair))
    return torch.nn.functional.pad(x, flat)
kernel_name = 'adaLN_cond__spectral_gfnet__glu_gated_bilinear__prompt'

def setup_inputs():

    _w = lambda a: (lambda t: t.to(torch.bfloat16) if t.is_floating_point() else t)(torch.as_tensor(a))

    def _A_setup():
        B, S, D = (1, 2048, 640)
        Df = D // 2 + 1
        return {'x': _w((lambda *s: torch.randn(*s, dtype=torch.bfloat16) * 0.05)(B, S, D)), 'w_r': _w((lambda *s: torch.randn(*s, dtype=torch.bfloat16) * 1.6)(S, Df) * 0.02), 'w_i': _w((lambda *s: torch.randn(*s, dtype=torch.bfloat16) * 1.6)(S, Df) * 0.02)}
    _A_in = _A_setup()

    def _B_setup():
        B, S, D, F = (1, 2048, 640, 1728)
        return {'x': _w((lambda *s: torch.randn(*s, dtype=torch.bfloat16) * 0.05)(B, S, D)), 'w_gate': _w((lambda *s: torch.randn(*s, dtype=torch.bfloat16) * 0.4)(D, F) * D ** (-0.5)), 'w_up': _w((lambda *s: torch.randn(*s, dtype=torch.bfloat16) * 0.4)(D, F) * D ** (-0.5)), 'w_down': _w((lambda *s: torch.randn(*s, dtype=torch.bfloat16) * 0.4)(F, D) * F ** (-0.5))}
    _B_in = _B_setup()
    return {'A_x': _A_in['x'], 'A_w_r': _A_in['w_r'], 'A_w_i': _A_in['w_i'], 'B_x': _B_in['x'], 'B_w_gate': _B_in['w_gate'], 'B_w_up': _B_in['w_up'], 'B_w_down': _B_in['w_down'], 'c': _w((lambda *s: torch.randn(*s, dtype=torch.bfloat16) * 0.1)(1, 640) * 8.0), 'w_mod': _w((lambda *s: torch.randn(*s, dtype=torch.bfloat16) * 0.1)(640, 6 * 640) * 640 ** (-0.5) * 8.0)}

def reference(A_x, A_w_r, A_w_i, B_x, B_w_gate, B_w_up, B_w_down, c, w_mod):

    def _A_ref(x, w_r, w_i):
        B, S, D = x.shape
        X = (lambda x, axes=(-2, -1): torch.fft.rfft2(x.float(), dim=axes))(x, axes=(-2, -1))
        W = w_r + 1j * w_i
        X = X * W
        y = (lambda x, s, axes=(-2, -1): torch.fft.irfft2(x, s=s, dim=axes).to(torch.bfloat16))(X, (S, D), axes=(-2, -1))
        return y

    def _B_ref(x, w_gate, w_up, w_down):
        g = torch.einsum('bsd,df->bsf', x, w_gate)
        u = torch.einsum('bsd,df->bsf', x, w_up)
        h = g * u
        return torch.einsum('bsf,fd->bsd', h, w_down)
    x = A_x
    mod = (_silu(c) @ w_mod).reshape(c.shape[0], 6, 1, -1)
    sa, ca, ga, sb, cb, gb = (mod[:, 0].clone(), mod[:, 1].clone(), mod[:, 2].clone(), mod[:, 3].clone(), mod[:, 4].clone(), mod[:, 5].clone())
    h = _layernorm(x, axis=-1) * (1 + ca) + sa
    x = x + ga * _A_ref(h, A_w_r, A_w_i)
    h = _layernorm(x, axis=-1) * (1 + cb) + sb
    x = x + gb * _B_ref(h, B_w_gate, B_w_up, B_w_down)
    return x
```

```asm
; @launch grid=(256,1,1) block=(512,1,1) lds=163840
.amdgcn_target "amdgcn-amd-amdhsa--gfx950"
.text
.p2align 8
pf_code_begin:
.globl adaLN_cond__spectral_gfnet__glu_gated_bilinear__prompt_kernel
.p2align 8
.type adaLN_cond__spectral_gfnet__glu_gated_bilinear__prompt_kernel,@function
adaLN_cond__spectral_gfnet__glu_gated_bilinear__prompt_kernel:
    s_cmp_ge_u32 s2, 256
    s_cbranch_scc1 .adaLN_cond__spectral_gfnet__glu_gated_bilinear__prompt_kernel_done1
    s_load_dwordx4 s[28:31], s[0:1], 56
    s_load_dwordx4 s[44:47], s[0:1], 72
    s_load_dwordx2 s[6:7], s[0:1], 88
    s_load_dwordx2 s[4:5], s[0:1], 0
    s_load_dwordx4 s[16:19], s[0:1], 8
    s_load_dwordx4 s[52:55], s[0:1], 32
    s_load_dwordx2 s[50:51], s[0:1], 48
    s_memrealtime s[48:49]
    v_lshrrev_b32 v62, 6, v0
    v_lshlrev_b32 v3, 4, v0
    v_readfirstlane_b32 s3, v62
    v_and_b32 v130, 255, v0
    s_mov_b32 s42, 0
    s_mov_b32 s33, 3
    s_mov_b32 s32, s2
    s_cmp_ge_u32 s2, 80
    s_cbranch_scc1 .adaLN_cond__spectral_gfnet__glu_gated_bilinear__prompt_kernel_ty6
    s_and_b32 s10, s2, 3
    s_lshr_b32 s11, s2, 2
    v_lshrrev_b32 v179, 3, v0
    v_and_b32 v176, 7, v0
    v_mul_u32_u24 v177, 7680, v179
    v_lshl_add_u32 v176, v176, 4, v177
    s_mul_i32 s12, s10, 1228800
    s_lshl_b32 s13, s11, 7
    s_add_u32 s12, s12, s13
    v_add_u32 v176, s12, v176
    v_add_u32 v177, 491520, v176
    v_add_u32 v178, 983040, v176
    s_mul_i32 s12, s10, 320
    v_lshl_add_u32 v179, v179, 1, s12
    v_mov_b32 v156, 0
    v_mov_b32 v140, 0
    v_mov_b32 v141, 0
    v_mov_b32 v142, 0
    v_mov_b32 v143, 0
    s_waitcnt lgkmcnt(0)
    global_load_dwordx4 v[132:135], v176, s[30:31]
    global_load_dwordx4 v[136:139], v177, s[30:31]
    global_load_ushort v152, v179, s[28:29]
    global_load_ushort v154, v179, s[28:29] offset:128
    s_cmp_ge_u32 s3, 4
    s_cbranch_scc1 .adaLN_cond__spectral_gfnet__glu_gated_bilinear__prompt_kernel_px7
    global_load_dwordx4 v[140:143], v178, s[30:31]
    global_load_ushort v156, v179, s[28:29] offset:256
.adaLN_cond__spectral_gfnet__glu_gated_bilinear__prompt_kernel_px7:
    s_and_b32 s36, s2, 3
    s_lshl_b32 s36, s36, 2
    s_lshr_b32 s37, s2, 6
    s_add_u32 s36, s36, s37
    s_bfe_u32 s37, s2, 0x10002
    s_lshl_b32 s37, s37, 3
    s_bfe_u32 s38, s2, 0x30003
    s_add_u32 s37, s37, s38
    s_lshl_b32 s20, s36, 1
    s_lshr_b32 s21, s37, 3
    s_add_u32 s20, s20, s21
    s_and_b32 s21, s37, 7
    s_mov_b32 s14, 0xffff0000
    s_lshl_b32 s23, s3, 10
    s_lshl_b32 s22, s21, 3
    s_add_u32 s22, s22, s3
    s_lshl_b32 s24, s22, 5
    s_add_u32 s24, s24, s20
    s_mul_i32 s24, s24, 1280
    s_add_u32 s4, s4, s24
    s_addc_u32 s5, s5, 0
    v_and_b32 v63, 63, v0
    v_lshlrev_b32 v1, 4, v63
    v_lshlrev_b32 v2, 2, v63
    s_lshr_b32 s15, s2, 4
    s_lshl_b32 s15, s15, 3
    s_and_b32 s24, s2, 7
    s_add_u32 s15, s15, s24
    s_and_b32 s26, s3, 3
    s_lshr_b32 s27, s3, 2
    s_lshl_b32 s27, s27, 15
    s_add_u32 s27, s27, 40960
    global_load_dwordx4 v[8:11], v1, s[4:5]
    global_load_dword v12, v2, s[4:5] offset:1024
    s_getpc_b64 s[8:9]
    s_add_u32 s8, s8, tab1@rel32@lo+4
    s_addc_u32 s9, s9, tab1@rel32@hi+12
    s_mov_b32 m0, s23
    v_min_u32 v114, 2032, v3
    v_add_u32 v114, 8192, v114
    global_load_lds_dwordx4 v3, s[8:9]
    s_add_u32 m0, s23, 8192
    s_nop 0
    global_load_lds_dwordx4 v114, s[8:9]
    s_waitcnt vmcnt(4)
    s_load_dword s49, s[46:47], 0
    s_cmp_lt_u32 s3, 4
    s_cbranch_scc1 .adaLN_cond__spectral_gfnet__glu_gated_bilinear__prompt_kernel_pw8
    s_mov_b32 s33, 1
    s_mul_i32 s25, s15, 10272
    s_add_u32 s16, s16, s25
    s_addc_u32 s17, s17, 0
    s_add_u32 s18, s18, s25
    s_addc_u32 s19, s19, 0
    s_lshl_b32 s12, s26, 10
    v_lshlrev_b32 v181, 4, v130
    v_add_u32 v182, 4096, v181
    v_add_u32 v183, 8192, v181
    v_min_u32 v183, 10256, v183
    s_add_u32 m0, s12, 122880
    s_nop 0
    global_load_lds_dwordx4 v181, s[16:17]
    s_add_u32 m0, s12, 135168
    s_nop 0
    global_load_lds_dwordx4 v181, s[18:19]
    s_add_u32 m0, s12, 126976
    s_nop 0
    global_load_lds_dwordx4 v182, s[16:17]
    s_add_u32 m0, s12, 139264
    s_nop 0
    global_load_lds_dwordx4 v182, s[18:19]
    s_add_u32 m0, s12, 131072
    s_nop 0
    global_load_lds_dwordx4 v183, s[16:17]
    s_add_u32 m0, s12, 143360
    s_nop 0
    global_load_lds_dwordx4 v183, s[18:19]
.adaLN_cond__spectral_gfnet__glu_gated_bilinear__prompt_kernel_pw8:
    v_lshlrev_b32 v152, 16, v152
    v_mul_f32 v153, 0xbfb8aa3b, v152
    v_lshlrev_b32 v154, 16, v154
    v_mul_f32 v155, 0xbfb8aa3b, v154
    v_lshlrev_b32 v156, 16, v156
    v_mul_f32 v157, 0xbfb8aa3b, v156
    v_exp_f32 v153, v153
    v_exp_f32 v155, v155
    v_exp_f32 v157, v157
    v_add_f32 v153, 1.0, v153
    v_add_f32 v155, 1.0, v155
    v_add_f32 v157, 1.0, v157
    v_rcp_f32 v153, v153
    v_rcp_f32 v155, v155
    v_rcp_f32 v157, v157
    v_mul_f32 v152, v152, v153
    v_mul_f32 v154, v154, v155
    v_mul_f32 v156, v156, v157
    v_cvt_pk_bf16_f32 v152, v152, v152
    v_cvt_pk_bf16_f32 v154, v154, v154
    v_cvt_pk_bf16_f32 v156, v156, v156
    v_lshlrev_b32 v152, 16, v152
    v_lshlrev_b32 v154, 16, v154
    v_lshlrev_b32 v156, 16, v156
    v_lshlrev_b32 v172, 16, v132
    v_and_b32 v173, s14, v132
    v_pk_mul_f32 v[164:165], v[172:173], v[152:153] op_sel_hi:[1,0]
    v_lshlrev_b32 v174, 16, v133
    v_and_b32 v175, s14, v133
    v_pk_mul_f32 v[166:167], v[174:175], v[152:153] op_sel_hi:[1,0]
    v_lshlrev_b32 v172, 16, v134
    v_and_b32 v173, s14, v134
    v_pk_mul_f32 v[168:169], v[172:173], v[152:153] op_sel_hi:[1,0]
    v_lshlrev_b32 v174, 16, v135
    v_and_b32 v175, s14, v135
    v_pk_mul_f32 v[170:171], v[174:175], v[152:153] op_sel_hi:[1,0]
    v_lshlrev_b32 v172, 16, v136
    v_and_b32 v173, s14, v136
    v_pk_fma_f32 v[164:165], v[172:173], v[154:155], v[164:165] op_sel_hi:[1,0,1]
    v_lshlrev_b32 v174, 16, v137
    v_and_b32 v175, s14, v137
    v_pk_fma_f32 v[166:167], v[174:175], v[154:155], v[166:167] op_sel_hi:[1,0,1]
    v_lshlrev_b32 v172, 16, v138
    v_and_b32 v173, s14, v138
    v_pk_fma_f32 v[168:169], v[172:173], v[154:155], v[168:169] op_sel_hi:[1,0,1]
    v_lshlrev_b32 v174, 16, v139
    v_and_b32 v175, s14, v139
    v_pk_fma_f32 v[170:171], v[174:175], v[154:155], v[170:171] op_sel_hi:[1,0,1]
    v_lshlrev_b32 v172, 16, v140
    v_and_b32 v173, s14, v140
    v_pk_fma_f32 v[164:165], v[172:173], v[156:157], v[164:165] op_sel_hi:[1,0,1]
    v_lshlrev_b32 v174, 16, v141
    v_and_b32 v175, s14, v141
    v_pk_fma_f32 v[166:167], v[174:175], v[156:157], v[166:167] op_sel_hi:[1,0,1]
    v_lshlrev_b32 v172, 16, v142
    v_and_b32 v173, s14, v142
    v_pk_fma_f32 v[168:169], v[172:173], v[156:157], v[168:169] op_sel_hi:[1,0,1]
    v_lshlrev_b32 v174, 16, v143
    v_and_b32 v175, s14, v143
    v_pk_fma_f32 v[170:171], v[174:175], v[156:157], v[170:171] op_sel_hi:[1,0,1]
    v_add_f32_dpp v164, v164, v164 row_ror:8 row_mask:0xf bank_mask:0xf
    v_add_f32_dpp v165, v165, v165 row_ror:8 row_mask:0xf bank_mask:0xf
    v_add_f32_dpp v166, v166, v166 row_ror:8 row_mask:0xf bank_mask:0xf
    v_add_f32_dpp v167, v167, v167 row_ror:8 row_mask:0xf bank_mask:0xf
    v_add_f32_dpp v168, v168, v168 row_ror:8 row_mask:0xf bank_mask:0xf
    v_add_f32_dpp v169, v169, v169 row_ror:8 row_mask:0xf bank_mask:0xf
    v_add_f32_dpp v170, v170, v170 row_ror:8 row_mask:0xf bank_mask:0xf
    v_add_f32_dpp v171, v171, v171 row_ror:8 row_mask:0xf bank_mask:0xf
    v_lshrrev_b32 v176, 4, v0
    v_lshlrev_b32 v176, 8, v176
    v_and_b32 v177, 7, v0
    v_lshl_add_u32 v176, v177, 5, v176
    v_add_u32 v176, 151552, v176
    s_mov_b32 exec_lo, 0x00ff00ff
    s_mov_b32 exec_hi, 0x00ff00ff
    ds_write_b128 v176, v[164:167]
    ds_write_b128 v176, v[168:171] offset:16
    s_mov_b64 exec, -1
    s_branch .adaLN_cond__spectral_gfnet__glu_gated_bilinear__prompt_kernel_b03
.adaLN_cond__spectral_gfnet__glu_gated_bilinear__prompt_kernel_ty6:
    s_mov_b32 s34, 537921624
    s_mov_b32 s35, 1078472744
    s_lshl_b32 s24, s3, 3
    s_lshr_b64 s[34:35], s[34:35], s24
    s_and_b32 s34, s34, 255
    s_load_dwordx2 s[40:41], s[0:1], s34
    s_mov_b32 s34, 269093568
    s_mov_b32 s35, 622071824
    s_lshr_b64 s[34:35], s[34:35], s24
    s_and_b32 s34, s34, 255
    s_lshl_b32 s34, s34, 17
    s_sub_u32 s34, s34, 4
    v_and_b32 v178, 63, v0
    v_lshlrev_b32 v178, 0, v178
    v_min_u32 v178, s34, v178
    s_sub_u32 s24, s2, 80
    s_and_b32 s25, s24, -8
    s_add_u32 s25, s25, s3
    s_lshl_b32 s25, s25, 8
    v_and_b32 v176, 1, v0
    v_lshl_add_u32 v176, v176, 7, s25
    s_getpc_b64 s[10:11]
    s_add_u32 s10, s10, pf_code_begin@rel32@lo+4
    s_addc_u32 s11, s11, pf_code_begin@rel32@hi+12
    s_getpc_b64 s[12:13]
    s_add_u32 s12, s12, pf_tab_begin@rel32@lo+4
    s_addc_u32 s13, s13, pf_tab_begin@rel32@hi+12
    v_min_u32 v177, pf_code_end-pf_code_begin-4, v176
    v_min_u32 v176, pf_tab_end-pf_tab_begin-4, v176
    global_load_dword v250, v177, s[10:11]
    global_load_dword v251, v176, s[12:13]
    s_mul_i32 s24, s24, 14944
    s_add_u32 s24, s24, 4194304
    v_add_u32 v124, s24, v3
    v_min_u32 v127, 6736, v3
    s_add_u32 s24, s24, 8192
    v_add_u32 v127, s24, v127
    v_mov_b32 v120, -1
    v_mov_b32 v121, -1
    v_mov_b32 v122, -1
    v_mov_b32 v123, -1
    v_cmp_gt_u32 vcc, 422, v0
    s_waitcnt lgkmcnt(0)
    s_cmp_lg_u32 s2, 80
    s_cbranch_scc1 .adaLN_cond__spectral_gfnet__glu_gated_bilinear__prompt_kernel_nn5
    s_cmp_lg_u32 s3, 0
    s_cbranch_scc1 .adaLN_cond__spectral_gfnet__glu_gated_bilinear__prompt_kernel_nn5
    s_or_b32 s48, s48, 1
    v_mov_b32 v176, s48
    v_mov_b32 v177, 0
    s_mov_b64 exec, 1
    global_store_dword v177, v176, s[46:47] sc1
    s_mov_b64 exec, -1
.adaLN_cond__spectral_gfnet__glu_gated_bilinear__prompt_kernel_nn5:
    global_store_dwordx4 v124, v[120:123], s[6:7] sc1
    s_or_b64 exec, vcc, 1
    global_store_dwordx4 v127, v[120:123], s[6:7] sc1
    s_mov_b64 exec, -1
    s_and_b32 s36, s2, 3
    s_lshl_b32 s36, s36, 2
    s_lshr_b32 s37, s2, 6
    s_add_u32 s36, s36, s37
    s_bfe_u32 s37, s2, 0x10002
    s_lshl_b32 s37, s37, 3
    s_bfe_u32 s38, s2, 0x30003
    s_add_u32 s37, s37, s38
    s_lshl_b32 s20, s36, 1
    s_lshr_b32 s21, s37, 3
    s_add_u32 s20, s20, s21
    s_and_b32 s21, s37, 7
    s_mov_b32 s14, 0xffff0000
    s_lshl_b32 s23, s3, 10
    s_lshl_b32 s22, s21, 3
    s_add_u32 s22, s22, s3
    s_lshl_b32 s24, s22, 5
    s_add_u32 s24, s24, s20
    s_mul_i32 s24, s24, 1280
    s_add_u32 s4, s4, s24
    s_addc_u32 s5, s5, 0
    v_and_b32 v63, 63, v0
    v_lshlrev_b32 v1, 4, v63
    v_lshlrev_b32 v2, 2, v63
    s_lshr_b32 s15, s2, 4
    s_lshl_b32 s15, s15, 3
    s_and_b32 s24, s2, 7
    s_add_u32 s15, s15, s24
    s_and_b32 s26, s3, 3
    s_lshr_b32 s27, s3, 2
    s_lshl_b32 s27, s27, 15
    s_add_u32 s27, s27, 40960
    global_load_dwordx4 v[8:11], v1, s[4:5]
    global_load_dword v12, v2, s[4:5] offset:1024
    s_getpc_b64 s[8:9]
    s_add_u32 s8, s8, tab1@rel32@lo+4
    s_addc_u32 s9, s9, tab1@rel32@hi+12
    s_mov_b32 m0, s23
    v_min_u32 v114, 2032, v3
    v_add_u32 v114, 8192, v114
    global_load_lds_dwordx4 v3, s[8:9]
    s_add_u32 m0, s23, 8192
    s_nop 0
    global_load_lds_dwordx4 v114, s[8:9]
    s_cmp_ge_u32 s3, 4
    s_cbranch_scc1 .adaLN_cond__spectral_gfnet__glu_gated_bilinear__prompt_kernel_e110_y
    s_cmp_ge_u32 s2, 240
    s_cbranch_scc1 .adaLN_cond__spectral_gfnet__glu_gated_bilinear__prompt_kernel_e110_n
    s_mov_b32 s33, 2
    s_and_b32 s10, s32, 3
    s_lshr_b32 s11, s32, 2
    v_lshrrev_b32 v179, 3, v130
    v_and_b32 v176, 7, v130
    v_mul_u32_u24 v177, 7680, v179
    v_lshl_add_u32 v176, v176, 4, v177
    s_mul_i32 s12, s10, 1228800
    s_lshl_b32 s13, s11, 7
    s_add_u32 s12, s12, s13
    v_add_u32 v176, s12, v176
    s_mul_i32 s12, s10, 320
    v_lshl_add_u32 v179, v179, 1, s12
    global_load_ushort v152, v179, s[28:29] offset:0
    global_load_ushort v154, v179, s[28:29] offset:64
    global_load_ushort v156, v179, s[28:29] offset:128
    global_load_ushort v158, v179, s[28:29] offset:192
    global_load_ushort v160, v179, s[28:29] offset:256
    global_load_dwordx4 v[132:135], v176, s[30:31]
    v_add_u32 v176, 245760, v176
    global_load_dwordx4 v[136:139], v176, s[30:31]
    v_add_u32 v176, 245760, v176
    global_load_dwordx4 v[140:143], v176, s[30:31]
    v_add_u32 v176, 245760, v176
    global_load_dwordx4 v[144:147], v176, s[30:31]
    v_add_u32 v176, 245760, v176
    global_load_dwordx4 v[148:151], v176, s[30:31]
    s_waitcnt vmcnt(14)
    s_branch .adaLN_cond__spectral_gfnet__glu_gated_bilinear__prompt_kernel_e110
.adaLN_cond__spectral_gfnet__glu_gated_bilinear__prompt_kernel_e110_y:
    s_mov_b32 s33, 1
    s_mul_i32 s25, s15, 10272
    s_add_u32 s16, s16, s25
    s_addc_u32 s17, s17, 0
    s_add_u32 s18, s18, s25
    s_addc_u32 s19, s19, 0
    s_lshl_b32 s12, s26, 10
    v_lshlrev_b32 v181, 4, v130
    v_add_u32 v182, 4096, v181
    v_add_u32 v183, 8192, v181
    v_min_u32 v183, 10256, v183
    s_add_u32 m0, s12, 122880
    s_nop 0
    global_load_lds_dwordx4 v181, s[16:17]
    s_add_u32 m0, s12, 135168
    s_nop 0
    global_load_lds_dwordx4 v181, s[18:19]
    s_add_u32 m0, s12, 126976
    s_nop 0
    global_load_lds_dwordx4 v182, s[16:17]
    s_add_u32 m0, s12, 139264
    s_nop 0
    global_load_lds_dwordx4 v182, s[18:19]
    s_add_u32 m0, s12, 131072
    s_nop 0
    global_load_lds_dwordx4 v183, s[16:17]
    s_add_u32 m0, s12, 143360
    s_nop 0
    global_load_lds_dwordx4 v183, s[18:19]
    s_waitcnt vmcnt(10)
    s_branch .adaLN_cond__spectral_gfnet__glu_gated_bilinear__prompt_kernel_e110
.adaLN_cond__spectral_gfnet__glu_gated_bilinear__prompt_kernel_e110_n:
    s_waitcnt vmcnt(4)
.adaLN_cond__spectral_gfnet__glu_gated_bilinear__prompt_kernel_e110:
    s_load_dword s49, s[46:47], 0
.adaLN_cond__spectral_gfnet__glu_gated_bilinear__prompt_kernel_b03:
    s_waitcnt lgkmcnt(0)
    s_barrier
    s_cmp_eq_u32 s49, 0
    s_cbranch_scc1 .adaLN_cond__spectral_gfnet__glu_gated_bilinear__prompt_kernel_tl11
.adaLN_cond__spectral_gfnet__glu_gated_bilinear__prompt_kernel_tok12:
    s_cmp_lg_u32 s3, 1
    s_cbranch_scc1 .adaLN_cond__spectral_gfnet__glu_gated_bilinear__prompt_kernel_fz13
    s_lshl_b32 s24, s2, 7
    s_add_u32 s24, s24, 196620
    v_mov_b32 v200, s24
    v_mov_b32 v201, s49
    s_mov_b64 exec, 1
    global_store_dword v200, v201, s[6:7] sc1
    s_mov_b64 exec, -1
.adaLN_cond__spectral_gfnet__glu_gated_bilinear__prompt_kernel_fz13:
    s_cmp_ge_u32 s2, 80
    s_cbranch_scc1 .adaLN_cond__spectral_gfnet__glu_gated_bilinear__prompt_kernel_gp15
    s_cmp_lg_u32 s3, 0
    s_cbranch_scc1 .adaLN_cond__spectral_gfnet__glu_gated_bilinear__prompt_kernel_ng14
    v_add_u32 v176, 151552, v2
    ds_read2st64_b32 v[132:133], v176 offset0:0 offset1:1
    ds_read2st64_b32 v[134:135], v176 offset0:2 offset1:3
    ds_read2st64_b32 v[136:137], v176 offset0:4 offset1:5
    ds_read2st64_b32 v[138:139], v176 offset0:6 offset1:7
    ds_read2st64_b32 v[140:141], v176 offset0:8 offset1:9
    ds_read2st64_b32 v[142:143], v176 offset0:10 offset1:11
    ds_read2st64_b32 v[144:145], v176 offset0:12 offset1:13
    ds_read2st64_b32 v[146:147], v176 offset0:14 offset1:15
    ds_read2st64_b32 v[148:149], v176 offset0:16 offset1:17
    ds_read2st64_b32 v[150:151], v176 offset0:18 offset1:19
    ds_read2st64_b32 v[152:153], v176 offset0:20 offset1:21
    ds_read2st64_b32 v[154:155], v176 offset0:22 offset1:23
    ds_read2st64_b32 v[156:157], v176 offset0:24 offset1:25
    ds_read2st64_b32 v[158:159], v176 offset0:26 offset1:27
    ds_read2st64_b32 v[160:161], v176 offset0:28 offset1:29
    ds_read2st64_b32 v[162:163], v176 offset0:30 offset1:31
    v_mul_u32_u24 v177, 12, v63
    v_mov_b32 v167, s49
    s_waitcnt lgkmcnt(0)
    v_pk_add_f32 v[132:133], v[132:133], v[148:149]
    v_pk_add_f32 v[134:135], v[134:135], v[150:151]
    v_pk_add_f32 v[136:137], v[136:137], v[152:153]
    v_pk_add_f32 v[138:139], v[138:139], v[154:155]
    v_pk_add_f32 v[140:141], v[140:141], v[156:157]
    v_pk_add_f32 v[142:143], v[142:143], v[158:159]
    v_pk_add_f32 v[144:145], v[144:145], v[160:161]
    v_pk_add_f32 v[146:147], v[146:147], v[162:163]
    v_pk_add_f32 v[132:133], v[132:133], v[140:141]
    v_pk_add_f32 v[134:135], v[134:135], v[142:143]
    v_pk_add_f32 v[136:137], v[136:137], v[144:145]
    v_pk_add_f32 v[138:139], v[138:139], v[146:147]
    v_pk_add_f32 v[132:133], v[132:133], v[136:137]
    v_pk_add_f32 v[134:135], v[134:135], v[138:139]
    v_pk_add_f32 v[132:133], v[132:133], v[134:135]
    v_add_f32 v132, v132, v133
    ds_bpermute_b32 v164, v177, v132
    ds_bpermute_b32 v165, v177, v132 offset:4
    ds_bpermute_b32 v166, v177, v132 offset:8
    s_lshl_b32 s24, s2, 9
    s_add_u32 s24, s24, 131072
    v_add_u32 v176, s24, v1
    s_mov_b64 exec, 0x3fffff
    s_waitcnt lgkmcnt(0)
    global_store_dwordx4 v176, v[164:167], s[6:7] sc1
    s_mov_b64 exec, -1
    s_branch .adaLN_cond__spectral_gfnet__glu_gated_bilinear__prompt_kernel_ng14
.adaLN_cond__spectral_gfnet__glu_gated_bilinear__prompt_kernel_gp15:
.adaLN_cond__spectral_gfnet__glu_gated_bilinear__prompt_kernel_ng14:
    s_waitcnt vmcnt(0)
    s_mov_b32 s38, s10
    s_mov_b32 s39, s11
    s_mov_b32 s34, -2
    v_mov_b32 v240, 0
    v_mov_b32 v241, 0
    v_mov_b32 v242, 0
    v_mov_b32 v243, 0
    s_cmp_lt_u32 s3, 2
    s_cbranch_scc1 .adaLN_cond__spectral_gfnet__glu_gated_bilinear__prompt_kernel_npk17
    s_cmp_ge_u32 s2, 252
    s_cbranch_scc1 .adaLN_cond__spectral_gfnet__glu_gated_bilinear__prompt_kernel_npk17
    s_mul_i32 s43, s2, 6
    s_add_u32 s43, s43, s3
    s_sub_u32 s43, s43, 2
    s_mul_i32 s35, s3, 5120
    s_add_u32 s35, s35, 81920
    s_cmp_lt_u32 s43, 432
    s_cbranch_scc1 .adaLN_cond__spectral_gfnet__glu_gated_bilinear__prompt_kernel_pd18
    s_sub_u32 s43, s43, 432
    s_cmp_ge_u32 s43, 540
    s_cselect_b32 s50, s54, s52
    s_cselect_b32 s51, s55, s53
    s_cselect_b32 s34, 1024, 0
    s_cselect_b32 s24, 540, 0
    s_sub_u32 s43, s43, s24
    s_mul_i32 s18, s43, 2428
    s_lshr_b32 s18, s18, 16
    s_mul_i32 s19, s18, 27
    s_sub_u32 s19, s43, s19
    v_lshrrev_b32 v231, 3, v63
    v_and_b32 v232, 7, v63
    v_mul_u32_u24 v233, 3456, v231
    v_lshl_add_u32 v233, v232, 4, v233
    s_mul_i32 s24, s18, 110592
    s_lshl_b32 s25, s19, 7
    s_add_u32 s24, s24, s25
    v_add_u32 v233, s24, v233
    v_add_u32 v234, 27648, v233
    v_add_u32 v235, 55296, v233
    v_add_u32 v236, 82944, v233
    s_add_u32 m0, s35, 0
    s_nop 0
    global_load_lds_dwordx4 v233, s[50:51] offset:0
    s_add_u32 m0, s35, 1024
    s_nop 0
    global_load_lds_dwordx4 v234, s[50:51] offset:0
    s_add_u32 m0, s35, 2048
    s_nop 0
    global_load_lds_dwordx4 v235, s[50:51] offset:0
    s_add_u32 m0, s35, 3072
    s_nop 0
    global_load_lds_dwordx4 v236, s[50:51] offset:0
    s_add_u32 s24, s43, 0
    s_mul_i32 s18, s24, 2428
    s_lshr_b32 s18, s18, 16
    s_mul_i32 s19, s18, 27
    s_sub_u32 s19, s24, s19
    v_lshlrev_b32 v237, 4, v63
    s_lshl_b32 s25, s19, 2
    s_add_u32 s8, s25, 0
    s_mul_i32 s9, s8, 147
    s_lshr_b32 s9, s9, 10
    s_mul_i32 s24, s9, 7
    s_min_u32 s24, s24, 101
    s_sub_u32 s8, s8, s24
    s_and_b32 s10, s9, 3
    s_mul_i32 s10, s10, 5
    s_sub_u32 s10, s18, s10
    s_add_u32 s11, s10, 20
    s_min_u32 s10, s10, s11
    s_movk_i32 s12, 228
    s_cmp_lt_u32 s8, 6
    s_cselect_b32 s11, 2, 1
    s_cselect_b32 s12, 152, s12
    s_cmp_lt_u32 s8, 4
    s_cselect_b32 s11, 3, s11
    s_cselect_b32 s12, 0, s12
    s_lshl_b32 s10, s10, s11
    s_add_u32 s10, s10, s12
    s_lshl_b32 s8, s8, 1
    s_add_u32 s8, s8, s10
    s_mul_i32 s9, s9, 280
    s_add_u32 s8, s8, s9
    s_lshl_b32 s8, s8, 10
    s_add_u32 s8, s8, s34
    s_add_u32 s8, s8, 13107200
    v_add_u32 v240, s8, v237
    s_add_u32 s8, s25, 1
    s_mul_i32 s9, s8, 147
    s_lshr_b32 s9, s9, 10
    s_mul_i32 s24, s9, 7
    s_min_u32 s24, s24, 101
    s_sub_u32 s8, s8, s24
    s_and_b32 s10, s9, 3
    s_mul_i32 s10, s10, 5
    s_sub_u32 s10, s18, s10
    s_add_u32 s11, s10, 20
    s_min_u32 s10, s10, s11
    s_movk_i32 s12, 228
    s_cmp_lt_u32 s8, 6
    s_cselect_b32 s11, 2, 1
    s_cselect_b32 s12, 152, s12
    s_cmp_lt_u32 s8, 4
    s_cselect_b32 s11, 3, s11
    s_cselect_b32 s12, 0, s12
    s_lshl_b32 s10, s10, s11
    s_add_u32 s10, s10, s12
    s_lshl_b32 s8, s8, 1
    s_add_u32 s8, s8, s10
    s_mul_i32 s9, s9, 280
    s_add_u32 s8, s8, s9
    s_lshl_b32 s8, s8, 10
    s_add_u32 s8, s8, s34
    s_add_u32 s8, s8, 13107200
    v_add_u32 v241, s8, v237
    s_add_u32 s8, s25, 2
    s_mul_i32 s9, s8, 147
    s_lshr_b32 s9, s9, 10
    s_mul_i32 s24, s9, 7
    s_min_u32 s24, s24, 101
    s_sub_u32 s8, s8, s24
    s_and_b32 s10, s9, 3
    s_mul_i32 s10, s10, 5
    s_sub_u32 s10, s18, s10
    s_add_u32 s11, s10, 20
    s_min_u32 s10, s10, s11
    s_movk_i32 s12, 228
    s_cmp_lt_u32 s8, 6
    s_cselect_b32 s11, 2, 1
    s_cselect_b32 s12, 152, s12
    s_cmp_lt_u32 s8, 4
    s_cselect_b32 s11, 3, s11
    s_cselect_b32 s12, 0, s12
    s_lshl_b32 s10, s10, s11
    s_add_u32 s10, s10, s12
    s_lshl_b32 s8, s8, 1
    s_add_u32 s8, s8, s10
    s_mul_i32 s9, s9, 280
    s_add_u32 s8, s8, s9
    s_lshl_b32 s8, s8, 10
    s_add_u32 s8, s8, s34
    s_add_u32 s8, s8, 13107200
    v_add_u32 v242, s8, v237
    s_add_u32 s8, s25, 3
    s_mul_i32 s9, s8, 147
    s_lshr_b32 s9, s9, 10
    s_mul_i32 s24, s9, 7
    s_min_u32 s24, s24, 101
    s_sub_u32 s8, s8, s24
    s_and_b32 s10, s9, 3
    s_mul_i32 s10, s10, 5
    s_sub_u32 s10, s18, s10
    s_add_u32 s11, s10, 20
    s_min_u32 s10, s10, s11
    s_movk_i32 s12, 228
    s_cmp_lt_u32 s8, 6
    s_cselect_b32 s11, 2, 1
    s_cselect_b32 s12, 152, s12
    s_cmp_lt_u32 s8, 4
    s_cselect_b32 s11, 3, s11
    s_cselect_b32 s12, 0, s12
    s_lshl_b32 s10, s10, s11
    s_add_u32 s10, s10, s12
    s_lshl_b32 s8, s8, 1
    s_add_u32 s8, s8, s10
    s_mul_i32 s9, s9, 280
    s_add_u32 s8, s8, s9
    s_lshl_b32 s8, s8, 10
    s_add_u32 s8, s8, s34
    s_add_u32 s8, s8, 13107200
    v_add_u32 v243, s8, v237
    s_branch .adaLN_cond__spectral_gfnet__glu_gated_bilinear__prompt_kernel_npk17
.adaLN_cond__spectral_gfnet__glu_gated_bilinear__prompt_kernel_pd18:
    s_mov_b32 s34, -1
    v_add_u32 v231, 0, v63
    v_mul_u32_u24 v232, 205, v231
    v_lshrrev_b32 v232, 11, v232
    v_mul_u32_u24 v232, 1120, v232
    v_lshl_add_u32 v233, v231, 4, v232
    v_add_u32 v231, 64, v63
    v_mul_u32_u24 v232, 205, v231
    v_lshrrev_b32 v232, 11, v232
    v_mul_u32_u24 v232, 1120, v232
    v_lshl_add_u32 v234, v231, 4, v232
    v_add_u32 v231, 128, v63
    v_mul_u32_u24 v232, 205, v231
    v_lshrrev_b32 v232, 11, v232
    v_mul_u32_u24 v232, 1120, v232
    v_lshl_add_u32 v235, v231, 4, v232
    s_add_u32 s24, s43, 0
    s_lshr_b32 s18, s24, 3
    s_and_b32 s19, s24, 7
    s_lshr_b32 s24, s18, 1
    s_mul_i32 s24, s24, 3
    s_lshl_b32 s25, s18, 1
    s_add_u32 s24, s24, s25
    s_mul_i32 s25, s18, 7
    s_sub_u32 s25, s25, 206
    s_min_u32 s25, s25, 105
    s_cmp_lt_u32 s18, 30
    s_cselect_b32 s24, s24, s25
    s_add_u32 s25, s24, 1
    s_mul_i32 s52, s18, 14
    s_sub_u32 s52, s52, 638
    s_add_u32 s53, s52, 7
    s_min_u32 s53, s53, 107
    s_cmp_lt_u32 s18, 46
    s_cselect_b32 s24, s24, s52
    s_cselect_b32 s25, s25, s53
    s_lshl_b32 s24, s24, 7
    s_lshl_b32 s25, s25, 7
    s_add_u32 s24, s24, s19
    s_add_u32 s25, s25, s19
    s_mul_i32 s24, s24, 160
    s_mul_i32 s25, s25, 160
    s_add_u32 s16, s50, s24
    s_addc_u32 s17, s51, 0
    s_add_u32 s18, s50, s25
    s_addc_u32 s19, s51, 0
    s_add_u32 m0, s35, 0
    s_nop 0
    global_load_lds_dwordx4 v233, s[16:17]
    s_add_u32 m0, s35, 2560
    s_nop 0
    global_load_lds_dwordx4 v233, s[18:19]
    s_add_u32 m0, s35, 1024
    s_nop 0
    global_load_lds_dwordx4 v234, s[16:17]
    s_add_u32 m0, s35, 3584
    s_nop 0
    global_load_lds_dwordx4 v234, s[18:19]
    s_mov_b32 exec_hi, 0
    s_add_u32 m0, s35, 2048
    s_nop 0
    global_load_lds_dwordx4 v235, s[16:17]
    s_add_u32 m0, s35, 4608
    s_nop 0
    global_load_lds_dwordx4 v235, s[18:19]
    s_mov_b32 exec_hi, -1
    s_add_u32 s24, s43, 0
    s_lshr_b32 s18, s24, 3
    s_and_b32 s19, s24, 7
    s_sub_u32 s10, s18, 24
    s_sub_u32 s11, s18, 16
    s_cmp_lt_u32 s18, 46
    s_cselect_b32 s10, s11, s10
    s_cmp_lt_u32 s18, 14
    s_cselect_b32 s10, s18, s10
    s_sub_u32 s12, s18, 14
    s_lshr_b32 s13, s12, 2
    s_mul_i32 s13, s13, 6
    s_and_b32 s9, s12, 3
    s_add_u32 s13, s13, s9
    s_add_u32 s13, s13, 30
    s_cmp_lt_u32 s12, 16
    s_cselect_b32 s10, s13, s10
    s_sub_u32 s12, s18, 38
    s_lshr_b32 s13, s12, 1
    s_mul_i32 s13, s13, 6
    s_and_b32 s9, s12, 1
    s_add_u32 s13, s13, s9
    s_add_u32 s13, s13, 34
    s_cmp_lt_u32 s12, 8
    s_cselect_b32 s10, s13, s10
    s_mul_i32 s10, s10, 5120
    s_mul_i32 s8, s19, 276480
    s_add_u32 s8, s8, s10
    s_add_u32 s8, s8, 10487808
    v_lshl_add_u32 v240, v63, 4, s8
.adaLN_cond__spectral_gfnet__glu_gated_bilinear__prompt_kernel_npk17:
    s_mul_i32 s24, s3, 1280
    s_add_u32 s24, s24, 16384
    v_add_u32 v4, s24, v1
    v_add_u32 v5, s24, v2
    v_and_b32 v13, 15, v63
    v_lshlrev_b32 v6, 3, v13
    v_add_u32 v6, s24, v6
    v_lshrrev_b32 v62, 4, v63
    v_lshl_add_u32 v7, v62, 8, v6
    v_cvt_f32_u32 v14, v13
    v_cvt_f32_u32 v15, v62
    v_mul_f32 v14, 0xbacccccd, v14
    v_mul_f32 v15, 4.0, v15
    v_add_f32 v40, 0xbccccccd, v14
    v_mul_f32 v41, v14, v15
    v_mul_f32 v42, v40, v15
    v_add_f32 v81, v41, v14
    v_fma_f32 v82, 2.0, v14, v41
    v_add_f32 v83, v82, v14
    v_cos_f32 v76, v41
    v_sin_f32 v80, v41
    v_cos_f32 v77, v81
    v_sin_f32 v81, v81
    v_cos_f32 v78, v82
    v_sin_f32 v82, v82
    v_cos_f32 v79, v83
    v_sin_f32 v83, v83
    v_add_f32 v89, v42, v40
    v_fma_f32 v90, 2.0, v40, v42
    v_add_f32 v91, v90, v40
    v_cos_f32 v84, v42
    v_sin_f32 v88, v42
    v_cos_f32 v85, v89
    v_sin_f32 v89, v89
    v_cos_f32 v86, v90
    v_sin_f32 v90, v90
    v_cos_f32 v87, v91
    v_sin_f32 v91, v91
    v_lshlrev_b32 v16, 16, v8
    v_and_b32 v17, s14, v8
    v_lshlrev_b32 v18, 16, v9
    v_and_b32 v19, s14, v9
    v_lshlrev_b32 v20, 16, v10
    v_and_b32 v21, s14, v10
    v_lshlrev_b32 v22, 16, v11
    v_and_b32 v23, s14, v11
    v_lshlrev_b32 v24, 16, v12
    v_and_b32 v25, s14, v12
    v_pk_add_f32 v[26:27], v[16:17], v[18:19]
    v_pk_add_f32 v[26:27], v[26:27], v[20:21]
    v_pk_add_f32 v[26:27], v[26:27], v[22:23]
    v_pk_add_f32 v[26:27], v[26:27], v[24:25]
    v_add_f32 v36, v26, v27
    s_nop 1
    v_add_f32_dpp v36, v36, v36 quad_perm:[1,0,3,2] row_mask:0xf bank_mask:0xf
    s_nop 1
    v_add_f32_dpp v36, v36, v36 quad_perm:[2,3,0,1] row_mask:0xf bank_mask:0xf
    s_nop 1
    v_add_f32_dpp v36, v36, v36 row_ror:4 row_mask:0xf bank_mask:0xf
    s_nop 1
    v_add_f32_dpp v36, v36, v36 row_ror:8 row_mask:0xf bank_mask:0xf
    v_mov_b32 v37, v36
    s_nop 1
    v_permlane16_swap_b32 v36, v37
    v_add_f32 v36, v36, v37
    v_mov_b32 v37, v36
    s_nop 1
    v_permlane32_swap_b32 v36, v37
    v_add_f32 v36, v36, v37
    v_mul_f32 v36, 0x3acccccd, v36
    v_pk_add_f32 v[26:27], v[16:17], v[36:37] op_sel_hi:[1,0] neg_lo:[0,1] neg_hi:[0,1]
    v_pk_add_f32 v[28:29], v[18:19], v[36:37] op_sel_hi:[1,0] neg_lo:[0,1] neg_hi:[0,1]
    v_pk_add_f32 v[30:31], v[20:21], v[36:37] op_sel_hi:[1,0] neg_lo:[0,1] neg_hi:[0,1]
    v_pk_add_f32 v[32:33], v[22:23], v[36:37] op_sel_hi:[1,0] neg_lo:[0,1] neg_hi:[0,1]
    v_pk_add_f32 v[34:35], v[24:25], v[36:37] op_sel_hi:[1,0] neg_lo:[0,1] neg_hi:[0,1]
    v_pk_mul_f32 v[26:27], v[26:27], v[26:27]
    v_pk_fma_f32 v[26:27], v[28:29], v[28:29], v[26:27]
    v_pk_fma_f32 v[26:27], v[30:31], v[30:31], v[26:27]
    v_pk_fma_f32 v[26:27], v[32:33], v[32:33], v[26:27]
    v_pk_fma_f32 v[26:27], v[34:35], v[34:35], v[26:27]
    v_add_f32 v38, v26, v27
    s_nop 1
    v_add_f32_dpp v38, v38, v38 quad_perm:[1,0,3,2] row_mask:0xf bank_mask:0xf
    s_nop 1
    v_add_f32_dpp v38, v38, v38 quad_perm:[2,3,0,1] row_mask:0xf bank_mask:0xf
    s_nop 1
    v_add_f32_dpp v38, v38, v38 row_ror:4 row_mask:0xf bank_mask:0xf
    s_nop 1
    v_add_f32_dpp v38, v38, v38 row_ror:8 row_mask:0xf bank_mask:0xf
    v_mov_b32 v39, v38
    s_nop 1
    v_permlane16_swap_b32 v38, v39
    v_add_f32 v38, v38, v39
    v_mov_b32 v39, v38
    s_nop 1
    v_permlane32_swap_b32 v38, v39
    v_add_f32 v38, v38, v39
    v_mul_f32 v38, 0x3acccccd, v38
    v_cvt_pk_bf16_f32 v36, v36, v38
    v_and_b32 v38, s14, v36
    v_lshlrev_b32 v36, 16, v36
    v_add_f32 v38, 0x3727c5ac, v38
    v_cvt_pk_bf16_f32 v38, v38, v38
    v_lshlrev_b32 v38, 16, v38
    v_sqrt_f32 v38, v38
    s_nop 0
    v_cvt_pk_bf16_f32 v38, v38, v38
    v_lshlrev_b32 v38, 16, v38
    v_rcp_f32 v38, v38
    s_cmp_lg_u32 s33, 2
    s_cbranch_scc1 .adaLN_cond__spectral_gfnet__glu_gated_bilinear__prompt_kernel_nc19
    v_lshlrev_b32 v152, 16, v152
    v_mul_f32 v153, 0xbfb8aa3b, v152
    v_lshlrev_b32 v154, 16, v154
    v_mul_f32 v155, 0xbfb8aa3b, v154
    v_lshlrev_b32 v156, 16, v156
    v_mul_f32 v157, 0xbfb8aa3b, v156
    v_lshlrev_b32 v158, 16, v158
    v_mul_f32 v159, 0xbfb8aa3b, v158
    v_lshlrev_b32 v160, 16, v160
    v_mul_f32 v161, 0xbfb8aa3b, v160
    v_exp_f32 v153, v153
    v_exp_f32 v155, v155
    v_exp_f32 v157, v157
    v_exp_f32 v159, v159
    v_exp_f32 v161, v161
    v_add_f32 v153, 1.0, v153
    v_add_f32 v155, 1.0, v155
    v_add_f32 v157, 1.0, v157
    v_add_f32 v159, 1.0, v159
    v_add_f32 v161, 1.0, v161
    v_rcp_f32 v153, v153
    v_rcp_f32 v155, v155
    v_rcp_f32 v157, v157
    v_rcp_f32 v159, v159
    v_rcp_f32 v161, v161
    v_mul_f32 v152, v152, v153
    v_mul_f32 v154, v154, v155
    v_mul_f32 v156, v156, v157
    v_mul_f32 v158, v158, v159
    v_mul_f32 v160, v160, v161
    v_cvt_pk_bf16_f32 v152, v152, v152
    v_cvt_pk_bf16_f32 v154, v154, v154
    v_cvt_pk_bf16_f32 v156, v156, v156
    v_cvt_pk_bf16_f32 v158, v158, v158
    v_cvt_pk_bf16_f32 v160, v160, v160
    v_lshlrev_b32 v152, 16, v152
    v_lshlrev_b32 v154, 16, v154
    v_lshlrev_b32 v156, 16, v156
    v_lshlrev_b32 v158, 16, v158
    v_lshlrev_b32 v160, 16, v160
    v_lshlrev_b32 v172, 16, v132
    v_and_b32 v173, s14, v132
    v_pk_mul_f32 v[164:165], v[172:173], v[152:153] op_sel_hi:[1,0]
    v_lshlrev_b32 v174, 16, v133
    v_and_b32 v175, s14, v133
    v_pk_mul_f32 v[166:167], v[174:175], v[152:153] op_sel_hi:[1,0]
    v_lshlrev_b32 v172, 16, v134
    v_and_b32 v173, s14, v134
    v_pk_mul_f32 v[168:169], v[172:173], v[152:153] op_sel_hi:[1,0]
    v_lshlrev_b32 v174, 16, v135
    v_and_b32 v175, s14, v135
    v_pk_mul_f32 v[170:171], v[174:175], v[152:153] op_sel_hi:[1,0]
    v_lshlrev_b32 v172, 16, v136
    v_and_b32 v173, s14, v136
    v_pk_fma_f32 v[164:165], v[172:173], v[154:155], v[164:165] op_sel_hi:[1,0,1]
    v_lshlrev_b32 v174, 16, v137
    v_and_b32 v175, s14, v137
    v_pk_fma_f32 v[166:167], v[174:175], v[154:155], v[166:167] op_sel_hi:[1,0,1]
    v_lshlrev_b32 v172, 16, v138
    v_and_b32 v173, s14, v138
    v_pk_fma_f32 v[168:169], v[172:173], v[154:155], v[168:169] op_sel_hi:[1,0,1]
    v_lshlrev_b32 v174, 16, v139
    v_and_b32 v175, s14, v139
    v_pk_fma_f32 v[170:171], v[174:175], v[154:155], v[170:171] op_sel_hi:[1,0,1]
    v_lshlrev_b32 v172, 16, v140
    v_and_b32 v173, s14, v140
    v_pk_fma_f32 v[164:165], v[172:173], v[156:157], v[164:165] op_sel_hi:[1,0,1]
    v_lshlrev_b32 v174, 16, v141
    v_and_b32 v175, s14, v141
    v_pk_fma_f32 v[166:167], v[174:175], v[156:157], v[166:167] op_sel_hi:[1,0,1]
    v_lshlrev_b32 v172, 16, v142
    v_and_b32 v173, s14, v142
    v_pk_fma_f32 v[168:169], v[172:173], v[156:157], v[168:169] op_sel_hi:[1,0,1]
    v_lshlrev_b32 v174, 16, v143
    v_and_b32 v175, s14, v143
    v_pk_fma_f32 v[170:171], v[174:175], v[156:157], v[170:171] op_sel_hi:[1,0,1]
    v_lshlrev_b32 v172, 16, v144
    v_and_b32 v173, s14, v144
    v_pk_fma_f32 v[164:165], v[172:173], v[158:159], v[164:165] op_sel_hi:[1,0,1]
    v_lshlrev_b32 v174, 16, v145
    v_and_b32 v175, s14, v145
    v_pk_fma_f32 v[166:167], v[174:175], v[158:159], v[166:167] op_sel_hi:[1,0,1]
    v_lshlrev_b32 v172, 16, v146
    v_and_b32 v173, s14, v146
    v_pk_fma_f32 v[168:169], v[172:173], v[158:159], v[168:169] op_sel_hi:[1,0,1]
    v_lshlrev_b32 v174, 16, v147
    v_and_b32 v175, s14, v147
    v_pk_fma_f32 v[170:171], v[174:175], v[158:159], v[170:171] op_sel_hi:[1,0,1]
    v_lshlrev_b32 v172, 16, v148
    v_and_b32 v173, s14, v148
    v_pk_fma_f32 v[164:165], v[172:173], v[160:161], v[164:165] op_sel_hi:[1,0,1]
    v_lshlrev_b32 v174, 16, v149
    v_and_b32 v175, s14, v149
    v_pk_fma_f32 v[166:167], v[174:175], v[160:161], v[166:167] op_sel_hi:[1,0,1]
    v_lshlrev_b32 v172, 16, v150
    v_and_b32 v173, s14, v150
    v_pk_fma_f32 v[168:169], v[172:173], v[160:161], v[168:169] op_sel_hi:[1,0,1]
    v_lshlrev_b32 v174, 16, v151
    v_and_b32 v175, s14, v151
    v_pk_fma_f32 v[170:171], v[174:175], v[160:161], v[170:171] op_sel_hi:[1,0,1]
    v_add_f32_dpp v164, v164, v164 row_ror:8 row_mask:0xf bank_mask:0xf
    v_add_f32_dpp v165, v165, v165 row_ror:8 row_mask:0xf bank_mask:0xf
    v_add_f32_dpp v166, v166, v166 row_ror:8 row_mask:0xf bank_mask:0xf
    v_add_f32_dpp v167, v167, v167 row_ror:8 row_mask:0xf bank_mask:0xf
    v_add_f32_dpp v168, v168, v168 row_ror:8 row_mask:0xf bank_mask:0xf
    v_add_f32_dpp v169, v169, v169 row_ror:8 row_mask:0xf bank_mask:0xf
    v_add_f32_dpp v170, v170, v170 row_ror:8 row_mask:0xf bank_mask:0xf
    v_add_f32_dpp v171, v171, v171 row_ror:8 row_mask:0xf bank_mask:0xf
    v_lshrrev_b32 v176, 4, v130
    v_lshlrev_b32 v176, 8, v176
    v_and_b32 v177, 7, v130
    v_lshl_add_u32 v176, v177, 5, v176
    v_add_u32 v176, 151552, v176
    s_mov_b32 exec_lo, 0x00ff00ff
    s_mov_b32 exec_hi, 0x00ff00ff
    ds_write_b128 v176, v[164:167]
    ds_write_b128 v176, v[168:171] offset:16
    s_mov_b64 exec, -1
.adaLN_cond__spectral_gfnet__glu_gated_bilinear__prompt_kernel_nc19:
    s_waitcnt lgkmcnt(0)
    s_barrier
    s_cmp_lg_u32 s33, 2
    s_cbranch_scc1 .adaLN_cond__spectral_gfnet__glu_gated_bilinear__prompt_kernel_nc19_b
    s_cmp_lg_u32 s3, 3
    s_cbranch_scc1 .adaLN_cond__spectral_gfnet__glu_gated_bilinear__prompt_kernel_nc19_b
    v_add_u32 v176, 151552, v2
    ds_read2st64_b32 v[132:133], v176 offset0:0 offset1:1
    ds_read2st64_b32 v[134:135], v176 offset0:2 offset1:3
    ds_read2st64_b32 v[136:137], v176 offset0:4 offset1:5
    ds_read2st64_b32 v[138:139], v176 offset0:6 offset1:7
    ds_read2st64_b32 v[140:141], v176 offset0:8 offset1:9
    ds_read2st64_b32 v[142:143], v176 offset0:10 offset1:11
    ds_read2st64_b32 v[144:145], v176 offset0:12 offset1:13
    ds_read2st64_b32 v[146:147], v176 offset0:14 offset1:15
    s_waitcnt lgkmcnt(0)
    v_pk_add_f32 v[132:133], v[132:133], v[140:141]
    v_pk_add_f32 v[134:135], v[134:135], v[142:143]
    v_pk_add_f32 v[136:137], v[136:137], v[144:145]
    v_pk_add_f32 v[138:139], v[138:139], v[146:147]
    v_pk_add_f32 v[132:133], v[132:133], v[136:137]
    v_pk_add_f32 v[134:135], v[134:135], v[138:139]
    v_pk_add_f32 v[132:133], v[132:133], v[134:135]
    v_add_f32 v132, v132, v133
    s_mul_i32 s12, s38, 15360
    s_lshl_b32 s13, s39, 8
    s_add_u32 s12, s12, s13
    s_add_u32 s12, s12, 65536
    v_add_u32 v179, s12, v2
    global_store_dword v179, v132, s[6:7] sc1
.adaLN_cond__spectral_gfnet__glu_gated_bilinear__prompt_kernel_nc19_b:
    s_bfe_u32 s24, s2, 0x10003
    s_mul_i32 s25, s24, 161
    v_and_b32 v176, 3, v0
    v_lshrrev_b32 v177, 2, v0
    v_sub_u32 v177, 127, v177
    s_sub_u32 s24, 33, s24
    v_cmp_gt_u32 vcc, s24, v177
    v_add_u32 v177, s25, v177
    v_mul_u32_u24 v179, 2568, v176
    v_lshl_add_u32 v179, v177, 1, v179
    v_add_u32 v179, 122880, v179
    v_lshlrev_b32 v180, 13, v177
    v_lshl_add_u32 v180, v176, 4, v180
    s_lshl_b32 s24, s15, 6
    s_add_u32 s24, s24, 1048576
    v_add_u32 v180, s24, v180
    ds_read_u16 v184, v179 offset:0
    ds_read_u16 v188, v179 offset:12288
    ds_read_u16 v185, v179 offset:642
    ds_read_u16 v189, v179 offset:12930
    ds_read_u16 v186, v179 offset:1284
    ds_read_u16 v190, v179 offset:13572
    ds_read_u16 v187, v179 offset:1926
    ds_read_u16 v191, v179 offset:14214
    s_waitcnt lgkmcnt(0)
    v_lshl_or_b32 v184, v188, 16, v184
    v_lshl_or_b32 v185, v189, 16, v185
    v_lshl_or_b32 v186, v190, 16, v186
    v_lshl_or_b32 v187, v191, 16, v187
    v_or_b32 v184, 1, v184
    global_store_dwordx4 v180, v[184:187], s[6:7] sc1
    s_and_b64 exec, exec, vcc
    s_cbranch_execz .adaLN_cond__spectral_gfnet__glu_gated_bilinear__prompt_kernel_q316
    v_add_u32 v180, 1048576, v180
    ds_read_u16 v192, v179 offset:256
    ds_read_u16 v196, v179 offset:12544
    ds_read_u16 v193, v179 offset:898
    ds_read_u16 v197, v179 offset:13186
    ds_read_u16 v194, v179 offset:1540
    ds_read_u16 v198, v179 offset:13828
    ds_read_u16 v195, v179 offset:2182
    ds_read_u16 v199, v179 offset:14470
    s_waitcnt lgkmcnt(0)
    v_lshl_or_b32 v192, v196, 16, v192
    v_lshl_or_b32 v193, v197, 16, v193
    v_lshl_or_b32 v194, v198, 16, v194
    v_lshl_or_b32 v195, v199, 16, v195
    v_or_b32 v192, 1, v192
    global_store_dwordx4 v180, v[192:195], s[6:7] sc1
.adaLN_cond__spectral_gfnet__glu_gated_bilinear__prompt_kernel_q316:
    s_mov_b64 exec, -1
    v_min_u32 v176, 439, v0
    v_mul_u32_u24 v177, 2979, v176
    v_lshrrev_b32 v177, 16, v177
    v_mul_u32_u24 v178, 22, v177
    v_sub_u32 v176, v176, v178
    v_lshlrev_b32 v178, 11, v177
    v_lshl_add_u32 v178, v176, 4, v178
    v_add_u32 v178, 131072, v178
    v_lshlrev_b32 v179, 9, v63
    v_add_u32 v179, 196608, v179
    s_movk_i32 s24, 512
    s_cmp_eq_u32 s3, 7
    s_cselect_b32 s24, 128, s24
    s_cselect_b64 vcc, -1, 0
    v_mul_u32_u24 v113, 6, v176
    v_lshl_add_u32 v113, v177, 7, v113
    v_cndmask_b32 v178, v178, v179, vcc
    v_add_u32 v179, s24, v178
    v_add_u32 v180, s24, v179
    v_add_u32 v181, s24, v180
    v_cmp_le_u32 vcc, 10, v177
    v_cmp_gt_u32 s[12:13], 21, v176
    s_nop 0
    v_cndmask_b32 v112, 0, 1.0, vcc
.adaLN_cond__spectral_gfnet__glu_gated_bilinear__prompt_kernel_gl20:
    global_load_dwordx4 v[96:99], v178, s[6:7] sc1
    global_load_dwordx4 v[100:103], v179, s[6:7] sc1
    global_load_dwordx4 v[104:107], v180, s[6:7] sc1
    global_load_dwordx4 v[108:111], v181, s[6:7] sc1
    s_waitcnt vmcnt(0)
    v_xor_b32 v99, s49, v99
    v_xor_b32 v103, s49, v103
    v_xor_b32 v107, s49, v107
    v_xor_b32 v111, s49, v111
    v_or3_b32 v182, v99, v103, v107
    v_or_b32 v182, v182, v111
    v_cmp_ne_u32 vcc, 0, v182
    s_cbranch_vccnz .adaLN_cond__spectral_gfnet__glu_gated_bilinear__prompt_kernel_gr22
.adaLN_cond__spectral_gfnet__glu_gated_bilinear__prompt_kernel_gok21:
    s_cmp_eq_u32 s3, 7
    s_cbranch_scc1 .adaLN_cond__spectral_gfnet__glu_gated_bilinear__prompt_kernel_gd23
    v_pk_add_f32 v[96:97], v[96:97], v[100:101]
    v_pk_add_f32 v[98:99], v[98:99], v[102:103]
    v_pk_add_f32 v[104:105], v[104:105], v[108:109]
    v_pk_add_f32 v[106:107], v[106:107], v[110:111]
    v_pk_add_f32 v[96:97], v[96:97], v[104:105]
    v_pk_add_f32 v[98:99], v[98:99], v[106:107]
    v_cvt_pk_bf16_f32 v100, v96, v97
    v_cvt_pk_bf16_f32 v101, v98, v99
    v_lshlrev_b32 v96, 16, v100
    v_and_b32 v97, s14, v100
    v_lshlrev_b32 v98, 16, v101
    v_and_b32 v99, s14, v101
    v_add_f32 v96, v96, v112
    v_add_f32 v97, v97, v112
    v_add_f32 v98, v98, v112
    v_add_f32 v99, v99, v112
    v_cvt_pk_bf16_f32 v96, v96, v97
    v_cvt_pk_bf16_f32 v97, v98, v99
    ds_write_b16 v113, v96 offset:37888
    s_mov_b64 exec, s[12:13]
    ds_write_b16_d16_hi v113, v96 offset:37890
    ds_write_b16 v113, v97 offset:37892
    s_mov_b64 exec, -1
.adaLN_cond__spectral_gfnet__glu_gated_bilinear__prompt_kernel_gd23:
    s_waitcnt lgkmcnt(0)
    s_barrier
    s_cmp_eq_u32 s34, -2
    s_cbranch_scc1 .adaLN_cond__spectral_gfnet__glu_gated_bilinear__prompt_kernel_pe25
    s_cmp_eq_u32 s34, -1
    s_cbranch_scc1 .adaLN_cond__spectral_gfnet__glu_gated_bilinear__prompt_kernel_pd24
    v_lshrrev_b32 v231, 4, v63
    v_lshlrev_b32 v231, 10, v231
    v_bfe_u32 v232, v63, 2, 2
    v_lshl_add_u32 v231, v232, 7, v231
    v_and_b32 v232, 3, v63
    v_lshl_add_u32 v231, v232, 3, v231
    v_add_u32 v231, s35, v231
    ds_read_b64_tr_b16 v[200:201], v231 offset:0
    ds_read_b64_tr_b16 v[202:203], v231 offset:512
    ds_read_b64_tr_b16 v[204:205], v231 offset:32
    ds_read_b64_tr_b16 v[206:207], v231 offset:544
    ds_read_b64_tr_b16 v[208:209], v231 offset:64
    ds_read_b64_tr_b16 v[210:211], v231 offset:576
    ds_read_b64_tr_b16 v[212:213], v231 offset:96
    ds_read_b64_tr_b16 v[214:215], v231 offset:608
    s_waitcnt lgkmcnt(6)
    global_store_dwordx4 v240, v[200:203], s[6:7] sc1
    s_waitcnt lgkmcnt(4)
    global_store_dwordx4 v241, v[204:207], s[6:7] sc1
    s_waitcnt lgkmcnt(2)
    global_store_dwordx4 v242, v[208:211], s[6:7] sc1
    s_waitcnt lgkmcnt(0)
    global_store_dwordx4 v243, v[212:215], s[6:7] sc1
    s_branch .adaLN_cond__spectral_gfnet__glu_gated_bilinear__prompt_kernel_pe25
.adaLN_cond__spectral_gfnet__glu_gated_bilinear__prompt_kernel_pd24:
    v_lshrrev_b32 v231, 2, v63
    v_mul_u32_u24 v231, 160, v231
    v_and_b32 v232, 3, v63
    v_add_u32 v231, s35, v231
    v_lshl_add_u32 v239, v232, 3, v231
    v_lshl_add_u32 v231, v232, 4, v231
    ds_read_b64_tr_b16 v[200:201], v231 offset:0
    ds_read_b64_tr_b16 v[202:203], v231 offset:2560
    ds_read_b64_tr_b16 v[204:205], v231 offset:8
    ds_read_b64_tr_b16 v[206:207], v231 offset:2568
    ds_read_b64_tr_b16 v[208:209], v231 offset:64
    ds_read_b64_tr_b16 v[210:211], v231 offset:2624
    ds_read_b64_tr_b16 v[212:213], v231 offset:72
    ds_read_b64_tr_b16 v[214:215], v231 offset:2632
    ds_read_b64_tr_b16 v[216:217], v239 offset:128
    ds_read_b64_tr_b16 v[218:219], v239 offset:2688
    s_waitcnt lgkmcnt(8)
    global_store_dwordx4 v240, v[200:203], s[6:7] offset:-2048 sc1
    s_waitcnt lgkmcnt(6)
    global_store_dwordx4 v240, v[204:207], s[6:7] offset:-1024 sc1
    s_waitcnt lgkmcnt(4)
    global_store_dwordx4 v240, v[208:211], s[6:7] offset:0 sc1
    s_waitcnt lgkmcnt(2)
    global_store_dwordx4 v240, v[212:215], s[6:7] offset:1024 sc1
    s_waitcnt lgkmcnt(0)
    global_store_dwordx4 v240, v[216:219], s[6:7] offset:2048 sc1
.adaLN_cond__spectral_gfnet__glu_gated_bilinear__prompt_kernel_pe25:
    ds_read_b128 v[40:43], v1 offset:39168
    ds_read_b32 v44, v2 offset:40192
    ds_read_b128 v[46:49], v1 offset:37888
    ds_read_b32 v50, v2 offset:38912
    ds_read_b128 v[92:95], v1 offset:0
    ds_read_b128 v[96:99], v1 offset:1024
    ds_read_b128 v[100:103], v1 offset:2048
    ds_read_b128 v[104:107], v1 offset:3072
    ds_read_b128 v[108:111], v1 offset:4096
    ds_read_b128 v[112:115], v1 offset:5120
    ds_read_b128 v[116:119], v1 offset:6144
    ds_read_b128 v[120:123], v1 offset:7168
    s_waitcnt lgkmcnt(8)
    v_lshlrev_b32 v52, 16, v40
    v_and_b32 v53, s14, v40
    v_lshlrev_b32 v54, 16, v41
    v_and_b32 v55, s14, v41
    v_lshlrev_b32 v56, 16, v42
    v_and_b32 v57, s14, v42
    v_lshlrev_b32 v58, 16, v43
    v_and_b32 v59, s14, v43
    v_lshlrev_b32 v60, 16, v44
    v_and_b32 v61, s14, v44
    v_lshlrev_b32 v64, 16, v46
    v_and_b32 v65, s14, v46
    v_lshlrev_b32 v66, 16, v47
    v_and_b32 v67, s14, v47
    v_lshlrev_b32 v68, 16, v48
    v_and_b32 v69, s14, v48
    v_lshlrev_b32 v70, 16, v49
    v_and_b32 v71, s14, v49
    v_lshlrev_b32 v72, 16, v50
    v_and_b32 v73, s14, v50
    v_pk_add_f32 v[26:27], v[16:17], v[36:37] op_sel_hi:[1,0] neg_lo:[0,1] neg_hi:[0,1]
    v_pk_add_f32 v[28:29], v[18:19], v[36:37] op_sel_hi:[1,0] neg_lo:[0,1] neg_hi:[0,1]
    v_pk_add_f32 v[30:31], v[20:21], v[36:37] op_sel_hi:[1,0] neg_lo:[0,1] neg_hi:[0,1]
    v_pk_add_f32 v[32:33], v[22:23], v[36:37] op_sel_hi:[1,0] neg_lo:[0,1] neg_hi:[0,1]
    v_pk_add_f32 v[34:35], v[24:25], v[36:37] op_sel_hi:[1,0] neg_lo:[0,1] neg_hi:[0,1]
    v_pk_mul_f32 v[26:27], v[26:27], v[38:39] op_sel_hi:[1,0]
    v_pk_mul_f32 v[28:29], v[28:29], v[38:39] op_sel_hi:[1,0]
    v_pk_mul_f32 v[30:31], v[30:31], v[38:39] op_sel_hi:[1,0]
    v_pk_mul_f32 v[32:33], v[32:33], v[38:39] op_sel_hi:[1,0]
    v_pk_mul_f32 v[34:35], v[34:35], v[38:39] op_sel_hi:[1,0]
    v_pk_fma_f32 v[26:27], v[26:27], v[52:53], v[64:65]
    v_pk_fma_f32 v[28:29], v[28:29], v[54:55], v[66:67]
    v_pk_fma_f32 v[30:31], v[30:31], v[56:57], v[68:69]
    v_pk_fma_f32 v[32:33], v[32:33], v[58:59], v[70:71]
    v_pk_fma_f32 v[34:35], v[34:35], v[60:61], v[72:73]
    v_cvt_pk_bf16_f32 v8, v26, v27
    v_cvt_pk_bf16_f32 v9, v28, v29
    v_cvt_pk_bf16_f32 v10, v30, v31
    v_cvt_pk_bf16_f32 v11, v32, v33
    v_cvt_pk_bf16_f32 v12, v34, v35
    ds_write_b128 v4, v[8:11]
    ds_write_b32 v5, v12 offset:1024
    s_waitcnt lgkmcnt(0)
    ds_read_b64_tr_b16 v[16:17], v7
    ds_read_b64_tr_b16 v[18:19], v7 offset:128
    ds_read_b64_tr_b16 v[20:21], v6 offset:1024
    ds_read_b64_tr_b16 v[22:23], v6 offset:1152
    ds_read_b128 v[52:55], v1 offset:8192
    ds_read_b128 v[56:59], v1 offset:9216
    s_mul_i32 s24, s3, 672
    s_add_u32 s24, s24, 26624
    v_lshlrev_b32 v4, 5, v13
    v_lshl_add_u32 v4, v62, 3, v4
    v_add_u32 v4, s24, v4
    s_waitcnt lgkmcnt(4)
    v_mfma_f32_16x16x32_bf16 v[24:27], v[16:19], v[92:95], 0
    v_mfma_f32_16x16x32_bf16 v[28:31], v[16:19], v[96:99], 0
    v_mfma_f32_16x16x32_bf16 v[32:35], v[16:19], v[100:103], 0
    v_mfma_f32_16x16x32_bf16 v[36:39], v[16:19], v[104:107], 0
    s_waitcnt lgkmcnt(2)
    v_mfma_f32_16x16x32_bf16 v[24:27], v[20:23], v[108:111], v[24:27]
    v_mfma_f32_16x16x32_bf16 v[28:31], v[20:23], v[112:115], v[28:31]
    v_mfma_f32_16x16x32_bf16 v[32:35], v[20:23], v[116:119], v[32:35]
    v_mfma_f32_16x16x32_bf16 v[36:39], v[20:23], v[120:123], v[36:39]
    s_lshl_b32 s24, s3, 1
    v_lshrrev_b32 v5, 5, v63
    v_add_u32 v5, s24, v5
    v_and_b32 v7, 1, v62
    v_bfe_u32 v64, v63, 2, 2
    v_mul_u32_u24 v64, 672, v64
    v_and_b32 v14, 3, v63
    v_lshl_add_u32 v64, v14, 3, v64
    v_mul_u32_u24 v14, 5504, v7
    v_add_u32 v64, v64, v14
    v_add_u32 v64, 26624, v64
    v_pk_mul_f32 v[40:41], v[28:29], v[80:81]
    v_pk_mul_f32 v[42:43], v[24:25], v[80:81]
    v_pk_fma_f32 v[24:25], v[24:25], v[76:77], v[40:41] neg_lo:[0,0,1] neg_hi:[0,0,1]
    v_pk_fma_f32 v[28:29], v[28:29], v[76:77], v[42:43]
    v_pk_mul_f32 v[40:41], v[30:31], v[82:83]
    v_pk_mul_f32 v[42:43], v[26:27], v[82:83]
    v_pk_fma_f32 v[26:27], v[26:27], v[78:79], v[40:41] neg_lo:[0,0,1] neg_hi:[0,0,1]
    v_pk_fma_f32 v[30:31], v[30:31], v[78:79], v[42:43]
    v_cvt_pk_bf16_f32 v44, v24, v25
    v_cvt_pk_bf16_f32 v45, v26, v27
    v_cvt_pk_bf16_f32 v46, v28, v29
    v_cvt_pk_bf16_f32 v47, v30, v31
    v_pk_mul_f32 v[40:41], v[36:37], v[88:89]
    v_pk_mul_f32 v[42:43], v[32:33], v[88:89]
    v_pk_fma_f32 v[32:33], v[32:33], v[84:85], v[40:41] neg_lo:[0,0,1] neg_hi:[0,0,1]
    v_pk_fma_f32 v[36:37], v[36:37], v[84:85], v[42:43]
    v_pk_mul_f32 v[40:41], v[38:39], v[90:91]
    v_pk_mul_f32 v[42:43], v[34:35], v[90:91]
    v_pk_fma_f32 v[34:35], v[34:35], v[86:87], v[40:41] neg_lo:[0,0,1] neg_hi:[0,0,1]
    v_pk_fma_f32 v[38:39], v[38:39], v[86:87], v[42:43]
    v_cvt_pk_bf16_f32 v48, v32, v33
    v_cvt_pk_bf16_f32 v49, v34, v35
    v_cvt_pk_bf16_f32 v50, v36, v37
    v_cvt_pk_bf16_f32 v51, v38, v39
    s_waitcnt lgkmcnt(0)
    v_mfma_f32_16x16x32_bf16 v[24:27], v[52:55], v[44:47], 0
    v_mfma_f32_16x16x32_bf16 v[28:31], v[56:59], v[44:47], 0
    v_mfma_f32_16x16x32_bf16 v[32:35], v[52:55], v[48:51], 0
    v_mfma_f32_16x16x32_bf16 v[36:39], v[56:59], v[48:51], 0
    v_lshl_add_u32 v14, v5, 5, v64
    v_add_u32 v15, 16, v5
    v_min_u32 v65, 20, v15
    v_lshl_add_u32 v64, v65, 5, v64
    v_mul_u32_u24 v66, 40, v13
    s_lshr_b32 s24, s20, 4
    s_lshl_b32 s24, s24, 12
    s_and_b32 s25, s20, 8
    s_lshl_b32 s25, s25, 5
    s_add_u32 s24, s24, s25
    s_and_b32 s25, s20, 1
    s_lshl_b32 s25, s25, 7
    s_add_u32 s24, s24, s25
    s_and_b32 s25, s20, 6
    s_lshl_b32 s25, s25, 4
    s_add_u32 s24, s24, s25
    s_lshl_b32 s25, s21, 9
    s_add_u32 s24, s24, s25
    s_add_u32 s24, s24, 4194304
    v_lshl_add_u32 v7, v7, 4, s24
    v_cmp_gt_u32 vcc, 8, v13
    v_add_u32 v67, v66, v5
    v_sub_u32 v68, 640, v67
    v_cndmask_b32 v67, v68, v67, vcc
    v_add_u32 v69, v66, v65
    v_sub_u32 v68, 640, v69
    v_cndmask_b32 v69, v68, v69, vcc
    v_lshl_add_u32 v67, v67, 13, v7
    v_lshl_add_u32 v69, v69, 13, v7
    v_cmp_ne_u32 s[26:27], 0, v5
    v_cmp_gt_u32 s[28:29], 9, v13
    s_nop 0
    s_or_b64 s[26:27], s[26:27], s[28:29]
    v_cmp_gt_u32 s[28:29], 20, v15
    v_cmp_eq_u32 s[30:31], 20, v15
    s_nop 0
    s_and_b64 s[30:31], s[30:31], vcc
    s_or_b64 s[28:29], s[28:29], s[30:31]
    v_cvt_pk_bf16_f32 v44, v24, v25
    v_cvt_pk_bf16_f32 v45, v26, v27
    v_cvt_pk_bf16_f32 v46, v28, v29
    v_cvt_pk_bf16_f32 v47, v30, v31
    v_cvt_pk_bf16_f32 v48, v32, v33
    v_cvt_pk_bf16_f32 v49, v34, v35
    v_cvt_pk_bf16_f32 v50, v36, v37
    v_cvt_pk_bf16_f32 v51, v38, v39
    ds_write_b64 v4, v[44:45]
    ds_write_b64 v4, v[46:47] offset:5504
    s_mov_b32 exec_lo, 0x001f001f
    s_mov_b32 exec_hi, 0x001f001f
    ds_write_b64 v4, v[48:49] offset:512
    ds_write_b64 v4, v[50:51] offset:6016
    s_mov_b64 exec, -1
    s_waitcnt vmcnt(0) lgkmcnt(0)
    s_barrier
    ds_read_b64_tr_b16 v[8:9], v14
    ds_read_b64_tr_b16 v[10:11], v14 offset:2688
    ds_read_b64_tr_b16 v[24:25], v64
    ds_read_b64_tr_b16 v[26:27], v64 offset:2688
    s_mov_b64 exec, s[26:27]
    s_waitcnt lgkmcnt(2)
    v_or_b32 v8, 1, v8
    global_store_dwordx4 v67, v[8:11], s[6:7] sc1
    s_mov_b64 exec, s[28:29]
    s_cbranch_execz .adaLN_cond__spectral_gfnet__glu_gated_bilinear__prompt_kernel_st4
    s_waitcnt lgkmcnt(0)
    v_or_b32 v24, 1, v24
    global_store_dwordx4 v69, v[24:27], s[6:7] sc1
.adaLN_cond__spectral_gfnet__glu_gated_bilinear__prompt_kernel_st4:
    s_mov_b64 exec, -1
    s_waitcnt lgkmcnt(0)
    s_mul_i32 s24, s37, 286720
    s_add_u32 s24, s24, 13107200
    s_add_u32 s46, s6, s24
    s_addc_u32 s47, s7, 0
    s_min_u32 s24, s37, 14
    s_mul_i32 s24, s24, 286720
    s_add_u32 s24, s24, 13107200
    s_add_u32 s48, s6, s24
    s_addc_u32 s49, s7, 0
    s_mul_i32 s34, s3, 6144
    s_add_u32 s34, s34, 73728
    s_add_u32 s32, s48, s34
    s_addc_u32 s33, s49, 0
    v_and_b32 v165, 63, v0
    v_lshlrev_b32 v165, 4, v165
    s_lshl_b32 s24, s36, 4
    s_add_u32 s24, s24, s37
    s_mul_i32 s24, s24, 27648
    s_mul_i32 s25, s3, 3456
    s_add_u32 s24, s24, s25
    s_add_u32 s24, s24, 17825792
    s_add_u32 s52, s6, s24
    s_addc_u32 s53, s7, 0
    v_mov_b32 v224, -1
    v_mov_b32 v225, -1
    v_mov_b32 v226, -1
    v_mov_b32 v227, -1
    global_store_dwordx4 v165, v[224:227], s[52:53] offset:0 sc1
    global_store_dwordx4 v165, v[224:227], s[52:53] offset:1024 sc1
    global_store_dwordx4 v165, v[224:227], s[52:53] offset:2048 sc1
    s_mov_b64 exec, 0xffffff
    global_store_dwordx4 v165, v[224:227], s[52:53] offset:3072 sc1
    s_mov_b64 exec, -1
    s_and_b32 s26, s3, 3
    s_lshr_b32 s27, s3, 2
    s_lshl_b32 s28, s27, 8
    s_add_u32 s28, s28, s2
    s_mul_i32 s27, s27, 40960
    s_cmp_ge_u32 s28, 321
    s_cbranch_scc1 .adaLN_cond__spectral_gfnet__glu_gated_bilinear__prompt_kernel_pack26
    v_and_b32 v2, 15, v0
    v_bfe_u32 v3, v0, 4, 2
    s_getpc_b64 s[8:9]
    s_add_u32 s8, s8, tab2@rel32@lo+4
    s_addc_u32 s9, s9, tab2@rel32@hi+12
    v_and_b32 v4, 63, v0
    v_lshlrev_b32 v4, 4, v4
    s_lshl_b32 s10, s26, 12
    v_add_u32 v5, s10, v4
    s_lshl_b32 s13, s26, 10
    s_add_u32 s10, s13, 16384
    v_add_u32 v7, s10, v4
    s_add_u32 s13, s13, s27
    s_add_u32 m0, s13, 16384
    global_load_dwordx4 v[40:43], v5, s[8:9] offset:0
    global_load_dwordx4 v[44:47], v5, s[8:9] offset:1024
    global_load_dwordx4 v[48:51], v5, s[8:9] offset:2048
    global_load_dwordx4 v[52:55], v5, s[8:9] offset:3072
    global_load_lds_dwordx4 v7, s[8:9]
    s_lshl_b32 s13, s26, 11
    v_add_u32 v156, s13, v4
    s_add_u32 s13, s13, s27
    s_lshl_b32 s12, s28, 13
    s_mov_b32 s15, 0x80008000
    s_add_u32 s10, s6, s12
    s_addc_u32 s11, s7, 0
    s_add_u32 s16, s10, 4194304
    s_addc_u32 s17, s11, 0
    s_add_u32 s18, s10, 1048576
    s_addc_u32 s19, s11, 0
    s_add_u32 s30, s10, 4194304
    s_addc_u32 s31, s11, 0
    v_add_u32 v157, s13, v4
    s_lshl_b32 s12, s26, 4
    v_add_u32 v5, s12, v2
    v_cvt_f32_u32 v5, v5
    v_mul_f32 v5, 0xba000000, v5
    v_lshlrev_b32 v7, 2, v3
    v_cvt_f32_u32 v152, v7
    v_mul_f32 v152, v152, v5
    v_fmamk_f32 v153, v5, 0x41800000, v152
    v_add_f32 v69, v152, v5
    v_fma_f32 v70, 2.0, v5, v152
    v_add_f32 v71, v70, v5
    v_cos_f32 v64, v152
    v_sin_f32 v68, v152
    v_cos_f32 v65, v69
    v_sin_f32 v69, v69
    v_cos_f32 v66, v70
    v_sin_f32 v70, v70
    v_cos_f32 v67, v71
    v_sin_f32 v71, v71
    v_add_f32 v77, v153, v5
    v_fma_f32 v78, 2.0, v5, v153
    v_add_f32 v79, v78, v5
    v_cos_f32 v72, v153
    v_sin_f32 v76, v153
    v_cos_f32 v73, v77
    v_sin_f32 v77, v77
    v_cos_f32 v74, v78
    v_sin_f32 v78, v78
    v_cos_f32 v75, v79
    v_sin_f32 v79, v79
    v_add_u32 v7, s12, v7
    v_cvt_f32_u32 v7, v7
    v_cvt_f32_u32 v5, v2
    v_mul_f32 v5, 0x3a000000, v5
    v_add_f32 v154, 0x3c000000, v5
    v_mul_f32 v152, v5, v7
    v_mul_f32 v153, v154, v7
    v_add_f32 v117, v152, v5
    v_fma_f32 v118, 2.0, v5, v152
    v_add_f32 v119, v118, v5
    v_cos_f32 v112, v152
    v_sin_f32 v116, v152
    v_cos_f32 v113, v117
    v_sin_f32 v117, v117
    v_cos_f32 v114, v118
    v_sin_f32 v118, v118
    v_cos_f32 v115, v119
    v_sin_f32 v119, v119
    v_add_f32 v125, v153, v154
    v_fma_f32 v126, 2.0, v154, v153
    v_add_f32 v127, v126, v154
    v_cos_f32 v120, v153
    v_sin_f32 v124, v153
    v_cos_f32 v121, v125
    v_sin_f32 v125, v125
    v_cos_f32 v122, v126
    v_sin_f32 v126, v126
    v_cos_f32 v123, v127
    v_sin_f32 v127, v127
    v_mul_u32_u24 v1, 144, v2
    v_add_u32 v1, s27, v1
    v_lshl_add_u32 v7, v3, 4, v1
    v_lshl_add_u32 v1, v3, 3, v1
    s_lshl_b32 s12, s26, 5
    v_add_u32 v1, s12, v1
    v_lshlrev_b32 v5, 8, v2
    v_lshl_add_u32 v5, v3, 4, v5
    s_lshl_b32 s12, s26, 6
    v_add_u32 v5, s12, v5
    v_add_u32 v6, 4096, v5
    v_lshlrev_b32 v2, 2, v2
    v_lshl_add_u32 v2, v3, 10, v2
    v_add_u32 v2, s12, v2
    v_add_u32 v160, 4096, v2
    v_and_b32 v3, 0x38, v0
    v_lshlrev_b32 v3, 5, v3
    v_and_b32 v152, 1, v0
    v_lshl_add_u32 v3, v152, 7, v3
    v_and_b32 v152, 6, v0
    v_lshl_add_u32 v3, v152, 4, v3
    v_add_u32 v3, s27, v3
    v_add_u32 v4, s27, v4
    s_waitcnt vmcnt(1)
    v_xor_b32 v56, s15, v44
    v_xor_b32 v57, s15, v45
    v_xor_b32 v58, s15, v46
    v_xor_b32 v59, s15, v47
    v_xor_b32 v60, s15, v52
    v_xor_b32 v61, s15, v53
    v_xor_b32 v62, s15, v54
    v_xor_b32 v63, s15, v55
    s_mov_b32 m0, s13
.adaLN_cond__spectral_gfnet__glu_gated_bilinear__prompt_kernel_pl28:
    s_nop 0
    global_load_lds_dwordx4 v156, s[16:17] sc1
    global_load_lds_dwordx4 v156, s[16:17] offset:1024 sc1
    s_waitcnt vmcnt(0)
    ds_read2st64_b32 v[158:159], v157 offset0:0 offset1:4
    s_waitcnt lgkmcnt(0)
    v_max_u32 v158, v158, v159
    v_cmp_eq_u32 vcc, -1, v158
    s_cbranch_vccnz .adaLN_cond__spectral_gfnet__glu_gated_bilinear__prompt_kernel_rt30
.adaLN_cond__spectral_gfnet__glu_gated_bilinear__prompt_kernel_ok29:
    s_barrier
    global_load_dword v104, v2, s[18:19] offset:0 sc1
    global_load_dword v105, v2, s[18:19] offset:256 sc1
    global_load_dword v106, v2, s[18:19] offset:512 sc1
    global_load_dword v107, v2, s[18:19] offset:768 sc1
    global_load_dword v108, v160, s[18:19] offset:0 sc1
    global_load_dword v109, v160, s[18:19] offset:256 sc1
    global_load_dword v110, v160, s[18:19] offset:512 sc1
    global_load_dword v111, v160, s[18:19] offset:768 sc1
    ds_read_b128 v[8:11], v3 offset:0
    ds_read_b128 v[24:27], v3 offset:4096
    ds_read_b128 v[12:15], v3 offset:16
    ds_read_b128 v[28:31], v3 offset:4112
    ds_read_b128 v[16:19], v3 offset:2048
    ds_read_b128 v[32:35], v3 offset:6144
    ds_read_b128 v[20:23], v3 offset:2064
    ds_read_b128 v[36:39], v3 offset:6160
    ds_read_b128 v[80:83], v4 offset:16384
    ds_read_b128 v[84:87], v4 offset:17408
    ds_read_b128 v[88:91], v4 offset:18432
    ds_read_b128 v[92:95], v4 offset:19456
    s_waitcnt lgkmcnt(10)
    v_mfma_f32_16x16x32_bf16 v[128:131], v[8:11], v[40:43], 0
    v_mfma_f32_16x16x32_bf16 v[132:135], v[8:11], v[44:47], 0
    v_mfma_f32_16x16x32_bf16 v[136:139], v[24:27], v[40:43], 0
    v_mfma_f32_16x16x32_bf16 v[140:143], v[24:27], v[44:47], 0
    s_waitcnt lgkmcnt(8)
    v_mfma_f32_16x16x32_bf16 v[132:135], v[12:15], v[40:43], v[132:135]
    v_mfma_f32_16x16x32_bf16 v[128:131], v[12:15], v[56:59], v[128:131]
    v_mfma_f32_16x16x32_bf16 v[140:143], v[28:31], v[40:43], v[140:143]
    v_mfma_f32_16x16x32_bf16 v[136:139], v[28:31], v[56:59], v[136:139]
    s_add_u32 m0, s34, 0
    s_nop 0
    global_load_lds_dwordx4 v165, s[32:33]
    global_load_lds_dwordx4 v165, s[32:33] offset:1024
    s_add_u32 s32, s32, 2048
    s_addc_u32 s33, s33, 0
    s_waitcnt lgkmcnt(6)
    v_mfma_f32_16x16x32_bf16 v[128:131], v[16:19], v[48:51], v[128:131]
    v_mfma_f32_16x16x32_bf16 v[132:135], v[16:19], v[52:55], v[132:135]
    v_mfma_f32_16x16x32_bf16 v[136:139], v[32:35], v[48:51], v[136:139]
    v_mfma_f32_16x16x32_bf16 v[140:143], v[32:35], v[52:55], v[140:143]
    s_waitcnt lgkmcnt(4)
    v_mfma_f32_16x16x32_bf16 v[132:135], v[20:23], v[48:51], v[132:135]
    v_mfma_f32_16x16x32_bf16 v[128:131], v[20:23], v[60:63], v[128:131]
    v_mfma_f32_16x16x32_bf16 v[140:143], v[36:39], v[48:51], v[140:143]
    v_mfma_f32_16x16x32_bf16 v[136:139], v[36:39], v[60:63], v[136:139]
    s_add_u32 m0, s34, 2048
    s_nop 0
    global_load_lds_dwordx4 v165, s[32:33]
    global_load_lds_dwordx4 v165, s[32:33] offset:1024
    s_add_u32 s32, s32, 2048
    s_addc_u32 s33, s33, 0
    s_waitcnt lgkmcnt(0)
    v_xor_b32 v96, s15, v84
    v_xor_b32 v97, s15, v85
    v_xor_b32 v98, s15, v86
    v_xor_b32 v99, s15, v87
    v_xor_b32 v100, s15, v92
    v_xor_b32 v101, s15, v93
    v_xor_b32 v102, s15, v94
    v_xor_b32 v103, s15, v95
    v_pk_mul_f32 v[152:153], v[132:133], v[68:69]
    v_pk_mul_f32 v[154:155], v[128:129], v[68:69]
    v_pk_fma_f32 v[128:129], v[128:129], v[64:65], v[152:153] neg_lo:[0,0,1] neg_hi:[0,0,1]
    v_pk_fma_f32 v[132:133], v[132:133], v[64:65], v[154:155]
    v_pk_mul_f32 v[152:153], v[134:135], v[70:71]
    v_pk_mul_f32 v[154:155], v[130:131], v[70:71]
    v_pk_fma_f32 v[130:131], v[130:131], v[66:67], v[152:153] neg_lo:[0,0,1] neg_hi:[0,0,1]
    v_pk_fma_f32 v[134:135], v[134:135], v[66:67], v[154:155]
    v_pk_mul_f32 v[152:153], v[140:141], v[76:77]
    v_pk_mul_f32 v[154:155], v[136:137], v[76:77]
    v_pk_fma_f32 v[136:137], v[136:137], v[72:73], v[152:153] neg_lo:[0,0,1] neg_hi:[0,0,1]
    v_pk_fma_f32 v[140:141], v[140:141], v[72:73], v[154:155]
    v_pk_mul_f32 v[152:153], v[142:143], v[78:79]
    v_pk_mul_f32 v[154:155], v[138:139], v[78:79]
    v_pk_fma_f32 v[138:139], v[138:139], v[74:75], v[152:153] neg_lo:[0,0,1] neg_hi:[0,0,1]
    v_pk_fma_f32 v[142:143], v[142:143], v[74:75], v[154:155]
    v_cvt_pk_bf16_f32 v144, v128, v129
    v_cvt_pk_bf16_f32 v145, v130, v131
    v_cvt_pk_bf16_f32 v148, v132, v133
    v_cvt_pk_bf16_f32 v149, v134, v135
    v_cvt_pk_bf16_f32 v146, v136, v137
    v_cvt_pk_bf16_f32 v147, v138, v139
    v_cvt_pk_bf16_f32 v150, v140, v141
    v_cvt_pk_bf16_f32 v151, v142, v143
    v_mfma_f32_16x16x32_bf16 v[128:131], v[80:83], v[144:147], 0
    v_mfma_f32_16x16x32_bf16 v[132:135], v[84:87], v[144:147], 0
    v_mfma_f32_16x16x32_bf16 v[136:139], v[88:91], v[144:147], 0
    v_mfma_f32_16x16x32_bf16 v[140:143], v[92:95], v[144:147], 0
    v_mfma_f32_16x16x32_bf16 v[128:131], v[96:99], v[148:151], v[128:131]
    v_mfma_f32_16x16x32_bf16 v[132:135], v[80:83], v[148:151], v[132:135]
    v_mfma_f32_16x16x32_bf16 v[136:139], v[100:103], v[148:151], v[136:139]
    v_mfma_f32_16x16x32_bf16 v[140:143], v[88:91], v[148:151], v[140:143]
    s_add_u32 m0, s34, 4096
    s_nop 0
    global_load_lds_dwordx4 v165, s[32:33]
    global_load_lds_dwordx4 v165, s[32:33] offset:1024
    s_add_u32 s32, s32, 2048
    s_addc_u32 s33, s33, 0
    s_waitcnt vmcnt(6)
    v_lshlrev_b32 v64, 16, v104
    v_and_b32 v68, s14, v104
    v_lshlrev_b32 v65, 16, v105
    v_and_b32 v69, s14, v105
    v_lshlrev_b32 v66, 16, v106
    v_and_b32 v70, s14, v106
    v_lshlrev_b32 v67, 16, v107
    v_and_b32 v71, s14, v107
    v_lshlrev_b32 v72, 16, v108
    v_and_b32 v76, s14, v108
    v_lshlrev_b32 v73, 16, v109
    v_and_b32 v77, s14, v109
    v_lshlrev_b32 v74, 16, v110
    v_and_b32 v78, s14, v110
    v_lshlrev_b32 v75, 16, v111
    v_and_b32 v79, s14, v111
    v_pk_mul_f32 v[152:153], v[132:133], v[68:69]
    v_pk_mul_f32 v[154:155], v[128:129], v[68:69]
    v_pk_fma_f32 v[128:129], v[128:129], v[64:65], v[152:153] neg_lo:[0,0,1] neg_hi:[0,0,1]
    v_pk_fma_f32 v[132:133], v[132:133], v[64:65], v[154:155]
    v_pk_mul_f32 v[152:153], v[134:135], v[70:71]
    v_pk_mul_f32 v[154:155], v[130:131], v[70:71]
    v_pk_fma_f32 v[130:131], v[130:131], v[66:67], v[152:153] neg_lo:[0,0,1] neg_hi:[0,0,1]
    v_pk_fma_f32 v[134:135], v[134:135], v[66:67], v[154:155]
    v_pk_mul_f32 v[152:153], v[140:141], v[76:77]
    v_pk_mul_f32 v[154:155], v[136:137], v[76:77]
    v_pk_fma_f32 v[136:137], v[136:137], v[72:73], v[152:153] neg_lo:[0,0,1] neg_hi:[0,0,1]
    v_pk_fma_f32 v[140:141], v[140:141], v[72:73], v[154:155]
    v_pk_mul_f32 v[152:153], v[142:143], v[78:79]
    v_pk_mul_f32 v[154:155], v[138:139], v[78:79]
    v_pk_fma_f32 v[138:139], v[138:139], v[74:75], v[152:153] neg_lo:[0,0,1] neg_hi:[0,0,1]
    v_pk_fma_f32 v[142:143], v[142:143], v[74:75], v[154:155]
    v_cvt_pk_bf16_f32 v144, v128, v129
    v_cvt_pk_bf16_f32 v145, v130, v131
    v_cvt_pk_bf16_f32 v148, v132, v133
    v_cvt_pk_bf16_f32 v149, v134, v135
    v_cvt_pk_bf16_f32 v146, v136, v137
    v_cvt_pk_bf16_f32 v147, v138, v139
    v_cvt_pk_bf16_f32 v150, v140, v141
    v_cvt_pk_bf16_f32 v151, v142, v143
    v_mfma_f32_16x16x32_bf16 v[128:131], v[144:147], v[80:83], 0
    v_mfma_f32_16x16x32_bf16 v[132:135], v[144:147], v[96:99], 0
    v_mfma_f32_16x16x32_bf16 v[136:139], v[144:147], v[88:91], 0
    v_mfma_f32_16x16x32_bf16 v[140:143], v[144:147], v[100:103], 0
    v_mfma_f32_16x16x32_bf16 v[128:131], v[148:151], v[84:87], v[128:131]
    v_mfma_f32_16x16x32_bf16 v[132:135], v[148:151], v[80:83], v[132:135]
    v_mfma_f32_16x16x32_bf16 v[136:139], v[148:151], v[92:95], v[136:139]
    v_mfma_f32_16x16x32_bf16 v[140:143], v[148:151], v[88:91], v[140:143]
    s_nop 5
    v_pk_mul_f32 v[152:153], v[132:133], v[116:117]
    v_pk_mul_f32 v[154:155], v[128:129], v[116:117]
    v_pk_fma_f32 v[128:129], v[128:129], v[112:113], v[152:153] neg_lo:[0,0,1] neg_hi:[0,0,1]
    v_pk_fma_f32 v[132:133], v[132:133], v[112:113], v[154:155]
    v_pk_mul_f32 v[152:153], v[134:135], v[118:119]
    v_pk_mul_f32 v[154:155], v[130:131], v[118:119]
    v_pk_fma_f32 v[130:131], v[130:131], v[114:115], v[152:153] neg_lo:[0,0,1] neg_hi:[0,0,1]
    v_pk_fma_f32 v[134:135], v[134:135], v[114:115], v[154:155]
    v_pk_mul_f32 v[152:153], v[140:141], v[124:125]
    v_pk_mul_f32 v[154:155], v[136:137], v[124:125]
    v_pk_fma_f32 v[136:137], v[136:137], v[120:121], v[152:153] neg_lo:[0,0,1] neg_hi:[0,0,1]
    v_pk_fma_f32 v[140:141], v[140:141], v[120:121], v[154:155]
    v_pk_mul_f32 v[152:153], v[142:143], v[126:127]
    v_pk_mul_f32 v[154:155], v[138:139], v[126:127]
    v_pk_fma_f32 v[138:139], v[138:139], v[122:123], v[152:153] neg_lo:[0,0,1] neg_hi:[0,0,1]
    v_pk_fma_f32 v[142:143], v[142:143], v[122:123], v[154:155]
    v_cvt_pk_bf16_f32 v144, v128, v129
    v_cvt_pk_bf16_f32 v145, v130, v131
    v_cvt_pk_bf16_f32 v148, v132, v133
    v_cvt_pk_bf16_f32 v149, v134, v135
    v_cvt_pk_bf16_f32 v146, v136, v137
    v_cvt_pk_bf16_f32 v147, v138, v139
    v_cvt_pk_bf16_f32 v150, v140, v141
    v_cvt_pk_bf16_f32 v151, v142, v143
    ds_write_b64 v1, v[144:145] offset:20480
    ds_write_b64 v1, v[146:147] offset:22784
    ds_write_b64 v1, v[148:149] offset:25088
    ds_write_b64 v1, v[150:151] offset:27392
    s_waitcnt lgkmcnt(0)
    s_barrier
    ds_read_b128 v[8:11], v7 offset:20480
    ds_read_b128 v[24:27], v7 offset:22784
    ds_read_b128 v[12:15], v7 offset:25088
    ds_read_b128 v[28:31], v7 offset:27392
    ds_read_b128 v[16:19], v7 offset:20544
    ds_read_b128 v[32:35], v7 offset:22848
    ds_read_b128 v[20:23], v7 offset:25152
    ds_read_b128 v[36:39], v7 offset:27456
    s_waitcnt lgkmcnt(6)
    v_mfma_f32_16x16x32_bf16 v[128:131], v[40:43], v[8:11], 0
    v_mfma_f32_16x16x32_bf16 v[132:135], v[56:59], v[8:11], 0
    v_mfma_f32_16x16x32_bf16 v[136:139], v[40:43], v[24:27], 0
    v_mfma_f32_16x16x32_bf16 v[140:143], v[56:59], v[24:27], 0
    s_waitcnt lgkmcnt(4)
    v_mfma_f32_16x16x32_bf16 v[128:131], v[44:47], v[12:15], v[128:131]
    v_mfma_f32_16x16x32_bf16 v[132:135], v[40:43], v[12:15], v[132:135]
    v_mfma_f32_16x16x32_bf16 v[136:139], v[44:47], v[28:31], v[136:139]
    v_mfma_f32_16x16x32_bf16 v[140:143], v[40:43], v[28:31], v[140:143]
    s_waitcnt lgkmcnt(2)
    v_mfma_f32_16x16x32_bf16 v[128:131], v[48:51], v[16:19], v[128:131]
    v_mfma_f32_16x16x32_bf16 v[132:135], v[60:63], v[16:19], v[132:135]
    v_mfma_f32_16x16x32_bf16 v[136:139], v[48:51], v[32:35], v[136:139]
    v_mfma_f32_16x16x32_bf16 v[140:143], v[60:63], v[32:35], v[140:143]
    s_waitcnt lgkmcnt(0)
    v_mfma_f32_16x16x32_bf16 v[128:131], v[52:55], v[20:23], v[128:131]
    v_mfma_f32_16x16x32_bf16 v[132:135], v[48:51], v[20:23], v[132:135]
    v_mfma_f32_16x16x32_bf16 v[136:139], v[52:55], v[36:39], v[136:139]
    v_mfma_f32_16x16x32_bf16 v[140:143], v[48:51], v[36:39], v[140:143]
    s_nop 4
    v_cvt_pk_bf16_f32 v144, v128, v129
    v_cvt_pk_bf16_f32 v145, v130, v131
    v_cvt_pk_bf16_f32 v146, v132, v133
    v_cvt_pk_bf16_f32 v147, v134, v135
    v_and_b32 v144, -2, v144
    global_store_dwordx4 v5, v[144:147], s[30:31] sc1
    v_cvt_pk_bf16_f32 v148, v136, v137
    v_cvt_pk_bf16_f32 v149, v138, v139
    v_cvt_pk_bf16_f32 v150, v140, v141
    v_cvt_pk_bf16_f32 v151, v142, v143
    v_and_b32 v148, -2, v148
    global_store_dwordx4 v6, v[148:151], s[30:31] sc1
    s_branch .adaLN_cond__spectral_gfnet__glu_gated_bilinear__prompt_kernel_join27
.adaLN_cond__spectral_gfnet__glu_gated_bilinear__prompt_kernel_pack26:
    s_barrier
    s_add_u32 m0, s34, 0
    s_nop 0
    global_load_lds_dwordx4 v165, s[32:33]
    global_load_lds_dwordx4 v165, s[32:33] offset:1024
    s_add_u32 s32, s32, 2048
    s_addc_u32 s33, s33, 0
    s_add_u32 m0, s34, 2048
    s_nop 0
    global_load_lds_dwordx4 v165, s[32:33]
    global_load_lds_dwordx4 v165, s[32:33] offset:1024
    s_add_u32 s32, s32, 2048
    s_addc_u32 s33, s33, 0
    s_add_u32 m0, s34, 4096
    s_nop 0
    global_load_lds_dwordx4 v165, s[32:33]
    global_load_lds_dwordx4 v165, s[32:33] offset:1024
    s_add_u32 s32, s32, 2048
    s_addc_u32 s33, s33, 0
    s_barrier
.adaLN_cond__spectral_gfnet__glu_gated_bilinear__prompt_kernel_join27:
    s_barrier
    v_and_b32 v63, 63, v0
    v_lshlrev_b32 v61, 4, v63
    s_mul_i32 s24, s21, 276480
    s_mul_i32 s25, s3, 30720
    s_add_u32 s24, s24, s25
    s_add_u32 s24, s24, 10532864
    s_add_u32 s50, s6, s24
    s_addc_u32 s51, s7, 0
    s_mul_i32 s34, s3, 9216
    s_add_u32 s32, s48, s34
    s_addc_u32 s33, s49, 0
    s_add_u32 m0, s34, 0
    s_nop 0
    global_load_lds_dwordx4 v61, s[32:33]
    global_load_lds_dwordx4 v61, s[32:33] offset:1024
    s_add_u32 s32, s32, 2048
    s_addc_u32 s33, s33, 0
    s_add_u32 m0, s34, 2048
    s_nop 0
    global_load_lds_dwordx4 v61, s[32:33]
    global_load_lds_dwordx4 v61, s[32:33] offset:1024
    s_add_u32 s32, s32, 2048
    s_addc_u32 s33, s33, 0
    s_add_u32 m0, s34, 4096
    s_nop 0
    global_load_lds_dwordx4 v61, s[32:33]
    global_load_lds_dwordx4 v61, s[32:33] offset:1024
    s_add_u32 s32, s32, 2048
    s_addc_u32 s33, s33, 0
    s_add_u32 m0, s34, 6144
    s_nop 0
    global_load_lds_dwordx4 v61, s[32:33]
    global_load_lds_dwordx4 v61, s[32:33] offset:1024
    global_load_lds_dwordx4 v61, s[32:33] offset:2048
    s_getpc_b64 s[8:9]
    s_add_u32 s8, s8, tab3@rel32@lo+4
    s_addc_u32 s9, s9, tab3@rel32@hi+12
    v_add_u32 v200, 320, v0
    s_mul_i32 s24, s21, 20
    s_add_u32 s24, s24, 320
    v_min_u32 v201, 499, v0
    v_add_u32 v201, s24, v201
    v_cmp_gt_u32 vcc, 480, v0
    v_lshlrev_b32 v3, 4, v0
    s_nop 0
    v_cndmask_b32 v200, v201, v200, vcc
    v_lshlrev_b32 v200, 4, v200
    v_add_u32 v200, 65536, v200
    v_add_u32 v201, 15360, v200
    v_add_u32 v202, 30720, v200
    v_add_u32 v203, 46080, v200
    global_load_dwordx4 v[204:207], v200, s[6:7] sc1
    global_load_dwordx4 v[208:211], v201, s[6:7] sc1
    global_load_dwordx4 v[212:215], v202, s[6:7] sc1
    global_load_dwordx4 v[216:219], v203, s[6:7] sc1
    s_add_u32 m0, s23, 122880
    v_subrev_u32 v200, 320, v0
    global_load_lds_dwordx4 v3, s[8:9]
    v_cmp_gt_u32 vcc, 160, v200
    v_mov_b32 v220, 0
    v_mov_b32 v221, 1.0
    v_cndmask_b32 v220, v220, v221, vcc
    s_cmp_ge_u32 s3, 4
    s_cbranch_scc1 .adaLN_cond__spectral_gfnet__glu_gated_bilinear__prompt_kernel_sk33
    v_add_u32 v3, 8192, v3
    s_add_u32 m0, s23, 131072
    s_nop 0
    global_load_lds_dwordx4 v3, s[8:9]
.adaLN_cond__spectral_gfnet__glu_gated_bilinear__prompt_kernel_sk33:
    v_lshrrev_b32 v1, 5, v63
    v_bfe_u32 v2, v63, 1, 4
    v_lshlrev_b32 v4, 1, v1
    v_xor_b32 v2, v2, v4
    v_mul_u32_u24 v4, 40, v2
    v_cmp_gt_u32 vcc, 8, v2
    s_lshl_b32 s24, s3, 1
    v_add_u32 v1, s24, v1
    v_add_u32 v58, v4, v1
    v_sub_u32 v6, 640, v58
    v_cndmask_b32 v58, v6, v58, vcc
    v_add_u32 v1, 16, v1
    v_min_u32 v1, 20, v1
    v_add_u32 v59, v4, v1
    v_sub_u32 v6, 640, v59
    v_cndmask_b32 v59, v6, v59, vcc
    v_xor_b32 v1, s3, v63
    v_and_b32 v1, 1, v1
    s_lshl_b32 s24, s20, 8
    s_lshl_b32 s25, s21, 5
    s_add_u32 s24, s24, s25
    s_add_u32 s24, s24, 4194304
    v_lshl_add_u32 v1, v1, 4, s24
    v_lshl_add_u32 v58, v58, 13, v1
    v_lshl_add_u32 v59, v59, 13, v1
    v_lshrrev_b32 v62, 4, v63
    v_and_b32 v2, 15, v63
    v_lshlrev_b32 v2, 5, v2
    v_lshl_add_u32 v2, v62, 3, v2
    s_mov_b32 s14, 0xffff0000
    v_mov_b32 v12, 0
    v_mov_b32 v13, 0
    global_load_dwordx2 v[8:9], v2, s[4:5]
    global_load_dwordx2 v[10:11], v2, s[4:5] offset:512
    s_mov_b32 exec_lo, 0x00ff00ff
    s_mov_b32 exec_hi, 0x00ff00ff
    global_load_dwordx2 v[12:13], v2, s[4:5] offset:1024
    s_mov_b64 exec, -1
    v_mov_b32 v186, 0
    v_mov_b32 v187, 0
    v_and_b32 v1, 3, v63
    v_lshlrev_b32 v4, 9, v1
    v_lshl_add_u32 v4, v62, 7, v4
    v_bfe_u32 v5, v63, 3, 1
    v_lshl_add_u32 v4, v5, 5, v4
    v_bfe_u32 v5, v63, 2, 1
    v_lshl_add_u32 v4, v5, 3, v4
    s_lshr_b32 s24, s3, 2
    v_bfe_u32 v5, v63, 1, 1
    v_xor_b32 v5, s24, v5
    v_lshl_add_u32 v4, v5, 4, v4
    v_and_b32 v5, 1, v63
    v_lshl_add_u32 v4, v5, 6, v4
    v_add_u32 v4, 139264, v4
    v_xor_b32 v5, 64, v4
    v_lshlrev_b32 v61, 4, v63
    v_add_u32 v1, 122880, v61
    v_add_u32 v60, 135168, v2
    s_waitcnt vmcnt(3)
    v_pk_add_f32 v[204:205], v[204:205], v[208:209]
    v_pk_add_f32 v[206:207], v[206:207], v[210:211]
    v_pk_add_f32 v[212:213], v[212:213], v[216:217]
    v_pk_add_f32 v[214:215], v[214:215], v[218:219]
    v_pk_add_f32 v[204:205], v[204:205], v[212:213]
    v_pk_add_f32 v[206:207], v[206:207], v[214:215]
    v_cvt_pk_bf16_f32 v208, v204, v205
    v_cvt_pk_bf16_f32 v209, v206, v207
    v_lshlrev_b32 v204, 16, v208
    v_and_b32 v205, s14, v208
    v_lshlrev_b32 v206, 16, v209
    v_and_b32 v207, s14, v209
    v_add_f32 v204, v204, v220
    v_add_f32 v205, v205, v220
    v_add_f32 v206, v206, v220
    v_add_f32 v207, v207, v220
    v_cvt_pk_bf16_f32 v204, v204, v205
    v_cvt_pk_bf16_f32 v205, v206, v207
    v_lshlrev_b32 v200, 3, v0
    v_add_u32 v201, 135168, v200
    ds_write_b64 v201, v[204:205]
    s_cmp_lg_u32 s3, 7
    s_cbranch_scc1 .adaLN_cond__spectral_gfnet__glu_gated_bilinear__prompt_kernel_sk37
    s_lshl_b32 s24, s2, 9
    s_add_u32 s24, s24, 651776
    v_add_u32 v200, s24, v200
    global_store_dwordx2 v200, v[204:205], s[6:7] sc1
.adaLN_cond__spectral_gfnet__glu_gated_bilinear__prompt_kernel_sk37:
    s_cmp_lt_u32 s2, 65
    s_cbranch_scc1 .adaLN_cond__spectral_gfnet__glu_gated_bilinear__prompt_kernel_z138
    s_sleep 16
.adaLN_cond__spectral_gfnet__glu_gated_bilinear__prompt_kernel_z138:
    s_lshl_b32 s23, s3, 10
    v_lshlrev_b32 v3, 4, v0
    v_add_u32 v3, 139264, v3
    v_mov_b32 v57, 0
.adaLN_cond__spectral_gfnet__glu_gated_bilinear__prompt_kernel_pl34:
    s_add_u32 m0, s23, 139264
    s_cmp_ge_u32 s3, 4
    global_load_lds_dwordx4 v58, s[6:7] sc1
    s_cbranch_scc1 .adaLN_cond__spectral_gfnet__glu_gated_bilinear__prompt_kernel_skip31
    s_add_u32 m0, s23, 147456
    s_nop 0
    global_load_lds_dwordx4 v59, s[6:7] sc1
    s_waitcnt vmcnt(0)
    ds_read_b32 v57, v3 offset:8192
.adaLN_cond__spectral_gfnet__glu_gated_bilinear__prompt_kernel_skip31:
    s_waitcnt vmcnt(0)
    ds_read_b32 v56, v3
    s_waitcnt lgkmcnt(0)
    v_or_b32 v56, v56, v57
    v_and_b32 v56, 1, v56
    v_cmp_eq_u32 vcc, 1, v56
    s_cbranch_vccnz .adaLN_cond__spectral_gfnet__glu_gated_bilinear__prompt_kernel_rt36
.adaLN_cond__spectral_gfnet__glu_gated_bilinear__prompt_kernel_ok35:
    s_barrier
    ds_read_b128 v[64:67], v1 offset:0
    ds_read_b128 v[68:71], v1 offset:1024
    ds_read_b64_tr_b16 v[108:109], v4 offset:0
    ds_read_b64_tr_b16 v[110:111], v5 offset:0
    ds_read_b64_tr_b16 v[112:113], v4 offset:2048
    ds_read_b64_tr_b16 v[114:115], v5 offset:2048
    ds_read_b64_tr_b16 v[116:117], v4 offset:4096
    ds_read_b64_tr_b16 v[118:119], v5 offset:4096
    ds_read_b64_tr_b16 v[120:121], v4 offset:6144
    ds_read_b64_tr_b16 v[122:123], v5 offset:6144
    ds_read_b64_tr_b16 v[124:125], v4 offset:8192
    ds_read_b64_tr_b16 v[126:127], v5 offset:8192
    ds_read_b64_tr_b16 v[128:129], v4 offset:10240
    ds_read_b64_tr_b16 v[130:131], v5 offset:10240
    s_cmp_lt_u32 s3, 4
    s_cbranch_scc1 .adaLN_cond__spectral_gfnet__glu_gated_bilinear__prompt_kernel_we39
    global_load_dwordx4 v[200:203], v61, s[50:51] offset:0
    global_load_dwordx4 v[204:207], v61, s[50:51] offset:1024
    s_add_u32 s50, s50, 2048
    s_addc_u32 s51, s51, 0
.adaLN_cond__spectral_gfnet__glu_gated_bilinear__prompt_kernel_we39:
    s_waitcnt lgkmcnt(10)
    v_mfma_f32_16x16x32_bf16 v[132:135], v[108:111], v[64:67], 0
    v_mfma_f32_16x16x32_bf16 v[136:139], v[108:111], v[68:71], 0
    s_waitcnt lgkmcnt(8)
    v_mfma_f32_16x16x32_bf16 v[140:143], v[112:115], v[64:67], 0
    v_mfma_f32_16x16x32_bf16 v[144:147], v[112:115], v[68:71], 0
    s_waitcnt lgkmcnt(6)
    v_mfma_f32_16x16x32_bf16 v[148:151], v[116:119], v[64:67], 0
    v_mfma_f32_16x16x32_bf16 v[152:155], v[116:119], v[68:71], 0
    s_waitcnt lgkmcnt(4)
    v_mfma_f32_16x16x32_bf16 v[156:159], v[120:123], v[64:67], 0
    v_mfma_f32_16x16x32_bf16 v[160:163], v[120:123], v[68:71], 0
    s_waitcnt lgkmcnt(2)
    v_mfma_f32_16x16x32_bf16 v[164:167], v[124:127], v[64:67], 0
    v_mfma_f32_16x16x32_bf16 v[168:171], v[124:127], v[68:71], 0
    s_waitcnt lgkmcnt(0)
    v_mfma_f32_16x16x32_bf16 v[172:175], v[128:131], v[64:67], 0
    v_mfma_f32_16x16x32_bf16 v[176:179], v[128:131], v[68:71], 0
    ds_read_b128 v[72:75], v1 offset:2048
    ds_read_b128 v[76:79], v1 offset:3072
    ds_read_b128 v[80:83], v1 offset:4096
    ds_read_b128 v[84:87], v1 offset:5120
    ds_read_b128 v[88:91], v1 offset:6144
    ds_read_b128 v[92:95], v1 offset:7168
    ds_read_b128 v[96:99], v1 offset:8192
    ds_read_b128 v[100:103], v1 offset:9216
    ds_read_b128 v[104:107], v1 offset:10240
    ds_read_b64 v[14:15], v60 offset:0
    ds_read_b64 v[16:17], v60 offset:512
    ds_read_b64 v[18:19], v60 offset:1024
    s_cmp_lt_u32 s3, 4
    s_cbranch_scc1 .adaLN_cond__spectral_gfnet__glu_gated_bilinear__prompt_kernel_we40
    global_load_dwordx4 v[208:211], v61, s[50:51] offset:0
    global_load_dwordx4 v[212:215], v61, s[50:51] offset:1024
    s_add_u32 s50, s50, 2048
    s_addc_u32 s51, s51, 0
.adaLN_cond__spectral_gfnet__glu_gated_bilinear__prompt_kernel_we40:
    s_and_b32 s24, s3, 3
    s_waitcnt lgkmcnt(9)
    s_cmp_eq_u32 s24, 1
    s_cbranch_scc1 .adaLN_cond__spectral_gfnet__glu_gated_bilinear__prompt_kernel_r42
    s_cmp_eq_u32 s24, 2
    s_cbranch_scc1 .adaLN_cond__spectral_gfnet__glu_gated_bilinear__prompt_kernel_r43
    s_cmp_eq_u32 s24, 3
    s_cbranch_scc1 .adaLN_cond__spectral_gfnet__glu_gated_bilinear__prompt_kernel_r44
.adaLN_cond__spectral_gfnet__glu_gated_bilinear__prompt_kernel_r41:
    v_mul_f32 v44, v132, v72
    v_mul_f32 v45, v132, v76
    v_fma_f32 v44, -v136, v76, v44
    v_fmac_f32 v45, v136, v72
    v_mul_f32 v46, v140, v73
    v_mul_f32 v47, v140, v77
    v_fma_f32 v46, -v144, v77, v46
    v_fmac_f32 v47, v144, v73
    v_mul_f32 v48, v148, v74
    v_mul_f32 v49, v148, v78
    v_fma_f32 v48, -v152, v78, v48
    v_fmac_f32 v49, v152, v74
    v_mul_f32 v50, v156, v75
    v_mul_f32 v51, v156, v79
    v_fma_f32 v50, -v160, v79, v50
    v_fmac_f32 v51, v160, v75
    v_mul_f32 v52, v164, v80
    v_mul_f32 v53, v164, v82
    v_fma_f32 v52, -v168, v82, v52
    v_fmac_f32 v53, v168, v80
    v_mul_f32 v54, v172, v81
    v_mul_f32 v55, v172, v83
    v_fma_f32 v54, -v176, v83, v54
    v_fmac_f32 v55, v176, v81
    s_branch .adaLN_cond__spectral_gfnet__glu_gated_bilinear__prompt_kernel_join45
.adaLN_cond__spectral_gfnet__glu_gated_bilinear__prompt_kernel_r42:
    v_mul_f32 v44, v133, v72
    v_mul_f32 v45, v133, v76
    v_fma_f32 v44, -v137, v76, v44
    v_fmac_f32 v45, v137, v72
    v_mul_f32 v46, v141, v73
    v_mul_f32 v47, v141, v77
    v_fma_f32 v46, -v145, v77, v46
    v_fmac_f32 v47, v145, v73
    v_mul_f32 v48, v149, v74
    v_mul_f32 v49, v149, v78
    v_fma_f32 v48, -v153, v78, v48
    v_fmac_f32 v49, v153, v74
    v_mul_f32 v50, v157, v75
    v_mul_f32 v51, v157, v79
    v_fma_f32 v50, -v161, v79, v50
    v_fmac_f32 v51, v161, v75
    v_mul_f32 v52, v165, v80
    v_mul_f32 v53, v165, v82
    v_fma_f32 v52, -v169, v82, v52
    v_fmac_f32 v53, v169, v80
    v_mul_f32 v54, v173, v81
    v_mul_f32 v55, v173, v83
    v_fma_f32 v54, -v177, v83, v54
    v_fmac_f32 v55, v177, v81
    s_branch .adaLN_cond__spectral_gfnet__glu_gated_bilinear__prompt_kernel_join45
.adaLN_cond__spectral_gfnet__glu_gated_bilinear__prompt_kernel_r43:
    v_mul_f32 v44, v134, v72
    v_mul_f32 v45, v134, v76
    v_fma_f32 v44, -v138, v76, v44
    v_fmac_f32 v45, v138, v72
    v_mul_f32 v46, v142, v73
    v_mul_f32 v47, v142, v77
    v_fma_f32 v46, -v146, v77, v46
    v_fmac_f32 v47, v146, v73
    v_mul_f32 v48, v150, v74
    v_mul_f32 v49, v150, v78
    v_fma_f32 v48, -v154, v78, v48
    v_fmac_f32 v49, v154, v74
    v_mul_f32 v50, v158, v75
    v_mul_f32 v51, v158, v79
    v_fma_f32 v50, -v162, v79, v50
    v_fmac_f32 v51, v162, v75
    v_mul_f32 v52, v166, v80
    v_mul_f32 v53, v166, v82
    v_fma_f32 v52, -v170, v82, v52
    v_fmac_f32 v53, v170, v80
    v_mul_f32 v54, v174, v81
    v_mul_f32 v55, v174, v83
    v_fma_f32 v54, -v178, v83, v54
    v_fmac_f32 v55, v178, v81
    s_branch .adaLN_cond__spectral_gfnet__glu_gated_bilinear__prompt_kernel_join45
.adaLN_cond__spectral_gfnet__glu_gated_bilinear__prompt_kernel_r44:
    v_mul_f32 v44, v135, v72
    v_mul_f32 v45, v135, v76
    v_fma_f32 v44, -v139, v76, v44
    v_fmac_f32 v45, v139, v72
    v_mul_f32 v46, v143, v73
    v_mul_f32 v47, v143, v77
    v_fma_f32 v46, -v147, v77, v46
    v_fmac_f32 v47, v147, v73
    v_mul_f32 v48, v151, v74
    v_mul_f32 v49, v151, v78
    v_fma_f32 v48, -v155, v78, v48
    v_fmac_f32 v49, v155, v74
    v_mul_f32 v50, v159, v75
    v_mul_f32 v51, v159, v79
    v_fma_f32 v50, -v163, v79, v50
    v_fmac_f32 v51, v163, v75
    v_mul_f32 v52, v167, v80
    v_mul_f32 v53, v167, v82
    v_fma_f32 v52, -v171, v82, v52
    v_fmac_f32 v53, v171, v80
    v_mul_f32 v54, v175, v81
    v_mul_f32 v55, v175, v83
    v_fma_f32 v54, -v179, v83, v54
    v_fmac_f32 v55, v179, v81
.adaLN_cond__spectral_gfnet__glu_gated_bilinear__prompt_kernel_join45:
    v_cvt_pk_bf16_f32 v180, v44, v45
    v_cvt_pk_bf16_f32 v181, v46, v47
    v_cvt_pk_bf16_f32 v182, v48, v49
    v_cvt_pk_bf16_f32 v183, v50, v51
    v_cvt_pk_bf16_f32 v184, v52, v53
    v_cvt_pk_bf16_f32 v185, v54, v55
    s_waitcnt lgkmcnt(3)
    v_mfma_f32_16x16x32_bf16 v[188:191], v[180:183], v[84:87], 0
    v_mfma_f32_16x16x32_bf16 v[192:195], v[180:183], v[92:95], 0
    v_mfma_f32_16x16x32_bf16 v[196:199], v[180:183], v[100:103], 0
    v_mfma_f32_16x16x32_bf16 v[188:191], v[184:187], v[88:91], v[188:191]
    v_mfma_f32_16x16x32_bf16 v[192:195], v[184:187], v[96:99], v[192:195]
    v_mfma_f32_16x16x32_bf16 v[196:199], v[184:187], v[104:107], v[196:199]
    ds_read_b64 v[20:21], v60 offset:1280
    ds_read_b64 v[22:23], v60 offset:1792
    ds_read_b64 v[24:25], v60 offset:2304
    ds_read_b64 v[26:27], v60 offset:2560
    ds_read_b64 v[28:29], v60 offset:3072
    ds_read_b64 v[30:31], v60 offset:3584
    s_cmp_lt_u32 s3, 4
    s_cbranch_scc1 .adaLN_cond__spectral_gfnet__glu_gated_bilinear__prompt_kernel_we46
    global_load_dwordx4 v[216:219], v61, s[50:51] offset:0
    global_load_dwordx4 v[220:223], v61, s[50:51] offset:1024
    s_add_u32 s50, s50, 2048
    s_addc_u32 s51, s51, 0
.adaLN_cond__spectral_gfnet__glu_gated_bilinear__prompt_kernel_we46:
    s_waitcnt lgkmcnt(6)
    v_lshlrev_b32 v32, 16, v8
    v_and_b32 v33, s14, v8
    v_lshlrev_b32 v34, 16, v9
    v_and_b32 v35, s14, v9
    v_lshlrev_b32 v36, 16, v10
    v_and_b32 v37, s14, v10
    v_lshlrev_b32 v38, 16, v11
    v_and_b32 v39, s14, v11
    v_lshlrev_b32 v40, 16, v12
    v_and_b32 v41, s14, v12
    v_lshlrev_b32 v42, 16, v13
    v_and_b32 v43, s14, v13
    v_lshlrev_b32 v156, 16, v14
    v_and_b32 v157, s14, v14
    v_lshlrev_b32 v158, 16, v15
    v_and_b32 v159, s14, v15
    v_lshlrev_b32 v160, 16, v16
    v_and_b32 v161, s14, v16
    v_lshlrev_b32 v162, 16, v17
    v_and_b32 v163, s14, v17
    v_lshlrev_b32 v164, 16, v18
    v_and_b32 v165, s14, v18
    v_lshlrev_b32 v166, 16, v19
    v_and_b32 v167, s14, v19
    v_pk_fma_f32 v[32:33], v[188:189], v[156:157], v[32:33]
    v_pk_fma_f32 v[34:35], v[190:191], v[158:159], v[34:35]
    v_pk_fma_f32 v[36:37], v[192:193], v[160:161], v[36:37]
    v_pk_fma_f32 v[38:39], v[194:195], v[162:163], v[38:39]
    v_pk_fma_f32 v[40:41], v[196:197], v[164:165], v[40:41]
    v_pk_fma_f32 v[42:43], v[198:199], v[166:167], v[42:43]
    v_cvt_pk_bf16_f32 v168, v32, v33
    v_cvt_pk_bf16_f32 v169, v34, v35
    v_cvt_pk_bf16_f32 v170, v36, v37
    v_cvt_pk_bf16_f32 v171, v38, v39
    v_cvt_pk_bf16_f32 v172, v40, v41
    v_cvt_pk_bf16_f32 v173, v42, v43
    v_lshlrev_b32 v32, 16, v168
    v_and_b32 v33, s14, v168
    v_lshlrev_b32 v34, 16, v169
    v_and_b32 v35, s14, v169
    v_lshlrev_b32 v36, 16, v170
    v_and_b32 v37, s14, v170
    v_lshlrev_b32 v38, 16, v171
    v_and_b32 v39, s14, v171
    v_lshlrev_b32 v40, 16, v172
    v_and_b32 v41, s14, v172
    v_lshlrev_b32 v42, 16, v173
    v_and_b32 v43, s14, v173
    s_lshl_b32 s25, s20, 6
    s_add_u32 s25, s25, s22
    s_mul_i32 s25, s25, 1280
    s_add_u32 s25, s25, 7340032
    s_add_u32 s12, s6, s25
    s_addc_u32 s13, s7, 0
    global_store_dwordx2 v2, v[168:169], s[12:13] sc1
    global_store_dwordx2 v2, v[170:171], s[12:13] offset:512 sc1
    s_mov_b32 exec_lo, 0x00ff00ff
    s_mov_b32 exec_hi, 0x00ff00ff
    global_store_dwordx2 v2, v[172:173], s[12:13] offset:1024 sc1
    s_mov_b64 exec, -1
    s_cmp_lt_u32 s3, 4
    s_cbranch_scc1 .adaLN_cond__spectral_gfnet__glu_gated_bilinear__prompt_kernel_we47
    global_load_dwordx4 v[224:227], v61, s[50:51] offset:0
    global_load_dwordx4 v[228:231], v61, s[50:51] offset:1024
    s_add_u32 s50, s50, 2048
    s_addc_u32 s51, s51, 0
.adaLN_cond__spectral_gfnet__glu_gated_bilinear__prompt_kernel_we47:
    v_pk_add_f32 v[44:45], v[32:33], v[34:35]
    v_pk_add_f32 v[44:45], v[44:45], v[36:37]
    v_pk_add_f32 v[44:45], v[44:45], v[38:39]
    v_pk_add_f32 v[44:45], v[44:45], v[40:41]
    v_pk_add_f32 v[44:45], v[44:45], v[42:43]
    v_add_f32 v176, v44, v45
    s_nop 1
    v_add_f32_dpp v176, v176, v176 quad_perm:[1,0,3,2] row_mask:0xf bank_mask:0xf
    s_nop 1
    v_add_f32_dpp v176, v176, v176 quad_perm:[2,3,0,1] row_mask:0xf bank_mask:0xf
    s_nop 1
    v_add_f32_dpp v176, v176, v176 row_ror:4 row_mask:0xf bank_mask:0xf
    s_nop 1
    v_add_f32_dpp v176, v176, v176 row_ror:8 row_mask:0xf bank_mask:0xf
    v_mov_b32 v177, v176
    s_nop 1
    v_permlane16_swap_b32 v176, v177
    v_add_f32 v176, v176, v177
    v_mov_b32 v177, v176
    s_nop 1
    v_permlane32_swap_b32 v176, v177
    v_add_f32 v176, v176, v177
    v_mul_f32 v176, 0x3acccccd, v176
    s_cmp_lt_u32 s3, 4
    s_cbranch_scc1 .adaLN_cond__spectral_gfnet__glu_gated_bilinear__prompt_kernel_we48
    global_load_dwordx4 v[232:235], v61, s[50:51] offset:0
    global_load_dwordx4 v[236:239], v61, s[50:51] offset:1024
    s_add_u32 s50, s50, 2048
    s_addc_u32 s51, s51, 0
.adaLN_cond__spectral_gfnet__glu_gated_bilinear__prompt_kernel_we48:
    v_pk_add_f32 v[44:45], v[32:33], v[176:177] op_sel_hi:[1,0] neg_lo:[0,1] neg_hi:[0,1]
    v_pk_add_f32 v[46:47], v[34:35], v[176:177] op_sel_hi:[1,0] neg_lo:[0,1] neg_hi:[0,1]
    v_pk_add_f32 v[48:49], v[36:37], v[176:177] op_sel_hi:[1,0] neg_lo:[0,1] neg_hi:[0,1]
    v_pk_add_f32 v[50:51], v[38:39], v[176:177] op_sel_hi:[1,0] neg_lo:[0,1] neg_hi:[0,1]
    v_pk_add_f32 v[52:53], v[40:41], v[176:177] op_sel_hi:[1,0] neg_lo:[0,1] neg_hi:[0,1]
    v_pk_add_f32 v[54:55], v[42:43], v[176:177] op_sel_hi:[1,0] neg_lo:[0,1] neg_hi:[0,1]
    v_pk_mul_f32 v[44:45], v[44:45], v[44:45]
    v_pk_fma_f32 v[44:45], v[46:47], v[46:47], v[44:45]
    v_pk_fma_f32 v[44:45], v[48:49], v[48:49], v[44:45]
    v_pk_fma_f32 v[44:45], v[50:51], v[50:51], v[44:45]
    s_mov_b32 exec_lo, 0x00ff00ff
    s_mov_b32 exec_hi, 0x00ff00ff
    v_pk_fma_f32 v[44:45], v[52:53], v[52:53], v[44:45]
    v_pk_fma_f32 v[44:45], v[54:55], v[54:55], v[44:45]
    s_mov_b64 exec, -1
    v_add_f32 v178, v44, v45
    s_nop 1
    v_add_f32_dpp v178, v178, v178 quad_perm:[1,0,3,2] row_mask:0xf bank_mask:0xf
    s_nop 1
    v_add_f32_dpp v178, v178, v178 quad_perm:[2,3,0,1] row_mask:0xf bank_mask:0xf
    s_nop 1
    v_add_f32_dpp v178, v178, v178 row_ror:4 row_mask:0xf bank_mask:0xf
    s_nop 1
    v_add_f32_dpp v178, v178, v178 row_ror:8 row_mask:0xf bank_mask:0xf
    v_mov_b32 v179, v178
    s_nop 1
    v_permlane16_swap_b32 v178, v179
    v_add_f32 v178, v178, v179
    v_mov_b32 v179, v178
    s_nop 1
    v_permlane32_swap_b32 v178, v179
    v_add_f32 v178, v178, v179
    v_mul_f32 v178, 0x3acccccd, v178
    v_cvt_pk_bf16_f32 v176, v176, v178
    v_and_b32 v178, s14, v176
    v_lshlrev_b32 v176, 16, v176
    v_add_f32 v178, 0x3727c5ac, v178
    v_cvt_pk_bf16_f32 v178, v178, v178
    v_lshlrev_b32 v178, 16, v178
    v_sqrt_f32 v178, v178
    s_nop 0
    v_cvt_pk_bf16_f32 v178, v178, v178
    v_lshlrev_b32 v178, 16, v178
    v_rcp_f32 v178, v178
    s_waitcnt lgkmcnt(0)
    s_cmp_lt_u32 s3, 4
    s_cbranch_scc1 .adaLN_cond__spectral_gfnet__glu_gated_bilinear__prompt_kernel_we49
    global_load_dwordx4 v[240:243], v61, s[50:51] offset:0
    global_load_dwordx4 v[244:247], v61, s[50:51] offset:1024
    s_add_u32 s50, s50, 2048
    s_addc_u32 s51, s51, 0
.adaLN_cond__spectral_gfnet__glu_gated_bilinear__prompt_kernel_we49:
    v_lshlrev_b32 v144, 16, v20
    v_and_b32 v145, s14, v20
    v_lshlrev_b32 v146, 16, v21
    v_and_b32 v147, s14, v21
    v_lshlrev_b32 v148, 16, v22
    v_and_b32 v149, s14, v22
    v_lshlrev_b32 v150, 16, v23
    v_and_b32 v151, s14, v23
    v_lshlrev_b32 v152, 16, v24
    v_and_b32 v153, s14, v24
    v_lshlrev_b32 v154, 16, v25
    v_and_b32 v155, s14, v25
    v_lshlrev_b32 v132, 16, v26
    v_and_b32 v133, s14, v26
    v_lshlrev_b32 v134, 16, v27
    v_and_b32 v135, s14, v27
    v_lshlrev_b32 v136, 16, v28
    v_and_b32 v137, s14, v28
    v_lshlrev_b32 v138, 16, v29
    v_and_b32 v139, s14, v29
    v_lshlrev_b32 v140, 16, v30
    v_and_b32 v141, s14, v30
    v_lshlrev_b32 v142, 16, v31
    v_and_b32 v143, s14, v31
    s_cmp_lt_u32 s3, 4
    s_cbranch_scc1 .adaLN_cond__spectral_gfnet__glu_gated_bilinear__prompt_kernel_we50
    global_load_dwordx4 v[248:251], v61, s[50:51] offset:0
    global_load_dwordx4 v[252:255], v61, s[50:51] offset:1024
    s_add_u32 s50, s50, 2048
    s_addc_u32 s51, s51, 0
.adaLN_cond__spectral_gfnet__glu_gated_bilinear__prompt_kernel_we50:
    v_pk_add_f32 v[44:45], v[32:33], v[176:177] op_sel_hi:[1,0] neg_lo:[0,1] neg_hi:[0,1]
    v_pk_add_f32 v[46:47], v[34:35], v[176:177] op_sel_hi:[1,0] neg_lo:[0,1] neg_hi:[0,1]
    v_pk_add_f32 v[48:49], v[36:37], v[176:177] op_sel_hi:[1,0] neg_lo:[0,1] neg_hi:[0,1]
    v_pk_add_f32 v[50:51], v[38:39], v[176:177] op_sel_hi:[1,0] neg_lo:[0,1] neg_hi:[0,1]
    v_pk_add_f32 v[52:53], v[40:41], v[176:177] op_sel_hi:[1,0] neg_lo:[0,1] neg_hi:[0,1]
    v_pk_add_f32 v[54:55], v[42:43], v[176:177] op_sel_hi:[1,0] neg_lo:[0,1] neg_hi:[0,1]
    v_pk_mul_f32 v[44:45], v[44:45], v[178:179] op_sel_hi:[1,0]
    v_pk_mul_f32 v[46:47], v[46:47], v[178:179] op_sel_hi:[1,0]
    v_pk_mul_f32 v[48:49], v[48:49], v[178:179] op_sel_hi:[1,0]
    v_pk_mul_f32 v[50:51], v[50:51], v[178:179] op_sel_hi:[1,0]
    v_pk_mul_f32 v[52:53], v[52:53], v[178:179] op_sel_hi:[1,0]
    v_pk_mul_f32 v[54:55], v[54:55], v[178:179] op_sel_hi:[1,0]
    v_pk_fma_f32 v[44:45], v[44:45], v[132:133], v[144:145]
    v_pk_fma_f32 v[46:47], v[46:47], v[134:135], v[146:147]
    v_pk_fma_f32 v[48:49], v[48:49], v[136:137], v[148:149]
    v_pk_fma_f32 v[50:51], v[50:51], v[138:139], v[150:151]
    v_pk_fma_f32 v[52:53], v[52:53], v[140:141], v[152:153]
    v_pk_fma_f32 v[54:55], v[54:55], v[142:143], v[154:155]
    v_cvt_pk_bf16_f32 v14, v44, v45
    v_cvt_pk_bf16_f32 v15, v46, v47
    v_cvt_pk_bf16_f32 v16, v48, v49
    v_cvt_pk_bf16_f32 v17, v50, v51
    v_cvt_pk_bf16_f32 v18, v52, v53
    v_cvt_pk_bf16_f32 v19, v54, v55
    s_mul_i32 s24, s3, 1312
    s_add_u32 s24, s24, 151552
    v_add_u32 v1, s24, v2
    ds_write_b64 v1, v[14:15]
    ds_write_b64 v1, v[16:17] offset:512
    s_mov_b32 exec_lo, 0x00ff00ff
    s_mov_b32 exec_hi, 0x00ff00ff
    ds_write_b64 v1, v[18:19] offset:1024
    s_mov_b64 exec, -1
    v_and_b32 v3, 7, v0
    v_lshrrev_b32 v4, 3, v0
    v_mul_u32_u24 v5, 1312, v3
    v_lshl_add_u32 v5, v4, 4, v5
    v_add_u32 v5, 151552, v5
    v_lshlrev_b32 v6, 8, v4
    v_lshl_add_u32 v6, v3, 4, v6
    s_lshl_b32 s24, s20, 2
    s_lshr_b32 s25, s21, 1
    s_add_u32 s24, s24, s25
    s_mul_i32 s24, s24, 20480
    s_and_b32 s25, s21, 1
    s_lshl_b32 s25, s25, 7
    s_add_u32 s24, s24, s25
    s_add_u32 s24, s24, 1048576
    s_add_u32 s12, s6, s24
    s_addc_u32 s13, s7, 0
    v_add_u32 v7, 16384, v6
    s_waitcnt vmcnt(0) lgkmcnt(0)
    s_barrier
    ds_read_b128 v[8:11], v5
    s_cmp_ge_u32 s3, 2
    s_cbranch_scc1 .adaLN_cond__spectral_gfnet__glu_gated_bilinear__prompt_kernel_st51
    ds_read_b128 v[12:15], v5 offset:1024
    s_waitcnt lgkmcnt(0)
    v_and_b32 v12, -2, v12
    global_store_dwordx4 v7, v[12:15], s[12:13] sc1
.adaLN_cond__spectral_gfnet__glu_gated_bilinear__prompt_kernel_st51:
    s_waitcnt lgkmcnt(0)
    v_and_b32 v8, -2, v8
    global_store_dwordx4 v6, v[8:11], s[12:13] sc1
    s_barrier
    s_cmp_gt_u32 s3, 3
    s_cbranch_scc1 .adaLN_cond__spectral_gfnet__glu_gated_bilinear__prompt_kernel_loader32
    s_setprio 1
    v_mov_b32 v1, v61
    v_add_u32 v2, 65536, v61
    v_add_u32 v3, 131072, v61
    s_lshl_b32 s23, s36, 3
    s_lshl_b32 s24, s3, 1
    s_add_u32 s23, s23, s24
    s_mul_i32 s27, s23, 20480
    s_add_u32 s27, s27, 1050624
    s_add_u32 s50, s6, s27
    s_addc_u32 s51, s7, 0
    s_and_b32 s38, s37, 3
    s_mov_b32 s42, 0
    s_mul_i32 s27, s23, 55296
    s_lshl_b32 s24, s37, 10
    s_add_u32 s27, s27, s24
    s_add_u32 s27, s27, 17825792
    s_add_u32 s16, s6, s27
    s_addc_u32 s17, s7, 0
    s_add_u32 s18, s16, 55296
    s_addc_u32 s19, s17, 0
    s_lshr_b32 s24, s37, 3
    s_lshl_b32 s20, s36, 1
    s_add_u32 s20, s20, s24
    s_and_b32 s24, s3, 1
    s_lshl_b32 s24, s24, 1
    s_lshr_b32 s25, s3, 1
    s_add_u32 s26, s24, s25
    s_lshl_b32 s23, s20, 2
    s_add_u32 s23, s23, s26
    s_lshl_b32 s28, s25, 10
    s_add_u32 s28, s28, 17829888
    s_mul_i32 s27, s23, 55296
    s_add_u32 s27, s27, s28
    s_add_u32 s52, s6, s27
    s_addc_u32 s53, s7, 0
    s_xor_b32 s27, s23, 1
    s_mul_i32 s27, s27, 55296
    s_add_u32 s27, s27, s28
    s_add_u32 s54, s6, s27
    s_addc_u32 s55, s7, 0
    s_sub_u32 s43, s16, s6
    s_sub_u32 s43, 24903680, s43
    s_lshl_b32 s24, s37, 10
    s_cmp_eq_u32 s37, 15
    s_cselect_b32 s43, s43, s24
    s_lshl_b32 s29, s37, 9
    s_sub_u32 s29, 47104, s29
    s_mul_i32 s24, s3, 10240
    s_add_u32 s24, s24, 122880
    s_add_u32 s8, s48, s24
    s_addc_u32 s9, s49, 0
    s_add_u32 m0, s24, 0
    s_nop 0
    global_load_lds_dwordx4 v1, s[8:9] offset:0
    global_load_lds_dwordx4 v1, s[8:9] offset:1024
    global_load_lds_dwordx4 v1, s[8:9] offset:2048
    global_load_lds_dwordx4 v1, s[8:9] offset:3072
    s_add_u32 s8, s8, 4096
    s_addc_u32 s9, s9, 0
    s_add_u32 m0, s24, 4096
    s_nop 0
    global_load_lds_dwordx4 v1, s[8:9] offset:0
    global_load_lds_dwordx4 v1, s[8:9] offset:1024
    global_load_lds_dwordx4 v1, s[8:9] offset:2048
    global_load_lds_dwordx4 v1, s[8:9] offset:3072
    s_add_u32 s8, s8, 4096
    s_addc_u32 s9, s9, 0
    s_add_u32 m0, s24, 8192
    s_nop 0
    global_load_lds_dwordx4 v1, s[8:9] offset:0
    global_load_lds_dwordx4 v1, s[8:9] offset:1024
    ds_read_b128 v[4:7], v1 offset:0
    ds_read_b128 v[8:11], v1 offset:1024
    ds_read_b128 v[12:15], v1 offset:2048
    ds_read_b128 v[16:19], v1 offset:3072
    ds_read_b128 v[20:23], v1 offset:4096
    ds_read_b128 v[24:27], v1 offset:5120
.adaLN_cond__spectral_gfnet__glu_gated_bilinear__prompt_kernel_pl52:
    s_mul_i32 s35, s38, 5120
    s_add_u32 s10, s50, s35
    s_addc_u32 s11, s51, 0
    s_add_u32 s12, s10, 20480
    s_addc_u32 s13, s11, 0
    global_load_dwordx4 v[96:99], v1, s[10:11] offset:-2048 sc1
    global_load_dwordx4 v[100:103], v1, s[12:13] offset:-2048 sc1
    global_load_dwordx4 v[104:107], v1, s[10:11] offset:-1024 sc1
    global_load_dwordx4 v[108:111], v1, s[12:13] offset:-1024 sc1
    global_load_dwordx4 v[112:115], v1, s[10:11] offset:0 sc1
    global_load_dwordx4 v[116:119], v1, s[12:13] offset:0 sc1
    global_load_dwordx4 v[120:123], v1, s[10:11] offset:1024 sc1
    global_load_dwordx4 v[124:127], v1, s[12:13] offset:1024 sc1
    global_load_dwordx4 v[128:131], v1, s[10:11] offset:2048 sc1
    global_load_dwordx4 v[132:135], v1, s[12:13] offset:2048 sc1
    s_add_u32 s35, s35, 5120
    s_cmp_eq_u32 s35, 20480
    s_cselect_b32 s35, 0, s35
    s_add_u32 s10, s50, s35
    s_addc_u32 s11, s51, 0
    s_add_u32 s12, s10, 20480
    s_addc_u32 s13, s11, 0
    global_load_dwordx4 v[136:139], v1, s[10:11] offset:-2048 sc1
    global_load_dwordx4 v[140:143], v1, s[12:13] offset:-2048 sc1
    global_load_dwordx4 v[144:147], v1, s[10:11] offset:-1024 sc1
    global_load_dwordx4 v[148:151], v1, s[12:13] offset:-1024 sc1
    s_waitcnt vmcnt(12)
    v_bitop3_b32 v0, v96, v100, 1 bitop3:0xa8
    v_cmp_eq_u32 vcc, 1, v0
    s_cbranch_vccnz .adaLN_cond__spectral_gfnet__glu_gated_bilinear__prompt_kernel_pr54
.adaLN_cond__spectral_gfnet__glu_gated_bilinear__prompt_kernel_pok53:
    s_waitcnt lgkmcnt(5)
    v_mfma_f32_16x16x32_bf16 v[32:35], v[4:7], v[96:99], 0
    ds_read_b128 v[28:31], v1 offset:6144
    v_mfma_f32_16x16x32_bf16 v[36:39], v[4:7], v[100:103], 0
    s_waitcnt lgkmcnt(5)
    v_mfma_f32_16x16x32_bf16 v[64:67], v[8:11], v[96:99], 0
    ds_read_b128 v[4:7], v1 offset:7168
    v_mfma_f32_16x16x32_bf16 v[68:71], v[8:11], v[100:103], 0
    global_load_dwordx4 v[152:155], v1, s[10:11] offset:0 sc1
    global_load_dwordx4 v[156:159], v1, s[12:13] offset:0 sc1
    s_waitcnt lgkmcnt(5)
    v_mfma_f32_16x16x32_bf16 v[40:43], v[12:15], v[96:99], 0
    ds_read_b128 v[8:11], v1 offset:8192
    v_mfma_f32_16x16x32_bf16 v[44:47], v[12:15], v[100:103], 0
    s_waitcnt lgkmcnt(5)
    v_mfma_f32_16x16x32_bf16 v[72:75], v[16:19], v[96:99], 0
    ds_read_b128 v[12:15], v1 offset:9216
    v_mfma_f32_16x16x32_bf16 v[76:79], v[16:19], v[100:103], 0
    s_waitcnt lgkmcnt(5)
    v_mfma_f32_16x16x32_bf16 v[48:51], v[20:23], v[96:99], 0
    ds_read_b128 v[16:19], v1 offset:10240
    v_mfma_f32_16x16x32_bf16 v[52:55], v[20:23], v[100:103], 0
    global_load_dwordx4 v[160:163], v1, s[10:11] offset:1024 sc1
    global_load_dwordx4 v[164:167], v1, s[12:13] offset:1024 sc1
    s_waitcnt lgkmcnt(5)
    v_mfma_f32_16x16x32_bf16 v[80:83], v[24:27], v[96:99], 0
    ds_read_b128 v[20:23], v1 offset:11264
    v_mfma_f32_16x16x32_bf16 v[84:87], v[24:27], v[100:103], 0
    s_waitcnt vmcnt(14)
    v_bitop3_b32 v0, v104, v108, 1 bitop3:0xa8
    s_waitcnt lgkmcnt(5)
    v_mfma_f32_16x16x32_bf16 v[56:59], v[28:31], v[96:99], 0
    ds_read_b128 v[24:27], v1 offset:12288
    v_mfma_f32_16x16x32_bf16 v[60:63], v[28:31], v[100:103], 0
    v_cmp_eq_u32 vcc, 1, v0
    s_waitcnt lgkmcnt(5)
    v_mfma_f32_16x16x32_bf16 v[88:91], v[4:7], v[96:99], 0
    ds_read_b128 v[28:31], v1 offset:13312
    v_mfma_f32_16x16x32_bf16 v[92:95], v[4:7], v[100:103], 0
    s_cbranch_vccnz .adaLN_cond__spectral_gfnet__glu_gated_bilinear__prompt_kernel_stub55
.adaLN_cond__spectral_gfnet__glu_gated_bilinear__prompt_kernel_back56:
    s_waitcnt lgkmcnt(5)
    v_mfma_f32_16x16x32_bf16 v[32:35], v[8:11], v[104:107], v[32:35]
    ds_read_b128 v[4:7], v1 offset:14336
    v_mfma_f32_16x16x32_bf16 v[36:39], v[8:11], v[108:111], v[36:39]
    s_waitcnt lgkmcnt(5)
    v_mfma_f32_16x16x32_bf16 v[64:67], v[12:15], v[104:107], v[64:67]
    ds_read_b128 v[8:11], v1 offset:15360
    v_mfma_f32_16x16x32_bf16 v[68:71], v[12:15], v[108:111], v[68:71]
    global_load_dwordx4 v[168:171], v1, s[10:11] offset:2048 sc1
    global_load_dwordx4 v[172:175], v1, s[12:13] offset:2048 sc1
    s_add_u32 s35, s35, 5120
    s_cmp_eq_u32 s35, 20480
    s_cselect_b32 s35, 0, s35
    s_add_u32 s10, s50, s35
    s_addc_u32 s11, s51, 0
    s_add_u32 s12, s10, 20480
    s_addc_u32 s13, s11, 0
    s_waitcnt lgkmcnt(5)
    v_mfma_f32_16x16x32_bf16 v[40:43], v[16:19], v[104:107], v[40:43]
    ds_read_b128 v[12:15], v1 offset:16384
    v_mfma_f32_16x16x32_bf16 v[44:47], v[16:19], v[108:111], v[44:47]
    s_waitcnt lgkmcnt(5)
    v_mfma_f32_16x16x32_bf16 v[72:75], v[20:23], v[104:107], v[72:75]
    ds_read_b128 v[16:19], v1 offset:17408
    v_mfma_f32_16x16x32_bf16 v[76:79], v[20:23], v[108:111], v[76:79]
    s_waitcnt lgkmcnt(5)
    v_mfma_f32_16x16x32_bf16 v[48:51], v[24:27], v[104:107], v[48:51]
    ds_read_b128 v[20:23], v1 offset:18432
    v_mfma_f32_16x16x32_bf16 v[52:55], v[24:27], v[108:111], v[52:55]
    global_load_dwordx4 v[176:179], v1, s[10:11] offset:-2048 sc1
    global_load_dwordx4 v[180:183], v1, s[12:13] offset:-2048 sc1
    s_waitcnt lgkmcnt(5)
    v_mfma_f32_16x16x32_bf16 v[80:83], v[28:31], v[104:107], v[80:83]
    ds_read_b128 v[24:27], v1 offset:19456
    v_mfma_f32_16x16x32_bf16 v[84:87], v[28:31], v[108:111], v[84:87]
    s_waitcnt vmcnt(16)
    v_bitop3_b32 v0, v112, v116, 1 bitop3:0xa8
    s_waitcnt lgkmcnt(5)
    v_mfma_f32_16x16x32_bf16 v[56:59], v[4:7], v[104:107], v[56:59]
    ds_read_b128 v[28:31], v1 offset:20480
    v_mfma_f32_16x16x32_bf16 v[60:63], v[4:7], v[108:111], v[60:63]
    v_cmp_eq_u32 vcc, 1, v0
    s_waitcnt lgkmcnt(5)
    v_mfma_f32_16x16x32_bf16 v[88:91], v[8:11], v[104:107], v[88:91]
    ds_read_b128 v[4:7], v1 offset:21504
    v_mfma_f32_16x16x32_bf16 v[92:95], v[8:11], v[108:111], v[92:95]
    s_cbranch_vccnz .adaLN_cond__spectral_gfnet__glu_gated_bilinear__prompt_kernel_stub57
.adaLN_cond__spectral_gfnet__glu_gated_bilinear__prompt_kernel_back58:
    s_waitcnt lgkmcnt(5)
    v_mfma_f32_16x16x32_bf16 v[32:35], v[12:15], v[112:115], v[32:35]
    ds_read_b128 v[8:11], v1 offset:22528
    v_mfma_f32_16x16x32_bf16 v[36:39], v[12:15], v[116:119], v[36:39]
    s_waitcnt lgkmcnt(5)
    v_mfma_f32_16x16x32_bf16 v[64:67], v[16:19], v[112:115], v[64:67]
    ds_read_b128 v[12:15], v1 offset:23552
    v_mfma_f32_16x16x32_bf16 v[68:71], v[16:19], v[116:119], v[68:71]
    global_load_dwordx4 v[184:187], v1, s[10:11] offset:-1024 sc1
    global_load_dwordx4 v[188:191], v1, s[12:13] offset:-1024 sc1
    s_waitcnt lgkmcnt(5)
    v_mfma_f32_16x16x32_bf16 v[40:43], v[20:23], v[112:115], v[40:43]
    ds_read_b128 v[16:19], v1 offset:24576
    v_mfma_f32_16x16x32_bf16 v[44:47], v[20:23], v[116:119], v[44:47]
    s_waitcnt lgkmcnt(5)
    v_mfma_f32_16x16x32_bf16 v[72:75], v[24:27], v[112:115], v[72:75]
    ds_read_b128 v[20:23], v1 offset:25600
    v_mfma_f32_16x16x32_bf16 v[76:79], v[24:27], v[116:119], v[76:79]
    s_barrier
    s_waitcnt lgkmcnt(5)
    v_mfma_f32_16x16x32_bf16 v[48:51], v[28:31], v[112:115], v[48:51]
    ds_read_b128 v[24:27], v1 offset:26624
    v_mfma_f32_16x16x32_bf16 v[52:55], v[28:31], v[116:119], v[52:55]
    global_load_dwordx4 v[192:195], v1, s[10:11] offset:0 sc1
    global_load_dwordx4 v[196:199], v1, s[12:13] offset:0 sc1
    s_waitcnt lgkmcnt(5)
    v_mfma_f32_16x16x32_bf16 v[80:83], v[4:7], v[112:115], v[80:83]
    ds_read_b128 v[28:31], v1 offset:27648
    v_mfma_f32_16x16x32_bf16 v[84:87], v[4:7], v[116:119], v[84:87]
    s_waitcnt vmcnt(18)
    v_bitop3_b32 v0, v120, v124, 1 bitop3:0xa8
    s_waitcnt lgkmcnt(5)
    v_mfma_f32_16x16x32_bf16 v[56:59], v[8:11], v[112:115], v[56:59]
    ds_read_b128 v[4:7], v1 offset:28672
    v_mfma_f32_16x16x32_bf16 v[60:63], v[8:11], v[116:119], v[60:63]
    v_cmp_eq_u32 vcc, 1, v0
    s_waitcnt lgkmcnt(5)
    v_mfma_f32_16x16x32_bf16 v[88:91], v[12:15], v[112:115], v[88:91]
    ds_read_b128 v[8:11], v1 offset:29696
    v_mfma_f32_16x16x32_bf16 v[92:95], v[12:15], v[116:119], v[92:95]
    s_cbranch_vccnz .adaLN_cond__spectral_gfnet__glu_gated_bilinear__prompt_kernel_stub59
.adaLN_cond__spectral_gfnet__glu_gated_bilinear__prompt_kernel_back60:
    s_waitcnt lgkmcnt(5)
    v_mfma_f32_16x16x32_bf16 v[32:35], v[16:19], v[120:123], v[32:35]
    ds_read_b128 v[12:15], v1 offset:30720
    v_mfma_f32_16x16x32_bf16 v[36:39], v[16:19], v[124:127], v[36:39]
    s_waitcnt lgkmcnt(5)
    v_mfma_f32_16x16x32_bf16 v[64:67], v[20:23], v[120:123], v[64:67]
    ds_read_b128 v[16:19], v1 offset:31744
    v_mfma_f32_16x16x32_bf16 v[68:71], v[20:23], v[124:127], v[68:71]
    global_load_dwordx4 v[200:203], v1, s[10:11] offset:1024 sc1
    global_load_dwordx4 v[204:207], v1, s[12:13] offset:1024 sc1
    s_waitcnt lgkmcnt(5)
    v_mfma_f32_16x16x32_bf16 v[40:43], v[24:27], v[120:123], v[40:43]
    ds_read_b128 v[20:23], v1 offset:32768
    v_mfma_f32_16x16x32_bf16 v[44:47], v[24:27], v[124:127], v[44:47]
    s_waitcnt lgkmcnt(5)
    v_mfma_f32_16x16x32_bf16 v[72:75], v[28:31], v[120:123], v[72:75]
    ds_read_b128 v[24:27], v1 offset:33792
    v_mfma_f32_16x16x32_bf16 v[76:79], v[28:31], v[124:127], v[76:79]
    s_waitcnt lgkmcnt(5)
    v_mfma_f32_16x16x32_bf16 v[48:51], v[4:7], v[120:123], v[48:51]
    ds_read_b128 v[28:31], v1 offset:34816
    v_mfma_f32_16x16x32_bf16 v[52:55], v[4:7], v[124:127], v[52:55]
    global_load_dwordx4 v[208:211], v1, s[10:11] offset:2048 sc1
    global_load_dwordx4 v[212:215], v1, s[12:13] offset:2048 sc1
    s_add_u32 s35, s35, 5120
    s_cmp_eq_u32 s35, 20480
    s_cselect_b32 s35, 0, s35
    s_add_u32 s10, s50, s35
    s_addc_u32 s11, s51, 0
    s_add_u32 s12, s10, 20480
    s_addc_u32 s13, s11, 0
    s_waitcnt lgkmcnt(5)
    v_mfma_f32_16x16x32_bf16 v[80:83], v[8:11], v[120:123], v[80:83]
    ds_read_b128 v[4:7], v1 offset:35840
    v_mfma_f32_16x16x32_bf16 v[84:87], v[8:11], v[124:127], v[84:87]
    s_waitcnt vmcnt(20)
    v_bitop3_b32 v0, v128, v132, 1 bitop3:0xa8
    s_waitcnt lgkmcnt(5)
    v_mfma_f32_16x16x32_bf16 v[56:59], v[12:15], v[120:123], v[56:59]
    ds_read_b128 v[8:11], v1 offset:36864
    v_mfma_f32_16x16x32_bf16 v[60:63], v[12:15], v[124:127], v[60:63]
    v_cmp_eq_u32 vcc, 1, v0
    s_waitcnt lgkmcnt(5)
    v_mfma_f32_16x16x32_bf16 v[88:91], v[16:19], v[120:123], v[88:91]
    ds_read_b128 v[12:15], v1 offset:37888
    v_mfma_f32_16x16x32_bf16 v[92:95], v[16:19], v[124:127], v[92:95]
    s_cbranch_vccnz .adaLN_cond__spectral_gfnet__glu_gated_bilinear__prompt_kernel_stub61
.adaLN_cond__spectral_gfnet__glu_gated_bilinear__prompt_kernel_back62:
    s_waitcnt lgkmcnt(5)
    v_mfma_f32_16x16x32_bf16 v[32:35], v[20:23], v[128:131], v[32:35]
    ds_read_b128 v[16:19], v1 offset:38912
    v_mfma_f32_16x16x32_bf16 v[36:39], v[20:23], v[132:135], v[36:39]
    s_waitcnt lgkmcnt(5)
    v_mfma_f32_16x16x32_bf16 v[64:67], v[24:27], v[128:131], v[64:67]
    ds_read_b128 v[20:23], v1 offset:39936
    v_mfma_f32_16x16x32_bf16 v[68:71], v[24:27], v[132:135], v[68:71]
    global_load_dwordx4 v[216:219], v1, s[10:11] offset:-2048 sc1
    global_load_dwordx4 v[220:223], v1, s[12:13] offset:-2048 sc1
    s_waitcnt lgkmcnt(5)
    v_mfma_f32_16x16x32_bf16 v[40:43], v[28:31], v[128:131], v[40:43]
    ds_read_b128 v[24:27], v1 offset:40960
    v_mfma_f32_16x16x32_bf16 v[44:47], v[28:31], v[132:135], v[44:47]
    s_waitcnt lgkmcnt(5)
    v_mfma_f32_16x16x32_bf16 v[72:75], v[4:7], v[128:131], v[72:75]
    ds_read_b128 v[28:31], v1 offset:41984
    v_mfma_f32_16x16x32_bf16 v[76:79], v[4:7], v[132:135], v[76:79]
    s_waitcnt lgkmcnt(5)
    v_mfma_f32_16x16x32_bf16 v[48:51], v[8:11], v[128:131], v[48:51]
    ds_read_b128 v[4:7], v1 offset:43008
    v_mfma_f32_16x16x32_bf16 v[52:55], v[8:11], v[132:135], v[52:55]
    global_load_dwordx4 v[224:227], v1, s[10:11] offset:-1024 sc1
    global_load_dwordx4 v[228:231], v1, s[12:13] offset:-1024 sc1
    s_waitcnt lgkmcnt(5)
    v_mfma_f32_16x16x32_bf16 v[80:83], v[12:15], v[128:131], v[80:83]
    ds_read_b128 v[8:11], v1 offset:44032
    v_mfma_f32_16x16x32_bf16 v[84:87], v[12:15], v[132:135], v[84:87]
    s_waitcnt vmcnt(22)
    v_bitop3_b32 v0, v136, v140, 1 bitop3:0xa8
    s_waitcnt lgkmcnt(5)
    v_mfma_f32_16x16x32_bf16 v[56:59], v[16:19], v[128:131], v[56:59]
    ds_read_b128 v[12:15], v1 offset:45056
    v_mfma_f32_16x16x32_bf16 v[60:63], v[16:19], v[132:135], v[60:63]
    v_cmp_eq_u32 vcc, 1, v0
    s_waitcnt lgkmcnt(5)
    v_mfma_f32_16x16x32_bf16 v[88:91], v[20:23], v[128:131], v[88:91]
    ds_read_b128 v[16:19], v1 offset:46080
    v_mfma_f32_16x16x32_bf16 v[92:95], v[20:23], v[132:135], v[92:95]
    s_cbranch_vccnz .adaLN_cond__spectral_gfnet__glu_gated_bilinear__prompt_kernel_stub63
.adaLN_cond__spectral_gfnet__glu_gated_bilinear__prompt_kernel_back64:
    s_barrier
    s_waitcnt lgkmcnt(5)
    v_mfma_f32_16x16x32_bf16 v[32:35], v[24:27], v[136:139], v[32:35]
    ds_read_b128 v[20:23], v1 offset:47104
    v_mfma_f32_16x16x32_bf16 v[36:39], v[24:27], v[140:143], v[36:39]
    s_waitcnt lgkmcnt(5)
    v_mfma_f32_16x16x32_bf16 v[64:67], v[28:31], v[136:139], v[64:67]
    ds_read_b128 v[24:27], v1 offset:48128
    v_mfma_f32_16x16x32_bf16 v[68:71], v[28:31], v[140:143], v[68:71]
    global_load_dwordx4 v[232:235], v1, s[10:11] offset:0 sc1
    global_load_dwordx4 v[236:239], v1, s[12:13] offset:0 sc1
    s_waitcnt lgkmcnt(5)
    v_mfma_f32_16x16x32_bf16 v[40:43], v[4:7], v[136:139], v[40:43]
    ds_read_b128 v[28:31], v1 offset:49152
    v_mfma_f32_16x16x32_bf16 v[44:47], v[4:7], v[140:143], v[44:47]
    s_waitcnt lgkmcnt(5)
    v_mfma_f32_16x16x32_bf16 v[72:75], v[8:11], v[136:139], v[72:75]
    ds_read_b128 v[4:7], v1 offset:50176
    v_mfma_f32_16x16x32_bf16 v[76:79], v[8:11], v[140:143], v[76:79]
    s_waitcnt lgkmcnt(5)
    v_mfma_f32_16x16x32_bf16 v[48:51], v[12:15], v[136:139], v[48:51]
    ds_read_b128 v[8:11], v1 offset:51200
    v_mfma_f32_16x16x32_bf16 v[52:55], v[12:15], v[140:143], v[52:55]
    global_load_dwordx4 v[240:243], v1, s[10:11] offset:1024 sc1
    global_load_dwordx4 v[244:247], v1, s[12:13] offset:1024 sc1
    s_waitcnt lgkmcnt(5)
    v_mfma_f32_16x16x32_bf16 v[80:83], v[16:19], v[136:139], v[80:83]
    ds_read_b128 v[12:15], v1 offset:52224
    v_mfma_f32_16x16x32_bf16 v[84:87], v[16:19], v[140:143], v[84:87]
    s_waitcnt vmcnt(24)
    v_bitop3_b32 v0, v144, v148, 1 bitop3:0xa8
    s_waitcnt lgkmcnt(5)
    v_mfma_f32_16x16x32_bf16 v[56:59], v[20:23], v[136:139], v[56:59]
    ds_read_b128 v[16:19], v1 offset:53248
    v_mfma_f32_16x16x32_bf16 v[60:63], v[20:23], v[140:143], v[60:63]
    v_cmp_eq_u32 vcc, 1, v0
    s_waitcnt lgkmcnt(5)
    v_mfma_f32_16x16x32_bf16 v[88:91], v[24:27], v[136:139], v[88:91]
    ds_read_b128 v[20:23], v1 offset:54272
    v_mfma_f32_16x16x32_bf16 v[92:95], v[24:27], v[140:143], v[92:95]
    s_cbranch_vccnz .adaLN_cond__spectral_gfnet__glu_gated_bilinear__prompt_kernel_stub65
.adaLN_cond__spectral_gfnet__glu_gated_bilinear__prompt_kernel_back66:
    s_waitcnt lgkmcnt(5)
    v_mfma_f32_16x16x32_bf16 v[32:35], v[28:31], v[144:147], v[32:35]
    ds_read_b128 v[24:27], v1 offset:55296
    v_mfma_f32_16x16x32_bf16 v[36:39], v[28:31], v[148:151], v[36:39]
    s_waitcnt lgkmcnt(5)
    v_mfma_f32_16x16x32_bf16 v[64:67], v[4:7], v[144:147], v[64:67]
    ds_read_b128 v[28:31], v1 offset:56320
    v_mfma_f32_16x16x32_bf16 v[68:71], v[4:7], v[148:151], v[68:71]
    global_load_dwordx4 v[248:251], v1, s[10:11] offset:2048 sc1
    global_load_dwordx4 v[252:255], v1, s[12:13] offset:2048 sc1
    s_waitcnt lgkmcnt(5)
    v_mfma_f32_16x16x32_bf16 v[40:43], v[8:11], v[144:147], v[40:43]
    ds_read_b128 v[4:7], v1 offset:57344
    v_mfma_f32_16x16x32_bf16 v[44:47], v[8:11], v[148:151], v[44:47]
    s_waitcnt lgkmcnt(5)
    v_mfma_f32_16x16x32_bf16 v[72:75], v[12:15], v[144:147], v[72:75]
    ds_read_b128 v[8:11], v1 offset:58368
    v_mfma_f32_16x16x32_bf16 v[76:79], v[12:15], v[148:151], v[76:79]
    s_waitcnt lgkmcnt(5)
    v_mfma_f32_16x16x32_bf16 v[48:51], v[16:19], v[144:147], v[48:51]
    ds_read_b128 v[12:15], v1 offset:59392
    v_mfma_f32_16x16x32_bf16 v[52:55], v[16:19], v[148:151], v[52:55]
    s_waitcnt lgkmcnt(5)
    v_mfma_f32_16x16x32_bf16 v[80:83], v[20:23], v[144:147], v[80:83]
    ds_read_b128 v[16:19], v1 offset:60416
    v_mfma_f32_16x16x32_bf16 v[84:87], v[20:23], v[148:151], v[84:87]
    s_waitcnt vmcnt(24)
    v_bitop3_b32 v0, v152, v156, 1 bitop3:0xa8
    s_waitcnt lgkmcnt(5)
    v_mfma_f32_16x16x32_bf16 v[56:59], v[24:27], v[144:147], v[56:59]
    ds_read_b128 v[20:23], v1 offset:61440
    v_mfma_f32_16x16x32_bf16 v[60:63], v[24:27], v[148:151], v[60:63]
    v_cmp_eq_u32 vcc, 1, v0
    s_waitcnt lgkmcnt(5)
    v_mfma_f32_16x16x32_bf16 v[88:91], v[28:31], v[144:147], v[88:91]
    ds_read_b128 v[24:27], v1 offset:62464
    v_mfma_f32_16x16x32_bf16 v[92:95], v[28:31], v[148:151], v[92:95]
    s_cbranch_vccnz .adaLN_cond__spectral_gfnet__glu_gated_bilinear__prompt_kernel_stub67
.adaLN_cond__spectral_gfnet__glu_gated_bilinear__prompt_kernel_back68:
    s_waitcnt lgkmcnt(5)
    v_mfma_f32_16x16x32_bf16 v[32:35], v[4:7], v[152:155], v[32:35]
    ds_read_b128 v[28:31], v1 offset:63488
    v_mfma_f32_16x16x32_bf16 v[36:39], v[4:7], v[156:159], v[36:39]
    s_waitcnt lgkmcnt(5)
    v_mfma_f32_16x16x32_bf16 v[64:67], v[8:11], v[152:155], v[64:67]
    ds_read_b128 v[4:7], v1 offset:64512
    v_mfma_f32_16x16x32_bf16 v[68:71], v[8:11], v[156:159], v[68:71]
    s_waitcnt lgkmcnt(5)
    v_mfma_f32_16x16x32_bf16 v[40:43], v[12:15], v[152:155], v[40:43]
    ds_read_b128 v[8:11], v2 offset:0
    v_mfma_f32_16x16x32_bf16 v[44:47], v[12:15], v[156:159], v[44:47]
    s_waitcnt lgkmcnt(5)
    v_mfma_f32_16x16x32_bf16 v[72:75], v[16:19], v[152:155], v[72:75]
    ds_read_b128 v[12:15], v2 offset:1024
    v_mfma_f32_16x16x32_bf16 v[76:79], v[16:19], v[156:159], v[76:79]
    s_barrier
    s_waitcnt lgkmcnt(5)
    v_mfma_f32_16x16x32_bf16 v[48:51], v[20:23], v[152:155], v[48:51]
    ds_read_b128 v[16:19], v2 offset:2048
    v_mfma_f32_16x16x32_bf16 v[52:55], v[20:23], v[156:159], v[52:55]
    s_waitcnt lgkmcnt(5)
    v_mfma_f32_16x16x32_bf16 v[80:83], v[24:27], v[152:155], v[80:83]
    ds_read_b128 v[20:23], v2 offset:3072
    v_mfma_f32_16x16x32_bf16 v[84:87], v[24:27], v[156:159], v[84:87]
    s_waitcnt vmcnt(22)
    v_bitop3_b32 v0, v160, v164, 1 bitop3:0xa8
    s_waitcnt lgkmcnt(5)
    v_mfma_f32_16x16x32_bf16 v[56:59], v[28:31], v[152:155], v[56:59]
    ds_read_b128 v[24:27], v2 offset:4096
    v_mfma_f32_16x16x32_bf16 v[60:63], v[28:31], v[156:159], v[60:63]
    v_cmp_eq_u32 vcc, 1, v0
    s_waitcnt lgkmcnt(5)
    v_mfma_f32_16x16x32_bf16 v[88:91], v[4:7], v[152:155], v[88:91]
    ds_read_b128 v[28:31], v2 offset:5120
    v_mfma_f32_16x16x32_bf16 v[92:95], v[4:7], v[156:159], v[92:95]
    s_cbranch_vccnz .adaLN_cond__spectral_gfnet__glu_gated_bilinear__prompt_kernel_stub69
.adaLN_cond__spectral_gfnet__glu_gated_bilinear__prompt_kernel_back70:
    s_waitcnt lgkmcnt(5)
    v_mfma_f32_16x16x32_bf16 v[32:35], v[8:11], v[160:163], v[32:35]
    ds_read_b128 v[4:7], v2 offset:6144
    v_mfma_f32_16x16x32_bf16 v[36:39], v[8:11], v[164:167], v[36:39]
    s_waitcnt lgkmcnt(5)
    v_mfma_f32_16x16x32_bf16 v[64:67], v[12:15], v[160:163], v[64:67]
    ds_read_b128 v[8:11], v2 offset:7168
    v_mfma_f32_16x16x32_bf16 v[68:71], v[12:15], v[164:167], v[68:71]
    s_waitcnt lgkmcnt(5)
    v_mfma_f32_16x16x32_bf16 v[40:43], v[16:19], v[160:163], v[40:43]
    ds_read_b128 v[12:15], v2 offset:8192
    v_mfma_f32_16x16x32_bf16 v[44:47], v[16:19], v[164:167], v[44:47]
    s_waitcnt lgkmcnt(5)
    v_mfma_f32_16x16x32_bf16 v[72:75], v[20:23], v[160:163], v[72:75]
    ds_read_b128 v[16:19], v2 offset:9216
    v_mfma_f32_16x16x32_bf16 v[76:79], v[20:23], v[164:167], v[76:79]
    s_waitcnt lgkmcnt(5)
    v_mfma_f32_16x16x32_bf16 v[48:51], v[24:27], v[160:163], v[48:51]
    ds_read_b128 v[20:23], v2 offset:10240
    v_mfma_f32_16x16x32_bf16 v[52:55], v[24:27], v[164:167], v[52:55]
    s_waitcnt lgkmcnt(5)
    v_mfma_f32_16x16x32_bf16 v[80:83], v[28:31], v[160:163], v[80:83]
    ds_read_b128 v[24:27], v2 offset:11264
    v_mfma_f32_16x16x32_bf16 v[84:87], v[28:31], v[164:167], v[84:87]
    s_waitcnt vmcnt(20)
    v_bitop3_b32 v0, v168, v172, 1 bitop3:0xa8
    s_waitcnt lgkmcnt(5)
    v_mfma_f32_16x16x32_bf16 v[56:59], v[4:7], v[160:163], v[56:59]
    ds_read_b128 v[28:31], v2 offset:12288
    v_mfma_f32_16x16x32_bf16 v[60:63], v[4:7], v[164:167], v[60:63]
    v_cmp_eq_u32 vcc, 1, v0
    s_waitcnt lgkmcnt(5)
    v_mfma_f32_16x16x32_bf16 v[88:91], v[8:11], v[160:163], v[88:91]
    ds_read_b128 v[4:7], v2 offset:13312
    v_mfma_f32_16x16x32_bf16 v[92:95], v[8:11], v[164:167], v[92:95]
    s_cbranch_vccnz .adaLN_cond__spectral_gfnet__glu_gated_bilinear__prompt_kernel_stub71
.adaLN_cond__spectral_gfnet__glu_gated_bilinear__prompt_kernel_back72:
    s_waitcnt lgkmcnt(5)
    v_mfma_f32_16x16x32_bf16 v[32:35], v[12:15], v[168:171], v[32:35]
    ds_read_b128 v[8:11], v2 offset:14336
    v_mfma_f32_16x16x32_bf16 v[36:39], v[12:15], v[172:175], v[36:39]
    s_waitcnt lgkmcnt(5)
    v_mfma_f32_16x16x32_bf16 v[64:67], v[16:19], v[168:171], v[64:67]
    ds_read_b128 v[12:15], v2 offset:15360
    v_mfma_f32_16x16x32_bf16 v[68:71], v[16:19], v[172:175], v[68:71]
    s_waitcnt lgkmcnt(5)
    v_mfma_f32_16x16x32_bf16 v[40:43], v[20:23], v[168:171], v[40:43]
    ds_read_b128 v[16:19], v2 offset:16384
    v_mfma_f32_16x16x32_bf16 v[44:47], v[20:23], v[172:175], v[44:47]
    s_waitcnt lgkmcnt(5)
    v_mfma_f32_16x16x32_bf16 v[72:75], v[24:27], v[168:171], v[72:75]
    ds_read_b128 v[20:23], v2 offset:17408
    v_mfma_f32_16x16x32_bf16 v[76:79], v[24:27], v[172:175], v[76:79]
    s_waitcnt lgkmcnt(5)
    v_mfma_f32_16x16x32_bf16 v[48:51], v[28:31], v[168:171], v[48:51]
    ds_read_b128 v[24:27], v2 offset:18432
    v_mfma_f32_16x16x32_bf16 v[52:55], v[28:31], v[172:175], v[52:55]
    s_waitcnt lgkmcnt(5)
    v_mfma_f32_16x16x32_bf16 v[80:83], v[4:7], v[168:171], v[80:83]
    ds_read_b128 v[28:31], v2 offset:19456
    v_mfma_f32_16x16x32_bf16 v[84:87], v[4:7], v[172:175], v[84:87]
    s_waitcnt vmcnt(18)
    v_bitop3_b32 v0, v176, v180, 1 bitop3:0xa8
    s_waitcnt lgkmcnt(5)
    v_mfma_f32_16x16x32_bf16 v[56:59], v[8:11], v[168:171], v[56:59]
    ds_read_b128 v[4:7], v2 offset:20480
    v_mfma_f32_16x16x32_bf16 v[60:63], v[8:11], v[172:175], v[60:63]
    v_cmp_eq_u32 vcc, 1, v0
    s_waitcnt lgkmcnt(5)
    v_mfma_f32_16x16x32_bf16 v[88:91], v[12:15], v[168:171], v[88:91]
    ds_read_b128 v[8:11], v2 offset:21504
    v_mfma_f32_16x16x32_bf16 v[92:95], v[12:15], v[172:175], v[92:95]
    s_cbranch_vccnz .adaLN_cond__spectral_gfnet__glu_gated_bilinear__prompt_kernel_stub73
.adaLN_cond__spectral_gfnet__glu_gated_bilinear__prompt_kernel_back74:
    s_barrier
    s_waitcnt lgkmcnt(5)
    v_mfma_f32_16x16x32_bf16 v[32:35], v[16:19], v[176:179], v[32:35]
    ds_read_b128 v[12:15], v2 offset:22528
    v_mfma_f32_16x16x32_bf16 v[36:39], v[16:19], v[180:183], v[36:39]
    s_waitcnt lgkmcnt(5)
    v_mfma_f32_16x16x32_bf16 v[64:67], v[20:23], v[176:179], v[64:67]
    ds_read_b128 v[16:19], v2 offset:23552
    v_mfma_f32_16x16x32_bf16 v[68:71], v[20:23], v[180:183], v[68:71]
    s_waitcnt lgkmcnt(5)
    v_mfma_f32_16x16x32_bf16 v[40:43], v[24:27], v[176:179], v[40:43]
    ds_read_b128 v[20:23], v2 offset:24576
    v_mfma_f32_16x16x32_bf16 v[44:47], v[24:27], v[180:183], v[44:47]
    s_waitcnt lgkmcnt(5)
    v_mfma_f32_16x16x32_bf16 v[72:75], v[28:31], v[176:179], v[72:75]
    ds_read_b128 v[24:27], v2 offset:25600
    v_mfma_f32_16x16x32_bf16 v[76:79], v[28:31], v[180:183], v[76:79]
    s_waitcnt lgkmcnt(5)
    v_mfma_f32_16x16x32_bf16 v[48:51], v[4:7], v[176:179], v[48:51]
    ds_read_b128 v[28:31], v2 offset:26624
    v_mfma_f32_16x16x32_bf16 v[52:55], v[4:7], v[180:183], v[52:55]
    s_waitcnt lgkmcnt(5)
    v_mfma_f32_16x16x32_bf16 v[80:83], v[8:11], v[176:179], v[80:83]
    ds_read_b128 v[4:7], v2 offset:27648
    v_mfma_f32_16x16x32_bf16 v[84:87], v[8:11], v[180:183], v[84:87]
    s_waitcnt vmcnt(16)
    v_bitop3_b32 v0, v184, v188, 1 bitop3:0xa8
    s_waitcnt lgkmcnt(5)
    v_mfma_f32_16x16x32_bf16 v[56:59], v[12:15], v[176:179], v[56:59]
    ds_read_b128 v[8:11], v2 offset:28672
    v_mfma_f32_16x16x32_bf16 v[60:63], v[12:15], v[180:183], v[60:63]
    v_cmp_eq_u32 vcc, 1, v0
    s_waitcnt lgkmcnt(5)
    v_mfma_f32_16x16x32_bf16 v[88:91], v[16:19], v[176:179], v[88:91]
    ds_read_b128 v[12:15], v2 offset:29696
    v_mfma_f32_16x16x32_bf16 v[92:95], v[16:19], v[180:183], v[92:95]
    s_cbranch_vccnz .adaLN_cond__spectral_gfnet__glu_gated_bilinear__prompt_kernel_stub75
.adaLN_cond__spectral_gfnet__glu_gated_bilinear__prompt_kernel_back76:
    s_waitcnt lgkmcnt(5)
    v_mfma_f32_16x16x32_bf16 v[32:35], v[20:23], v[184:187], v[32:35]
    ds_read_b128 v[16:19], v2 offset:30720
    v_mfma_f32_16x16x32_bf16 v[36:39], v[20:23], v[188:191], v[36:39]
    s_waitcnt lgkmcnt(5)
    v_mfma_f32_16x16x32_bf16 v[64:67], v[24:27], v[184:187], v[64:67]
    ds_read_b128 v[20:23], v2 offset:31744
    v_mfma_f32_16x16x32_bf16 v[68:71], v[24:27], v[188:191], v[68:71]
    s_waitcnt lgkmcnt(5)
    v_mfma_f32_16x16x32_bf16 v[40:43], v[28:31], v[184:187], v[40:43]
    ds_read_b128 v[24:27], v2 offset:32768
    v_mfma_f32_16x16x32_bf16 v[44:47], v[28:31], v[188:191], v[44:47]
    s_waitcnt lgkmcnt(5)
    v_mfma_f32_16x16x32_bf16 v[72:75], v[4:7], v[184:187], v[72:75]
    ds_read_b128 v[28:31], v2 offset:33792
    v_mfma_f32_16x16x32_bf16 v[76:79], v[4:7], v[188:191], v[76:79]
    s_waitcnt lgkmcnt(5)
    v_mfma_f32_16x16x32_bf16 v[48:51], v[8:11], v[184:187], v[48:51]
    ds_read_b128 v[4:7], v2 offset:34816
    v_mfma_f32_16x16x32_bf16 v[52:55], v[8:11], v[188:191], v[52:55]
    s_waitcnt lgkmcnt(5)
    v_mfma_f32_16x16x32_bf16 v[80:83], v[12:15], v[184:187], v[80:83]
    ds_read_b128 v[8:11], v2 offset:35840
    v_mfma_f32_16x16x32_bf16 v[84:87], v[12:15], v[188:191], v[84:87]
    s_waitcnt vmcnt(14)
    v_bitop3_b32 v0, v192, v196, 1 bitop3:0xa8
    s_waitcnt lgkmcnt(5)
    v_mfma_f32_16x16x32_bf16 v[56:59], v[16:19], v[184:187], v[56:59]
    ds_read_b128 v[12:15], v2 offset:36864
    v_mfma_f32_16x16x32_bf16 v[60:63], v[16:19], v[188:191], v[60:63]
    v_cmp_eq_u32 vcc, 1, v0
    s_waitcnt lgkmcnt(5)
    v_mfma_f32_16x16x32_bf16 v[88:91], v[20:23], v[184:187], v[88:91]
    ds_read_b128 v[16:19], v2 offset:37888
    v_mfma_f32_16x16x32_bf16 v[92:95], v[20:23], v[188:191], v[92:95]
    s_cbranch_vccnz .adaLN_cond__spectral_gfnet__glu_gated_bilinear__prompt_kernel_stub77
.adaLN_cond__spectral_gfnet__glu_gated_bilinear__prompt_kernel_back78:
    s_waitcnt lgkmcnt(5)
    v_mfma_f32_16x16x32_bf16 v[32:35], v[24:27], v[192:195], v[32:35]
    ds_read_b128 v[20:23], v2 offset:38912
    v_mfma_f32_16x16x32_bf16 v[36:39], v[24:27], v[196:199], v[36:39]
    s_waitcnt lgkmcnt(5)
    v_mfma_f32_16x16x32_bf16 v[64:67], v[28:31], v[192:195], v[64:67]
    ds_read_b128 v[24:27], v2 offset:39936
    v_mfma_f32_16x16x32_bf16 v[68:71], v[28:31], v[196:199], v[68:71]
    s_waitcnt lgkmcnt(5)
    v_mfma_f32_16x16x32_bf16 v[40:43], v[4:7], v[192:195], v[40:43]
    ds_read_b128 v[28:31], v2 offset:40960
    v_mfma_f32_16x16x32_bf16 v[44:47], v[4:7], v[196:199], v[44:47]
    s_waitcnt lgkmcnt(5)
    v_mfma_f32_16x16x32_bf16 v[72:75], v[8:11], v[192:195], v[72:75]
    ds_read_b128 v[4:7], v2 offset:41984
    v_mfma_f32_16x16x32_bf16 v[76:79], v[8:11], v[196:199], v[76:79]
    s_barrier
    s_waitcnt lgkmcnt(5)
    v_mfma_f32_16x16x32_bf16 v[48:51], v[12:15], v[192:195], v[48:51]
    ds_read_b128 v[8:11], v2 offset:43008
    v_mfma_f32_16x16x32_bf16 v[52:55], v[12:15], v[196:199], v[52:55]
    s_waitcnt lgkmcnt(5)
    v_mfma_f32_16x16x32_bf16 v[80:83], v[16:19], v[192:195], v[80:83]
    ds_read_b128 v[12:15], v2 offset:44032
    v_mfma_f32_16x16x32_bf16 v[84:87], v[16:19], v[196:199], v[84:87]
    s_waitcnt vmcnt(12)
    v_bitop3_b32 v0, v200, v204, 1 bitop3:0xa8
    s_waitcnt lgkmcnt(5)
    v_mfma_f32_16x16x32_bf16 v[56:59], v[20:23], v[192:195], v[56:59]
    ds_read_b128 v[16:19], v2 offset:45056
    v_mfma_f32_16x16x32_bf16 v[60:63], v[20:23], v[196:199], v[60:63]
    v_cmp_eq_u32 vcc, 1, v0
    s_waitcnt lgkmcnt(5)
    v_mfma_f32_16x16x32_bf16 v[88:91], v[24:27], v[192:195], v[88:91]
    ds_read_b128 v[20:23], v2 offset:46080
    v_mfma_f32_16x16x32_bf16 v[92:95], v[24:27], v[196:199], v[92:95]
    s_cbranch_vccnz .adaLN_cond__spectral_gfnet__glu_gated_bilinear__prompt_kernel_stub79
.adaLN_cond__spectral_gfnet__glu_gated_bilinear__prompt_kernel_back80:
    s_waitcnt lgkmcnt(5)
    v_mfma_f32_16x16x32_bf16 v[32:35], v[28:31], v[200:203], v[32:35]
    ds_read_b128 v[24:27], v2 offset:47104
    v_mfma_f32_16x16x32_bf16 v[36:39], v[28:31], v[204:207], v[36:39]
    s_waitcnt lgkmcnt(5)
    v_mfma_f32_16x16x32_bf16 v[64:67], v[4:7], v[200:203], v[64:67]
    ds_read_b128 v[28:31], v2 offset:48128
    v_mfma_f32_16x16x32_bf16 v[68:71], v[4:7], v[204:207], v[68:71]
    s_waitcnt lgkmcnt(5)
    v_mfma_f32_16x16x32_bf16 v[40:43], v[8:11], v[200:203], v[40:43]
    ds_read_b128 v[4:7], v2 offset:49152
    v_mfma_f32_16x16x32_bf16 v[44:47], v[8:11], v[204:207], v[44:47]
    s_waitcnt lgkmcnt(5)
    v_mfma_f32_16x16x32_bf16 v[72:75], v[12:15], v[200:203], v[72:75]
    ds_read_b128 v[8:11], v2 offset:50176
    v_mfma_f32_16x16x32_bf16 v[76:79], v[12:15], v[204:207], v[76:79]
    s_waitcnt lgkmcnt(5)
    v_mfma_f32_16x16x32_bf16 v[48:51], v[16:19], v[200:203], v[48:51]
    ds_read_b128 v[12:15], v2 offset:51200
    v_mfma_f32_16x16x32_bf16 v[52:55], v[16:19], v[204:207], v[52:55]
    s_waitcnt lgkmcnt(5)
    v_mfma_f32_16x16x32_bf16 v[80:83], v[20:23], v[200:203], v[80:83]
    ds_read_b128 v[16:19], v2 offset:52224
    v_mfma_f32_16x16x32_bf16 v[84:87], v[20:23], v[204:207], v[84:87]
    s_waitcnt vmcnt(10)
    v_bitop3_b32 v0, v208, v212, 1 bitop3:0xa8
    s_waitcnt lgkmcnt(5)
    v_mfma_f32_16x16x32_bf16 v[56:59], v[24:27], v[200:203], v[56:59]
    ds_read_b128 v[20:23], v2 offset:53248
    v_mfma_f32_16x16x32_bf16 v[60:63], v[24:27], v[204:207], v[60:63]
    v_cmp_eq_u32 vcc, 1, v0
    s_waitcnt lgkmcnt(5)
    v_mfma_f32_16x16x32_bf16 v[88:91], v[28:31], v[200:203], v[88:91]
    ds_read_b128 v[24:27], v2 offset:54272
    v_mfma_f32_16x16x32_bf16 v[92:95], v[28:31], v[204:207], v[92:95]
    s_cbranch_vccnz .adaLN_cond__spectral_gfnet__glu_gated_bilinear__prompt_kernel_stub81
.adaLN_cond__spectral_gfnet__glu_gated_bilinear__prompt_kernel_back82:
    s_waitcnt lgkmcnt(5)
    v_mfma_f32_16x16x32_bf16 v[32:35], v[4:7], v[208:211], v[32:35]
    ds_read_b128 v[28:31], v2 offset:55296
    v_mfma_f32_16x16x32_bf16 v[36:39], v[4:7], v[212:215], v[36:39]
    s_waitcnt lgkmcnt(5)
    v_mfma_f32_16x16x32_bf16 v[64:67], v[8:11], v[208:211], v[64:67]
    ds_read_b128 v[4:7], v2 offset:56320
    v_mfma_f32_16x16x32_bf16 v[68:71], v[8:11], v[212:215], v[68:71]
    s_waitcnt lgkmcnt(5)
    v_mfma_f32_16x16x32_bf16 v[40:43], v[12:15], v[208:211], v[40:43]
    ds_read_b128 v[8:11], v2 offset:57344
    v_mfma_f32_16x16x32_bf16 v[44:47], v[12:15], v[212:215], v[44:47]
    s_waitcnt lgkmcnt(5)
    v_mfma_f32_16x16x32_bf16 v[72:75], v[16:19], v[208:211], v[72:75]
    ds_read_b128 v[12:15], v2 offset:58368
    v_mfma_f32_16x16x32_bf16 v[76:79], v[16:19], v[212:215], v[76:79]
    s_waitcnt lgkmcnt(5)
    v_mfma_f32_16x16x32_bf16 v[48:51], v[20:23], v[208:211], v[48:51]
    ds_read_b128 v[16:19], v2 offset:59392
    v_mfma_f32_16x16x32_bf16 v[52:55], v[20:23], v[212:215], v[52:55]
    s_waitcnt lgkmcnt(5)
    v_mfma_f32_16x16x32_bf16 v[80:83], v[24:27], v[208:211], v[80:83]
    ds_read_b128 v[20:23], v2 offset:60416
    v_mfma_f32_16x16x32_bf16 v[84:87], v[24:27], v[212:215], v[84:87]
    s_waitcnt vmcnt(8)
    v_bitop3_b32 v0, v216, v220, 1 bitop3:0xa8
    s_waitcnt lgkmcnt(5)
    v_mfma_f32_16x16x32_bf16 v[56:59], v[28:31], v[208:211], v[56:59]
    ds_read_b128 v[24:27], v2 offset:61440
    v_mfma_f32_16x16x32_bf16 v[60:63], v[28:31], v[212:215], v[60:63]
    v_cmp_eq_u32 vcc, 1, v0
    s_waitcnt lgkmcnt(5)
    v_mfma_f32_16x16x32_bf16 v[88:91], v[4:7], v[208:211], v[88:91]
    ds_read_b128 v[28:31], v2 offset:62464
    v_mfma_f32_16x16x32_bf16 v[92:95], v[4:7], v[212:215], v[92:95]
    s_cbranch_vccnz .adaLN_cond__spectral_gfnet__glu_gated_bilinear__prompt_kernel_stub83
.adaLN_cond__spectral_gfnet__glu_gated_bilinear__prompt_kernel_back84:
    s_barrier
    s_waitcnt lgkmcnt(5)
    v_mfma_f32_16x16x32_bf16 v[32:35], v[8:11], v[216:219], v[32:35]
    ds_read_b128 v[4:7], v2 offset:63488
    v_mfma_f32_16x16x32_bf16 v[36:39], v[8:11], v[220:223], v[36:39]
    s_waitcnt lgkmcnt(5)
    v_mfma_f32_16x16x32_bf16 v[64:67], v[12:15], v[216:219], v[64:67]
    ds_read_b128 v[8:11], v2 offset:64512
    v_mfma_f32_16x16x32_bf16 v[68:71], v[12:15], v[220:223], v[68:71]
    s_waitcnt lgkmcnt(5)
    v_mfma_f32_16x16x32_bf16 v[40:43], v[16:19], v[216:219], v[40:43]
    ds_read_b128 v[12:15], v3 offset:0
    v_mfma_f32_16x16x32_bf16 v[44:47], v[16:19], v[220:223], v[44:47]
    s_waitcnt lgkmcnt(5)
    v_mfma_f32_16x16x32_bf16 v[72:75], v[20:23], v[216:219], v[72:75]
    ds_read_b128 v[16:19], v3 offset:1024
    v_mfma_f32_16x16x32_bf16 v[76:79], v[20:23], v[220:223], v[76:79]
    s_waitcnt lgkmcnt(5)
    v_mfma_f32_16x16x32_bf16 v[48:51], v[24:27], v[216:219], v[48:51]
    ds_read_b128 v[20:23], v3 offset:2048
    v_mfma_f32_16x16x32_bf16 v[52:55], v[24:27], v[220:223], v[52:55]
    s_waitcnt lgkmcnt(5)
    v_mfma_f32_16x16x32_bf16 v[80:83], v[28:31], v[216:219], v[80:83]
    ds_read_b128 v[24:27], v3 offset:3072
    v_mfma_f32_16x16x32_bf16 v[84:87], v[28:31], v[220:223], v[84:87]
    s_waitcnt vmcnt(6)
    v_bitop3_b32 v0, v224, v228, 1 bitop3:0xa8
    s_waitcnt lgkmcnt(5)
    v_mfma_f32_16x16x32_bf16 v[56:59], v[4:7], v[216:219], v[56:59]
    ds_read_b128 v[28:31], v3 offset:4096
    v_mfma_f32_16x16x32_bf16 v[60:63], v[4:7], v[220:223], v[60:63]
    v_cmp_eq_u32 vcc, 1, v0
    s_waitcnt lgkmcnt(5)
    v_mfma_f32_16x16x32_bf16 v[88:91], v[8:11], v[216:219], v[88:91]
    ds_read_b128 v[4:7], v3 offset:5120
    v_mfma_f32_16x16x32_bf16 v[92:95], v[8:11], v[220:223], v[92:95]
    s_cbranch_vccnz .adaLN_cond__spectral_gfnet__glu_gated_bilinear__prompt_kernel_stub85
.adaLN_cond__spectral_gfnet__glu_gated_bilinear__prompt_kernel_back86:
    s_waitcnt lgkmcnt(5)
    v_mfma_f32_16x16x32_bf16 v[32:35], v[12:15], v[224:227], v[32:35]
    ds_read_b128 v[8:11], v3 offset:6144
    v_mfma_f32_16x16x32_bf16 v[36:39], v[12:15], v[228:231], v[36:39]
    s_waitcnt lgkmcnt(5)
    v_mfma_f32_16x16x32_bf16 v[64:67], v[16:19], v[224:227], v[64:67]
    ds_read_b128 v[12:15], v3 offset:7168
    v_mfma_f32_16x16x32_bf16 v[68:71], v[16:19], v[228:231], v[68:71]
    s_waitcnt lgkmcnt(5)
    v_mfma_f32_16x16x32_bf16 v[40:43], v[20:23], v[224:227], v[40:43]
    ds_read_b128 v[16:19], v3 offset:8192
    v_mfma_f32_16x16x32_bf16 v[44:47], v[20:23], v[228:231], v[44:47]
    s_waitcnt lgkmcnt(5)
    v_mfma_f32_16x16x32_bf16 v[72:75], v[24:27], v[224:227], v[72:75]
    ds_read_b128 v[20:23], v3 offset:9216
    v_mfma_f32_16x16x32_bf16 v[76:79], v[24:27], v[228:231], v[76:79]
    s_waitcnt lgkmcnt(5)
    v_mfma_f32_16x16x32_bf16 v[48:51], v[28:31], v[224:227], v[48:51]
    ds_read_b128 v[24:27], v3 offset:10240
    v_mfma_f32_16x16x32_bf16 v[52:55], v[28:31], v[228:231], v[52:55]
    s_waitcnt lgkmcnt(5)
    v_mfma_f32_16x16x32_bf16 v[80:83], v[4:7], v[224:227], v[80:83]
    ds_read_b128 v[28:31], v3 offset:11264
    v_mfma_f32_16x16x32_bf16 v[84:87], v[4:7], v[228:231], v[84:87]
    s_waitcnt vmcnt(4)
    v_bitop3_b32 v0, v232, v236, 1 bitop3:0xa8
    s_waitcnt lgkmcnt(5)
    v_mfma_f32_16x16x32_bf16 v[56:59], v[8:11], v[224:227], v[56:59]
    ds_read_b128 v[4:7], v3 offset:12288
    v_mfma_f32_16x16x32_bf16 v[60:63], v[8:11], v[228:231], v[60:63]
    v_cmp_eq_u32 vcc, 1, v0
    s_waitcnt lgkmcnt(5)
    v_mfma_f32_16x16x32_bf16 v[88:91], v[12:15], v[224:227], v[88:91]
    ds_read_b128 v[8:11], v3 offset:13312
    v_mfma_f32_16x16x32_bf16 v[92:95], v[12:15], v[228:231], v[92:95]
    s_cbranch_vccnz .adaLN_cond__spectral_gfnet__glu_gated_bilinear__prompt_kernel_stub87
.adaLN_cond__spectral_gfnet__glu_gated_bilinear__prompt_kernel_back88:
    s_waitcnt lgkmcnt(5)
    v_mfma_f32_16x16x32_bf16 v[32:35], v[16:19], v[232:235], v[32:35]
    ds_read_b128 v[12:15], v3 offset:14336
    v_mfma_f32_16x16x32_bf16 v[36:39], v[16:19], v[236:239], v[36:39]
    s_waitcnt lgkmcnt(5)
    v_mfma_f32_16x16x32_bf16 v[64:67], v[20:23], v[232:235], v[64:67]
    ds_read_b128 v[16:19], v3 offset:15360
    v_mfma_f32_16x16x32_bf16 v[68:71], v[20:23], v[236:239], v[68:71]
    s_waitcnt lgkmcnt(5)
    v_mfma_f32_16x16x32_bf16 v[40:43], v[24:27], v[232:235], v[40:43]
    ds_read_b128 v[20:23], v3 offset:16384
    v_mfma_f32_16x16x32_bf16 v[44:47], v[24:27], v[236:239], v[44:47]
    s_waitcnt lgkmcnt(5)
    v_mfma_f32_16x16x32_bf16 v[72:75], v[28:31], v[232:235], v[72:75]
    ds_read_b128 v[24:27], v3 offset:17408
    v_mfma_f32_16x16x32_bf16 v[76:79], v[28:31], v[236:239], v[76:79]
    s_barrier
    s_waitcnt lgkmcnt(5)
    v_mfma_f32_16x16x32_bf16 v[48:51], v[4:7], v[232:235], v[48:51]
    ds_read_b128 v[28:31], v3 offset:18432
    v_mfma_f32_16x16x32_bf16 v[52:55], v[4:7], v[236:239], v[52:55]
    s_waitcnt lgkmcnt(5)
    v_mfma_f32_16x16x32_bf16 v[80:83], v[8:11], v[232:235], v[80:83]
    ds_read_b128 v[4:7], v3 offset:19456
    v_mfma_f32_16x16x32_bf16 v[84:87], v[8:11], v[236:239], v[84:87]
    s_waitcnt vmcnt(2)
    v_bitop3_b32 v0, v240, v244, 1 bitop3:0xa8
    s_waitcnt lgkmcnt(5)
    v_mfma_f32_16x16x32_bf16 v[56:59], v[12:15], v[232:235], v[56:59]
    ds_read_b128 v[8:11], v3 offset:20480
    v_mfma_f32_16x16x32_bf16 v[60:63], v[12:15], v[236:239], v[60:63]
    v_cmp_eq_u32 vcc, 1, v0
    s_waitcnt lgkmcnt(5)
    v_mfma_f32_16x16x32_bf16 v[88:91], v[16:19], v[232:235], v[88:91]
    ds_read_b128 v[12:15], v3 offset:21504
    v_mfma_f32_16x16x32_bf16 v[92:95], v[16:19], v[236:239], v[92:95]
    s_cbranch_vccnz .adaLN_cond__spectral_gfnet__glu_gated_bilinear__prompt_kernel_stub89
.adaLN_cond__spectral_gfnet__glu_gated_bilinear__prompt_kernel_back90:
    s_waitcnt lgkmcnt(5)
    v_mfma_f32_16x16x32_bf16 v[32:35], v[20:23], v[240:243], v[32:35]
    ds_read_b128 v[16:19], v3 offset:22528
    v_mfma_f32_16x16x32_bf16 v[36:39], v[20:23], v[244:247], v[36:39]
    s_waitcnt lgkmcnt(5)
    v_mfma_f32_16x16x32_bf16 v[64:67], v[24:27], v[240:243], v[64:67]
    ds_read_b128 v[20:23], v3 offset:23552
    v_mfma_f32_16x16x32_bf16 v[68:71], v[24:27], v[244:247], v[68:71]
    s_waitcnt lgkmcnt(5)
    v_mfma_f32_16x16x32_bf16 v[40:43], v[28:31], v[240:243], v[40:43]
    ds_read_b128 v[24:27], v3 offset:24576
    v_mfma_f32_16x16x32_bf16 v[44:47], v[28:31], v[244:247], v[44:47]
    s_waitcnt lgkmcnt(5)
    v_mfma_f32_16x16x32_bf16 v[72:75], v[4:7], v[240:243], v[72:75]
    ds_read_b128 v[28:31], v3 offset:25600
    v_mfma_f32_16x16x32_bf16 v[76:79], v[4:7], v[244:247], v[76:79]
    s_waitcnt lgkmcnt(5)
    v_mfma_f32_16x16x32_bf16 v[48:51], v[8:11], v[240:243], v[48:51]
    ds_read_b128 v[4:7], v3 offset:26624
    v_mfma_f32_16x16x32_bf16 v[52:55], v[8:11], v[244:247], v[52:55]
    s_waitcnt lgkmcnt(5)
    v_mfma_f32_16x16x32_bf16 v[80:83], v[12:15], v[240:243], v[80:83]
    ds_read_b128 v[8:11], v3 offset:27648
    v_mfma_f32_16x16x32_bf16 v[84:87], v[12:15], v[244:247], v[84:87]
    s_waitcnt vmcnt(0)
    v_bitop3_b32 v0, v248, v252, 1 bitop3:0xa8
    s_waitcnt lgkmcnt(5)
    v_mfma_f32_16x16x32_bf16 v[56:59], v[16:19], v[240:243], v[56:59]
    ds_read_b128 v[12:15], v3 offset:28672
    v_mfma_f32_16x16x32_bf16 v[60:63], v[16:19], v[244:247], v[60:63]
    v_cmp_eq_u32 vcc, 1, v0
    s_waitcnt lgkmcnt(5)
    v_mfma_f32_16x16x32_bf16 v[88:91], v[20:23], v[240:243], v[88:91]
    ds_read_b128 v[16:19], v3 offset:29696
    v_mfma_f32_16x16x32_bf16 v[92:95], v[20:23], v[244:247], v[92:95]
    s_cbranch_vccnz .adaLN_cond__spectral_gfnet__glu_gated_bilinear__prompt_kernel_stub91
.adaLN_cond__spectral_gfnet__glu_gated_bilinear__prompt_kernel_back92:
    s_waitcnt lgkmcnt(5)
    v_mfma_f32_16x16x32_bf16 v[32:35], v[24:27], v[248:251], v[32:35]
    ds_read_b128 v[20:23], v3 offset:30720
    v_mfma_f32_16x16x32_bf16 v[36:39], v[24:27], v[252:255], v[36:39]
    s_waitcnt lgkmcnt(5)
    v_mfma_f32_16x16x32_bf16 v[64:67], v[28:31], v[248:251], v[64:67]
    ds_read_b128 v[24:27], v3 offset:31744
    v_mfma_f32_16x16x32_bf16 v[68:71], v[28:31], v[252:255], v[68:71]
    s_waitcnt lgkmcnt(5)
    v_mfma_f32_16x16x32_bf16 v[40:43], v[4:7], v[248:251], v[40:43]
    ds_read_b128 v[28:31], v1 offset:0
    v_mfma_f32_16x16x32_bf16 v[44:47], v[4:7], v[252:255], v[44:47]
    s_waitcnt lgkmcnt(5)
    v_mfma_f32_16x16x32_bf16 v[72:75], v[8:11], v[248:251], v[72:75]
    ds_read_b128 v[4:7], v1 offset:1024
    v_mfma_f32_16x16x32_bf16 v[76:79], v[8:11], v[252:255], v[76:79]
    s_waitcnt lgkmcnt(5)
    v_mfma_f32_16x16x32_bf16 v[48:51], v[12:15], v[248:251], v[48:51]
    ds_read_b128 v[8:11], v1 offset:2048
    v_mfma_f32_16x16x32_bf16 v[52:55], v[12:15], v[252:255], v[52:55]
    s_waitcnt lgkmcnt(5)
    v_mfma_f32_16x16x32_bf16 v[80:83], v[16:19], v[248:251], v[80:83]
    ds_read_b128 v[12:15], v1 offset:3072
    v_mfma_f32_16x16x32_bf16 v[84:87], v[16:19], v[252:255], v[84:87]
    s_waitcnt lgkmcnt(5)
    v_mfma_f32_16x16x32_bf16 v[56:59], v[20:23], v[248:251], v[56:59]
    ds_read_b128 v[16:19], v1 offset:4096
    v_mfma_f32_16x16x32_bf16 v[60:63], v[20:23], v[252:255], v[60:63]
    s_waitcnt lgkmcnt(5)
    v_mfma_f32_16x16x32_bf16 v[88:91], v[24:27], v[248:251], v[88:91]
    ds_read_b128 v[20:23], v1 offset:5120
    v_mfma_f32_16x16x32_bf16 v[92:95], v[24:27], v[252:255], v[92:95]
    v_pk_mul_f32 v[32:33], v[32:33], v[64:65]
    v_pk_mul_f32 v[34:35], v[34:35], v[66:67]
    v_pk_mul_f32 v[36:37], v[36:37], v[68:69]
    v_pk_mul_f32 v[38:39], v[38:39], v[70:71]
    v_pk_mul_f32 v[40:41], v[40:41], v[72:73]
    v_pk_mul_f32 v[42:43], v[42:43], v[74:75]
    v_pk_mul_f32 v[44:45], v[44:45], v[76:77]
    v_pk_mul_f32 v[46:47], v[46:47], v[78:79]
    v_pk_mul_f32 v[48:49], v[48:49], v[80:81]
    v_pk_mul_f32 v[50:51], v[50:51], v[82:83]
    v_pk_mul_f32 v[52:53], v[52:53], v[84:85]
    v_pk_mul_f32 v[54:55], v[54:55], v[86:87]
    v_pk_mul_f32 v[56:57], v[56:57], v[88:89]
    v_pk_mul_f32 v[58:59], v[58:59], v[90:91]
    v_pk_mul_f32 v[60:61], v[60:61], v[92:93]
    v_pk_mul_f32 v[62:63], v[62:63], v[94:95]
    s_barrier
    s_waitcnt lgkmcnt(5)
    v_mfma_f32_16x16x32_bf16 v[64:67], v[28:31], v[96:99], 0
    ds_read_b128 v[24:27], v1 offset:6144
    v_mfma_f32_16x16x32_bf16 v[68:71], v[28:31], v[100:103], 0
    v_add_u32 v0, s43, v1
    s_waitcnt lgkmcnt(5)
    v_mfma_f32_16x16x32_bf16 v[80:83], v[4:7], v[96:99], 0
    ds_read_b128 v[28:31], v1 offset:7168
    v_mfma_f32_16x16x32_bf16 v[84:87], v[4:7], v[100:103], 0
    v_cvt_pk_bf16_f32 v32, v32, v33
    s_waitcnt lgkmcnt(5)
    v_mfma_f32_16x16x32_bf16 v[72:75], v[8:11], v[96:99], 0
    ds_read_b128 v[4:7], v1 offset:8192
    v_mfma_f32_16x16x32_bf16 v[76:79], v[8:11], v[100:103], 0
    v_cvt_pk_bf16_f32 v33, v34, v35
    s_waitcnt lgkmcnt(5)
    v_mfma_f32_16x16x32_bf16 v[88:91], v[12:15], v[96:99], 0
    ds_read_b128 v[8:11], v1 offset:9216
    v_mfma_f32_16x16x32_bf16 v[92:95], v[12:15], v[100:103], 0
    v_cvt_pk_bf16_f32 v34, v40, v41
    s_waitcnt lgkmcnt(5)
    v_mfma_f32_16x16x32_bf16 v[64:67], v[16:19], v[104:107], v[64:67]
    ds_read_b128 v[12:15], v1 offset:10240
    v_mfma_f32_16x16x32_bf16 v[68:71], v[16:19], v[108:111], v[68:71]
    v_cvt_pk_bf16_f32 v35, v42, v43
    s_waitcnt lgkmcnt(5)
    v_mfma_f32_16x16x32_bf16 v[80:83], v[20:23], v[104:107], v[80:83]
    ds_read_b128 v[16:19], v1 offset:11264
    v_mfma_f32_16x16x32_bf16 v[84:87], v[20:23], v[108:111], v[84:87]
    global_store_dwordx4 v0, v[32:35], s[16:17] offset:0 sc1
    s_waitcnt lgkmcnt(5)
    v_mfma_f32_16x16x32_bf16 v[72:75], v[24:27], v[104:107], v[72:75]
    ds_read_b128 v[20:23], v1 offset:12288
    v_mfma_f32_16x16x32_bf16 v[76:79], v[24:27], v[108:111], v[76:79]
    v_cvt_pk_bf16_f32 v36, v36, v37
    s_waitcnt lgkmcnt(5)
    v_mfma_f32_16x16x32_bf16 v[88:91], v[28:31], v[104:107], v[88:91]
    ds_read_b128 v[24:27], v1 offset:13312
    v_mfma_f32_16x16x32_bf16 v[92:95], v[28:31], v[108:111], v[92:95]
    v_cvt_pk_bf16_f32 v37, v38, v39
    s_waitcnt lgkmcnt(5)
    v_mfma_f32_16x16x32_bf16 v[64:67], v[4:7], v[112:115], v[64:67]
    ds_read_b128 v[28:31], v1 offset:14336
    v_mfma_f32_16x16x32_bf16 v[68:71], v[4:7], v[116:119], v[68:71]
    v_cvt_pk_bf16_f32 v38, v44, v45
    s_waitcnt lgkmcnt(5)
    v_mfma_f32_16x16x32_bf16 v[80:83], v[8:11], v[112:115], v[80:83]
    ds_read_b128 v[4:7], v1 offset:15360
    v_mfma_f32_16x16x32_bf16 v[84:87], v[8:11], v[116:119], v[84:87]
    v_cvt_pk_bf16_f32 v39, v46, v47
    s_waitcnt lgkmcnt(5)
    v_mfma_f32_16x16x32_bf16 v[72:75], v[12:15], v[112:115], v[72:75]
    ds_read_b128 v[8:11], v1 offset:16384
    v_mfma_f32_16x16x32_bf16 v[76:79], v[12:15], v[116:119], v[76:79]
    global_store_dwordx4 v0, v[36:39], s[18:19] offset:0 sc1
    s_waitcnt lgkmcnt(5)
    v_mfma_f32_16x16x32_bf16 v[88:91], v[16:19], v[112:115], v[88:91]
    ds_read_b128 v[12:15], v1 offset:17408
    v_mfma_f32_16x16x32_bf16 v[92:95], v[16:19], v[116:119], v[92:95]
    v_cvt_pk_bf16_f32 v48, v48, v49
    s_waitcnt lgkmcnt(5)
    v_mfma_f32_16x16x32_bf16 v[64:67], v[20:23], v[120:123], v[64:67]
    ds_read_b128 v[16:19], v1 offset:18432
    v_mfma_f32_16x16x32_bf16 v[68:71], v[20:23], v[124:127], v[68:71]
    v_cvt_pk_bf16_f32 v49, v50, v51
    s_waitcnt lgkmcnt(5)
    v_mfma_f32_16x16x32_bf16 v[80:83], v[24:27], v[120:123], v[80:83]
    ds_read_b128 v[20:23], v1 offset:19456
    v_mfma_f32_16x16x32_bf16 v[84:87], v[24:27], v[124:127], v[84:87]
    v_cvt_pk_bf16_f32 v50, v56, v57
    s_waitcnt lgkmcnt(5)
    v_mfma_f32_16x16x32_bf16 v[72:75], v[28:31], v[120:123], v[72:75]
    ds_read_b128 v[24:27], v1 offset:20480
    v_mfma_f32_16x16x32_bf16 v[76:79], v[28:31], v[124:127], v[76:79]
    v_cvt_pk_bf16_f32 v51, v58, v59
    s_waitcnt lgkmcnt(5)
    v_mfma_f32_16x16x32_bf16 v[88:91], v[4:7], v[120:123], v[88:91]
    ds_read_b128 v[28:31], v1 offset:21504
    v_mfma_f32_16x16x32_bf16 v[92:95], v[4:7], v[124:127], v[92:95]
    global_store_dwordx4 v0, v[48:51], s[16:17] offset:1024 sc1
    s_waitcnt lgkmcnt(5)
    v_mfma_f32_16x16x32_bf16 v[64:67], v[8:11], v[128:131], v[64:67]
    ds_read_b128 v[4:7], v1 offset:22528
    v_mfma_f32_16x16x32_bf16 v[68:71], v[8:11], v[132:135], v[68:71]
    v_cvt_pk_bf16_f32 v52, v52, v53
    s_waitcnt lgkmcnt(5)
    v_mfma_f32_16x16x32_bf16 v[80:83], v[12:15], v[128:131], v[80:83]
    ds_read_b128 v[8:11], v1 offset:23552
    v_mfma_f32_16x16x32_bf16 v[84:87], v[12:15], v[132:135], v[84:87]
    v_cvt_pk_bf16_f32 v53, v54, v55
    s_waitcnt lgkmcnt(5)
    v_mfma_f32_16x16x32_bf16 v[72:75], v[16:19], v[128:131], v[72:75]
    ds_read_b128 v[12:15], v1 offset:24576
    v_mfma_f32_16x16x32_bf16 v[76:79], v[16:19], v[132:135], v[76:79]
    v_cvt_pk_bf16_f32 v54, v60, v61
    s_waitcnt lgkmcnt(5)
    v_mfma_f32_16x16x32_bf16 v[88:91], v[20:23], v[128:131], v[88:91]
    ds_read_b128 v[16:19], v1 offset:25600
    v_mfma_f32_16x16x32_bf16 v[92:95], v[20:23], v[132:135], v[92:95]
    v_cvt_pk_bf16_f32 v55, v62, v63
    s_barrier
    s_waitcnt lgkmcnt(5)
    v_mfma_f32_16x16x32_bf16 v[64:67], v[24:27], v[136:139], v[64:67]
    ds_read_b128 v[20:23], v1 offset:26624
    v_mfma_f32_16x16x32_bf16 v[68:71], v[24:27], v[140:143], v[68:71]
    global_store_dwordx4 v0, v[52:55], s[18:19] offset:1024 sc1
    s_waitcnt lgkmcnt(5)
    v_mfma_f32_16x16x32_bf16 v[80:83], v[28:31], v[136:139], v[80:83]
    ds_read_b128 v[24:27], v1 offset:27648
    v_mfma_f32_16x16x32_bf16 v[84:87], v[28:31], v[140:143], v[84:87]
    s_waitcnt lgkmcnt(5)
    v_mfma_f32_16x16x32_bf16 v[72:75], v[4:7], v[136:139], v[72:75]
    ds_read_b128 v[28:31], v1 offset:28672
    v_mfma_f32_16x16x32_bf16 v[76:79], v[4:7], v[140:143], v[76:79]
    s_waitcnt lgkmcnt(5)
    v_mfma_f32_16x16x32_bf16 v[88:91], v[8:11], v[136:139], v[88:91]
    ds_read_b128 v[4:7], v1 offset:29696
    v_mfma_f32_16x16x32_bf16 v[92:95], v[8:11], v[140:143], v[92:95]
    s_waitcnt lgkmcnt(5)
    v_mfma_f32_16x16x32_bf16 v[64:67], v[12:15], v[144:147], v[64:67]
    ds_read_b128 v[8:11], v1 offset:30720
    v_mfma_f32_16x16x32_bf16 v[68:71], v[12:15], v[148:151], v[68:71]
    s_waitcnt lgkmcnt(5)
    v_mfma_f32_16x16x32_bf16 v[80:83], v[16:19], v[144:147], v[80:83]
    ds_read_b128 v[12:15], v1 offset:31744
    v_mfma_f32_16x16x32_bf16 v[84:87], v[16:19], v[148:151], v[84:87]
    s_waitcnt lgkmcnt(5)
    v_mfma_f32_16x16x32_bf16 v[72:75], v[20:23], v[144:147], v[72:75]
    ds_read_b128 v[16:19], v1 offset:32768
    v_mfma_f32_16x16x32_bf16 v[76:79], v[20:23], v[148:151], v[76:79]
    s_waitcnt lgkmcnt(5)
    v_mfma_f32_16x16x32_bf16 v[88:91], v[24:27], v[144:147], v[88:91]
    ds_read_b128 v[20:23], v1 offset:33792
    v_mfma_f32_16x16x32_bf16 v[92:95], v[24:27], v[148:151], v[92:95]
    s_waitcnt lgkmcnt(5)
    v_mfma_f32_16x16x32_bf16 v[64:67], v[28:31], v[152:155], v[64:67]
    ds_read_b128 v[24:27], v1 offset:34816
    v_mfma_f32_16x16x32_bf16 v[68:71], v[28:31], v[156:159], v[68:71]
    s_waitcnt lgkmcnt(5)
    v_mfma_f32_16x16x32_bf16 v[80:83], v[4:7], v[152:155], v[80:83]
    ds_read_b128 v[28:31], v1 offset:35840
    v_mfma_f32_16x16x32_bf16 v[84:87], v[4:7], v[156:159], v[84:87]
    s_waitcnt lgkmcnt(5)
    v_mfma_f32_16x16x32_bf16 v[72:75], v[8:11], v[152:155], v[72:75]
    ds_read_b128 v[4:7], v1 offset:36864
    v_mfma_f32_16x16x32_bf16 v[76:79], v[8:11], v[156:159], v[76:79]
    s_waitcnt lgkmcnt(5)
    v_mfma_f32_16x16x32_bf16 v[88:91], v[12:15], v[152:155], v[88:91]
    ds_read_b128 v[8:11], v1 offset:37888
    v_mfma_f32_16x16x32_bf16 v[92:95], v[12:15], v[156:159], v[92:95]
    s_waitcnt lgkmcnt(5)
    v_mfma_f32_16x16x32_bf16 v[64:67], v[16:19], v[160:163], v[64:67]
    ds_read_b128 v[12:15], v1 offset:38912
    v_mfma_f32_16x16x32_bf16 v[68:71], v[16:19], v[164:167], v[68:71]
    s_waitcnt lgkmcnt(5)
    v_mfma_f32_16x16x32_bf16 v[80:83], v[20:23], v[160:163], v[80:83]
    ds_read_b128 v[16:19], v1 offset:39936
    v_mfma_f32_16x16x32_bf16 v[84:87], v[20:23], v[164:167], v[84:87]
    s_waitcnt lgkmcnt(5)
    v_mfma_f32_16x16x32_bf16 v[72:75], v[24:27], v[160:163], v[72:75]
    ds_read_b128 v[20:23], v1 offset:40960
    v_mfma_f32_16x16x32_bf16 v[76:79], v[24:27], v[164:167], v[76:79]
    s_waitcnt lgkmcnt(5)
    v_mfma_f32_16x16x32_bf16 v[88:91], v[28:31], v[160:163], v[88:91]
    ds_read_b128 v[24:27], v1 offset:41984
    v_mfma_f32_16x16x32_bf16 v[92:95], v[28:31], v[164:167], v[92:95]
    s_waitcnt lgkmcnt(5)
    v_mfma_f32_16x16x32_bf16 v[64:67], v[4:7], v[168:171], v[64:67]
    ds_read_b128 v[28:31], v1 offset:43008
    v_mfma_f32_16x16x32_bf16 v[68:71], v[4:7], v[172:175], v[68:71]
    s_waitcnt lgkmcnt(5)
    v_mfma_f32_16x16x32_bf16 v[80:83], v[8:11], v[168:171], v[80:83]
    ds_read_b128 v[4:7], v1 offset:44032
    v_mfma_f32_16x16x32_bf16 v[84:87], v[8:11], v[172:175], v[84:87]
    s_waitcnt lgkmcnt(5)
    v_mfma_f32_16x16x32_bf16 v[72:75], v[12:15], v[168:171], v[72:75]
    ds_read_b128 v[8:11], v1 offset:45056
    v_mfma_f32_16x16x32_bf16 v[76:79], v[12:15], v[172:175], v[76:79]
    s_waitcnt lgkmcnt(5)
    v_mfma_f32_16x16x32_bf16 v[88:91], v[16:19], v[168:171], v[88:91]
    ds_read_b128 v[12:15], v1 offset:46080
    v_mfma_f32_16x16x32_bf16 v[92:95], v[16:19], v[172:175], v[92:95]
    s_barrier
    s_waitcnt lgkmcnt(5)
    v_mfma_f32_16x16x32_bf16 v[64:67], v[20:23], v[176:179], v[64:67]
    ds_read_b128 v[16:19], v1 offset:47104
    v_mfma_f32_16x16x32_bf16 v[68:71], v[20:23], v[180:183], v[68:71]
    s_waitcnt lgkmcnt(5)
    v_mfma_f32_16x16x32_bf16 v[80:83], v[24:27], v[176:179], v[80:83]
    ds_read_b128 v[20:23], v1 offset:48128
    v_mfma_f32_16x16x32_bf16 v[84:87], v[24:27], v[180:183], v[84:87]
    s_waitcnt lgkmcnt(5)
    v_mfma_f32_16x16x32_bf16 v[72:75], v[28:31], v[176:179], v[72:75]
    ds_read_b128 v[24:27], v1 offset:49152
    v_mfma_f32_16x16x32_bf16 v[76:79], v[28:31], v[180:183], v[76:79]
    s_waitcnt lgkmcnt(5)
    v_mfma_f32_16x16x32_bf16 v[88:91], v[4:7], v[176:179], v[88:91]
    ds_read_b128 v[28:31], v1 offset:50176
    v_mfma_f32_16x16x32_bf16 v[92:95], v[4:7], v[180:183], v[92:95]
    s_waitcnt lgkmcnt(5)
    v_mfma_f32_16x16x32_bf16 v[64:67], v[8:11], v[184:187], v[64:67]
    ds_read_b128 v[4:7], v1 offset:51200
    v_mfma_f32_16x16x32_bf16 v[68:71], v[8:11], v[188:191], v[68:71]
    s_waitcnt lgkmcnt(5)
    v_mfma_f32_16x16x32_bf16 v[80:83], v[12:15], v[184:187], v[80:83]
    ds_read_b128 v[8:11], v1 offset:52224
    v_mfma_f32_16x16x32_bf16 v[84:87], v[12:15], v[188:191], v[84:87]
    s_waitcnt lgkmcnt(5)
    v_mfma_f32_16x16x32_bf16 v[72:75], v[16:19], v[184:187], v[72:75]
    ds_read_b128 v[12:15], v1 offset:53248
    v_mfma_f32_16x16x32_bf16 v[76:79], v[16:19], v[188:191], v[76:79]
    s_waitcnt lgkmcnt(5)
    v_mfma_f32_16x16x32_bf16 v[88:91], v[20:23], v[184:187], v[88:91]
    ds_read_b128 v[16:19], v1 offset:54272
    v_mfma_f32_16x16x32_bf16 v[92:95], v[20:23], v[188:191], v[92:95]
    s_waitcnt lgkmcnt(5)
    v_mfma_f32_16x16x32_bf16 v[64:67], v[24:27], v[192:195], v[64:67]
    ds_read_b128 v[20:23], v1 offset:55296
    v_mfma_f32_16x16x32_bf16 v[68:71], v[24:27], v[196:199], v[68:71]
    s_waitcnt lgkmcnt(5)
    v_mfma_f32_16x16x32_bf16 v[80:83], v[28:31], v[192:195], v[80:83]
    ds_read_b128 v[24:27], v1 offset:56320
    v_mfma_f32_16x16x32_bf16 v[84:87], v[28:31], v[196:199], v[84:87]
    s_waitcnt lgkmcnt(5)
    v_mfma_f32_16x16x32_bf16 v[72:75], v[4:7], v[192:195], v[72:75]
    ds_read_b128 v[28:31], v1 offset:57344
    v_mfma_f32_16x16x32_bf16 v[76:79], v[4:7], v[196:199], v[76:79]
    s_waitcnt lgkmcnt(5)
    v_mfma_f32_16x16x32_bf16 v[88:91], v[8:11], v[192:195], v[88:91]
    ds_read_b128 v[4:7], v1 offset:58368
    v_mfma_f32_16x16x32_bf16 v[92:95], v[8:11], v[196:199], v[92:95]
    s_waitcnt lgkmcnt(5)
    v_mfma_f32_16x16x32_bf16 v[64:67], v[12:15], v[200:203], v[64:67]
    ds_read_b128 v[8:11], v1 offset:59392
    v_mfma_f32_16x16x32_bf16 v[68:71], v[12:15], v[204:207], v[68:71]
    s_waitcnt lgkmcnt(5)
    v_mfma_f32_16x16x32_bf16 v[80:83], v[16:19], v[200:203], v[80:83]
    ds_read_b128 v[12:15], v1 offset:60416
    v_mfma_f32_16x16x32_bf16 v[84:87], v[16:19], v[204:207], v[84:87]
    s_waitcnt lgkmcnt(5)
    v_mfma_f32_16x16x32_bf16 v[72:75], v[20:23], v[200:203], v[72:75]
    ds_read_b128 v[16:19], v1 offset:61440
    v_mfma_f32_16x16x32_bf16 v[76:79], v[20:23], v[204:207], v[76:79]
    s_waitcnt lgkmcnt(5)
    v_mfma_f32_16x16x32_bf16 v[88:91], v[24:27], v[200:203], v[88:91]
    ds_read_b128 v[20:23], v1 offset:62464
    v_mfma_f32_16x16x32_bf16 v[92:95], v[24:27], v[204:207], v[92:95]
    s_waitcnt lgkmcnt(5)
    v_mfma_f32_16x16x32_bf16 v[64:67], v[28:31], v[208:211], v[64:67]
    ds_read_b128 v[24:27], v1 offset:63488
    v_mfma_f32_16x16x32_bf16 v[68:71], v[28:31], v[212:215], v[68:71]
    s_waitcnt lgkmcnt(5)
    v_mfma_f32_16x16x32_bf16 v[80:83], v[4:7], v[208:211], v[80:83]
    ds_read_b128 v[28:31], v1 offset:64512
    v_mfma_f32_16x16x32_bf16 v[84:87], v[4:7], v[212:215], v[84:87]
    s_waitcnt lgkmcnt(5)
    v_mfma_f32_16x16x32_bf16 v[72:75], v[8:11], v[208:211], v[72:75]
    ds_read_b128 v[4:7], v2 offset:0
    v_mfma_f32_16x16x32_bf16 v[76:79], v[8:11], v[212:215], v[76:79]
    s_waitcnt lgkmcnt(5)
    v_mfma_f32_16x16x32_bf16 v[88:91], v[12:15], v[208:211], v[88:91]
    ds_read_b128 v[8:11], v2 offset:1024
    v_mfma_f32_16x16x32_bf16 v[92:95], v[12:15], v[212:215], v[92:95]
    s_barrier
    s_waitcnt lgkmcnt(5)
    v_mfma_f32_16x16x32_bf16 v[64:67], v[16:19], v[216:219], v[64:67]
    ds_read_b128 v[12:15], v2 offset:2048
    v_mfma_f32_16x16x32_bf16 v[68:71], v[16:19], v[220:223], v[68:71]
    s_waitcnt lgkmcnt(5)
    v_mfma_f32_16x16x32_bf16 v[80:83], v[20:23], v[216:219], v[80:83]
    ds_read_b128 v[16:19], v2 offset:3072
    v_mfma_f32_16x16x32_bf16 v[84:87], v[20:23], v[220:223], v[84:87]
    s_waitcnt lgkmcnt(5)
    v_mfma_f32_16x16x32_bf16 v[72:75], v[24:27], v[216:219], v[72:75]
    ds_read_b128 v[20:23], v2 offset:4096
    v_mfma_f32_16x16x32_bf16 v[76:79], v[24:27], v[220:223], v[76:79]
    s_waitcnt lgkmcnt(5)
    v_mfma_f32_16x16x32_bf16 v[88:91], v[28:31], v[216:219], v[88:91]
    ds_read_b128 v[24:27], v2 offset:5120
    v_mfma_f32_16x16x32_bf16 v[92:95], v[28:31], v[220:223], v[92:95]
    s_waitcnt lgkmcnt(5)
    v_mfma_f32_16x16x32_bf16 v[64:67], v[4:7], v[224:227], v[64:67]
    ds_read_b128 v[28:31], v2 offset:6144
    v_mfma_f32_16x16x32_bf16 v[68:71], v[4:7], v[228:231], v[68:71]
    s_waitcnt lgkmcnt(5)
    v_mfma_f32_16x16x32_bf16 v[80:83], v[8:11], v[224:227], v[80:83]
    ds_read_b128 v[4:7], v2 offset:7168
    v_mfma_f32_16x16x32_bf16 v[84:87], v[8:11], v[228:231], v[84:87]
    s_waitcnt lgkmcnt(5)
    v_mfma_f32_16x16x32_bf16 v[72:75], v[12:15], v[224:227], v[72:75]
    ds_read_b128 v[8:11], v2 offset:8192
    v_mfma_f32_16x16x32_bf16 v[76:79], v[12:15], v[228:231], v[76:79]
    s_waitcnt lgkmcnt(5)
    v_mfma_f32_16x16x32_bf16 v[88:91], v[16:19], v[224:227], v[88:91]
    ds_read_b128 v[12:15], v2 offset:9216
    v_mfma_f32_16x16x32_bf16 v[92:95], v[16:19], v[228:231], v[92:95]
    s_waitcnt lgkmcnt(5)
    v_mfma_f32_16x16x32_bf16 v[64:67], v[20:23], v[232:235], v[64:67]
    ds_read_b128 v[16:19], v2 offset:10240
    v_mfma_f32_16x16x32_bf16 v[68:71], v[20:23], v[236:239], v[68:71]
    s_waitcnt lgkmcnt(5)
    v_mfma_f32_16x16x32_bf16 v[80:83], v[24:27], v[232:235], v[80:83]
    ds_read_b128 v[20:23], v2 offset:11264
    v_mfma_f32_16x16x32_bf16 v[84:87], v[24:27], v[236:239], v[84:87]
    s_waitcnt lgkmcnt(5)
    v_mfma_f32_16x16x32_bf16 v[72:75], v[28:31], v[232:235], v[72:75]
    ds_read_b128 v[24:27], v2 offset:12288
    v_mfma_f32_16x16x32_bf16 v[76:79], v[28:31], v[236:239], v[76:79]
    s_waitcnt lgkmcnt(5)
    v_mfma_f32_16x16x32_bf16 v[88:91], v[4:7], v[232:235], v[88:91]
    ds_read_b128 v[28:31], v2 offset:13312
    v_mfma_f32_16x16x32_bf16 v[92:95], v[4:7], v[236:239], v[92:95]
    s_waitcnt lgkmcnt(5)
    v_mfma_f32_16x16x32_bf16 v[64:67], v[8:11], v[240:243], v[64:67]
    ds_read_b128 v[4:7], v2 offset:14336
    v_mfma_f32_16x16x32_bf16 v[68:71], v[8:11], v[244:247], v[68:71]
    s_waitcnt lgkmcnt(5)
    v_mfma_f32_16x16x32_bf16 v[80:83], v[12:15], v[240:243], v[80:83]
    ds_read_b128 v[8:11], v2 offset:15360
    v_mfma_f32_16x16x32_bf16 v[84:87], v[12:15], v[244:247], v[84:87]
    s_waitcnt lgkmcnt(5)
    v_mfma_f32_16x16x32_bf16 v[72:75], v[16:19], v[240:243], v[72:75]
    ds_read_b128 v[12:15], v2 offset:16384
    v_mfma_f32_16x16x32_bf16 v[76:79], v[16:19], v[244:247], v[76:79]
    s_waitcnt lgkmcnt(5)
    v_mfma_f32_16x16x32_bf16 v[88:91], v[20:23], v[240:243], v[88:91]
    ds_read_b128 v[16:19], v2 offset:17408
    v_mfma_f32_16x16x32_bf16 v[92:95], v[20:23], v[244:247], v[92:95]
    s_waitcnt lgkmcnt(5)
    v_mfma_f32_16x16x32_bf16 v[64:67], v[24:27], v[248:251], v[64:67]
    ds_read_b128 v[20:23], v2 offset:18432
    v_mfma_f32_16x16x32_bf16 v[68:71], v[24:27], v[252:255], v[68:71]
    s_waitcnt lgkmcnt(5)
    v_mfma_f32_16x16x32_bf16 v[80:83], v[28:31], v[248:251], v[80:83]
    ds_read_b128 v[24:27], v2 offset:19456
    v_mfma_f32_16x16x32_bf16 v[84:87], v[28:31], v[252:255], v[84:87]
    s_waitcnt lgkmcnt(5)
    v_mfma_f32_16x16x32_bf16 v[72:75], v[4:7], v[248:251], v[72:75]
    ds_read_b128 v[28:31], v2 offset:20480
    v_mfma_f32_16x16x32_bf16 v[76:79], v[4:7], v[252:255], v[76:79]
    s_waitcnt lgkmcnt(5)
    v_mfma_f32_16x16x32_bf16 v[88:91], v[8:11], v[248:251], v[88:91]
    ds_read_b128 v[4:7], v2 offset:21504
    v_mfma_f32_16x16x32_bf16 v[92:95], v[8:11], v[252:255], v[92:95]
    v_pk_mul_f32 v[64:65], v[64:65], v[80:81]
    v_pk_mul_f32 v[66:67], v[66:67], v[82:83]
    v_pk_mul_f32 v[68:69], v[68:69], v[84:85]
    v_pk_mul_f32 v[70:71], v[70:71], v[86:87]
    s_nop 1
    v_pk_mul_f32 v[72:73], v[72:73], v[88:89]
    v_pk_mul_f32 v[74:75], v[74:75], v[90:91]
    v_pk_mul_f32 v[76:77], v[76:77], v[92:93]
    v_pk_mul_f32 v[78:79], v[78:79], v[94:95]
    s_barrier
    s_waitcnt lgkmcnt(5)
    v_mfma_f32_16x16x32_bf16 v[32:35], v[12:15], v[96:99], 0
    ds_read_b128 v[8:11], v2 offset:22528
    v_mfma_f32_16x16x32_bf16 v[36:39], v[12:15], v[100:103], 0
    v_add_u32 v0, 30720, v1
    s_waitcnt lgkmcnt(5)
    v_mfma_f32_16x16x32_bf16 v[40:43], v[16:19], v[96:99], 0
    ds_read_b128 v[12:15], v2 offset:23552
    v_mfma_f32_16x16x32_bf16 v[44:47], v[16:19], v[100:103], 0
    v_cvt_pk_bf16_f32 v64, v64, v65
    s_waitcnt lgkmcnt(5)
    v_mfma_f32_16x16x32_bf16 v[32:35], v[20:23], v[104:107], v[32:35]
    ds_read_b128 v[16:19], v2 offset:24576
    v_mfma_f32_16x16x32_bf16 v[36:39], v[20:23], v[108:111], v[36:39]
    v_cvt_pk_bf16_f32 v65, v66, v67
    s_waitcnt lgkmcnt(5)
    v_mfma_f32_16x16x32_bf16 v[40:43], v[24:27], v[104:107], v[40:43]
    ds_read_b128 v[20:23], v2 offset:25600
    v_mfma_f32_16x16x32_bf16 v[44:47], v[24:27], v[108:111], v[44:47]
    v_cvt_pk_bf16_f32 v66, v72, v73
    s_waitcnt lgkmcnt(5)
    v_mfma_f32_16x16x32_bf16 v[32:35], v[28:31], v[112:115], v[32:35]
    ds_read_b128 v[24:27], v2 offset:26624
    v_mfma_f32_16x16x32_bf16 v[36:39], v[28:31], v[116:119], v[36:39]
    v_cvt_pk_bf16_f32 v67, v74, v75
    s_waitcnt lgkmcnt(5)
    v_mfma_f32_16x16x32_bf16 v[40:43], v[4:7], v[112:115], v[40:43]
    ds_read_b128 v[28:31], v2 offset:27648
    v_mfma_f32_16x16x32_bf16 v[44:47], v[4:7], v[116:119], v[44:47]
    global_store_dwordx4 v0, v[64:67], s[16:17] offset:0 sc1
    s_waitcnt lgkmcnt(5)
    v_mfma_f32_16x16x32_bf16 v[32:35], v[8:11], v[120:123], v[32:35]
    ds_read_b128 v[4:7], v2 offset:28672
    v_mfma_f32_16x16x32_bf16 v[36:39], v[8:11], v[124:127], v[36:39]
    v_cvt_pk_bf16_f32 v68, v68, v69
    s_waitcnt lgkmcnt(5)
    v_mfma_f32_16x16x32_bf16 v[40:43], v[12:15], v[120:123], v[40:43]
    ds_read_b128 v[8:11], v2 offset:29696
    v_mfma_f32_16x16x32_bf16 v[44:47], v[12:15], v[124:127], v[44:47]
    v_cvt_pk_bf16_f32 v69, v70, v71
    s_waitcnt lgkmcnt(5)
    v_mfma_f32_16x16x32_bf16 v[32:35], v[16:19], v[128:131], v[32:35]
    ds_read_b128 v[12:15], v2 offset:30720
    v_mfma_f32_16x16x32_bf16 v[36:39], v[16:19], v[132:135], v[36:39]
    v_cvt_pk_bf16_f32 v70, v76, v77
    s_waitcnt lgkmcnt(5)
    v_mfma_f32_16x16x32_bf16 v[40:43], v[20:23], v[128:131], v[40:43]
    ds_read_b128 v[16:19], v2 offset:31744
    v_mfma_f32_16x16x32_bf16 v[44:47], v[20:23], v[132:135], v[44:47]
    v_cvt_pk_bf16_f32 v71, v78, v79
    s_waitcnt lgkmcnt(5)
    v_mfma_f32_16x16x32_bf16 v[32:35], v[24:27], v[136:139], v[32:35]
    ds_read_b128 v[20:23], v2 offset:32768
    v_mfma_f32_16x16x32_bf16 v[36:39], v[24:27], v[140:143], v[36:39]
    global_store_dwordx4 v0, v[68:71], s[18:19] offset:0 sc1
    s_waitcnt lgkmcnt(5)
    v_mfma_f32_16x16x32_bf16 v[40:43], v[28:31], v[136:139], v[40:43]
    ds_read_b128 v[24:27], v2 offset:33792
    v_mfma_f32_16x16x32_bf16 v[44:47], v[28:31], v[140:143], v[44:47]
    s_waitcnt lgkmcnt(5)
    v_mfma_f32_16x16x32_bf16 v[32:35], v[4:7], v[144:147], v[32:35]
    ds_read_b128 v[28:31], v2 offset:34816
    v_mfma_f32_16x16x32_bf16 v[36:39], v[4:7], v[148:151], v[36:39]
    v_mov_b32 v97, v1
    s_waitcnt lgkmcnt(5)
    v_mfma_f32_16x16x32_bf16 v[40:43], v[8:11], v[144:147], v[40:43]
    ds_read_b128 v[4:7], v2 offset:35840
    v_mfma_f32_16x16x32_bf16 v[44:47], v[8:11], v[148:151], v[44:47]
    v_lshrrev_b32 v98, 1, v1
    s_waitcnt lgkmcnt(5)
    v_mfma_f32_16x16x32_bf16 v[32:35], v[12:15], v[152:155], v[32:35]
    ds_read_b128 v[8:11], v2 offset:36864
    v_mfma_f32_16x16x32_bf16 v[36:39], v[12:15], v[156:159], v[36:39]
    s_waitcnt lgkmcnt(5)
    v_mfma_f32_16x16x32_bf16 v[40:43], v[16:19], v[152:155], v[40:43]
    ds_read_b128 v[12:15], v2 offset:37888
    v_mfma_f32_16x16x32_bf16 v[44:47], v[16:19], v[156:159], v[44:47]
    s_waitcnt lgkmcnt(5)
    v_mfma_f32_16x16x32_bf16 v[32:35], v[20:23], v[160:163], v[32:35]
    ds_read_b128 v[16:19], v2 offset:38912
    v_mfma_f32_16x16x32_bf16 v[36:39], v[20:23], v[164:167], v[36:39]
    s_waitcnt lgkmcnt(5)
    v_mfma_f32_16x16x32_bf16 v[40:43], v[24:27], v[160:163], v[40:43]
    ds_read_b128 v[20:23], v2 offset:39936
    v_mfma_f32_16x16x32_bf16 v[44:47], v[24:27], v[164:167], v[44:47]
    s_waitcnt lgkmcnt(5)
    v_mfma_f32_16x16x32_bf16 v[32:35], v[28:31], v[168:171], v[32:35]
    ds_read_b128 v[24:27], v2 offset:40960
    v_mfma_f32_16x16x32_bf16 v[36:39], v[28:31], v[172:175], v[36:39]
    s_waitcnt lgkmcnt(5)
    v_mfma_f32_16x16x32_bf16 v[40:43], v[4:7], v[168:171], v[40:43]
    ds_read_b128 v[28:31], v2 offset:41984
    v_mfma_f32_16x16x32_bf16 v[44:47], v[4:7], v[172:175], v[44:47]
    s_barrier
    s_waitcnt lgkmcnt(5)
    v_mfma_f32_16x16x32_bf16 v[32:35], v[8:11], v[176:179], v[32:35]
    ds_read_b128 v[4:7], v2 offset:43008
    v_mfma_f32_16x16x32_bf16 v[36:39], v[8:11], v[180:183], v[36:39]
    s_waitcnt lgkmcnt(5)
    v_mfma_f32_16x16x32_bf16 v[40:43], v[12:15], v[176:179], v[40:43]
    ds_read_b128 v[8:11], v2 offset:44032
    v_mfma_f32_16x16x32_bf16 v[44:47], v[12:15], v[180:183], v[44:47]
    s_waitcnt lgkmcnt(5)
    v_mfma_f32_16x16x32_bf16 v[32:35], v[16:19], v[184:187], v[32:35]
    ds_read_b128 v[12:15], v2 offset:45056
    v_mfma_f32_16x16x32_bf16 v[36:39], v[16:19], v[188:191], v[36:39]
    s_waitcnt lgkmcnt(5)
    v_mfma_f32_16x16x32_bf16 v[40:43], v[20:23], v[184:187], v[40:43]
    ds_read_b128 v[16:19], v2 offset:46080
    v_mfma_f32_16x16x32_bf16 v[44:47], v[20:23], v[188:191], v[44:47]
    s_waitcnt lgkmcnt(5)
    v_mfma_f32_16x16x32_bf16 v[32:35], v[24:27], v[192:195], v[32:35]
    ds_read_b128 v[20:23], v2 offset:47104
    v_mfma_f32_16x16x32_bf16 v[36:39], v[24:27], v[196:199], v[36:39]
    v_add_u32 v99, 0, v97
    s_waitcnt lgkmcnt(5)
    v_mfma_f32_16x16x32_bf16 v[40:43], v[28:31], v[192:195], v[40:43]
    ds_read_b128 v[24:27], v2 offset:48128
    v_mfma_f32_16x16x32_bf16 v[44:47], v[28:31], v[196:199], v[44:47]
    global_load_dwordx4 v[100:103], v99, s[52:53] offset:-4096 sc1
    s_waitcnt lgkmcnt(5)
    v_mfma_f32_16x16x32_bf16 v[32:35], v[4:7], v[200:203], v[32:35]
    ds_read_b128 v[28:31], v2 offset:49152
    v_mfma_f32_16x16x32_bf16 v[36:39], v[4:7], v[204:207], v[36:39]
    global_load_dwordx4 v[104:107], v99, s[54:55] offset:-4096 sc1
    s_waitcnt lgkmcnt(5)
    v_mfma_f32_16x16x32_bf16 v[40:43], v[8:11], v[200:203], v[40:43]
    ds_read_b128 v[4:7], v2 offset:50176
    v_mfma_f32_16x16x32_bf16 v[44:47], v[8:11], v[204:207], v[44:47]
    global_load_dwordx4 v[108:111], v99, s[52:53] offset:-2048 sc1
    s_waitcnt lgkmcnt(5)
    v_mfma_f32_16x16x32_bf16 v[32:35], v[12:15], v[208:211], v[32:35]
    ds_read_b128 v[8:11], v2 offset:51200
    v_mfma_f32_16x16x32_bf16 v[36:39], v[12:15], v[212:215], v[36:39]
    global_load_dwordx4 v[112:115], v99, s[54:55] offset:-2048 sc1
    s_waitcnt lgkmcnt(5)
    v_mfma_f32_16x16x32_bf16 v[40:43], v[16:19], v[208:211], v[40:43]
    ds_read_b128 v[12:15], v2 offset:52224
    v_mfma_f32_16x16x32_bf16 v[44:47], v[16:19], v[212:215], v[44:47]
    global_load_dwordx4 v[116:119], v99, s[52:53] offset:0 sc1
    s_waitcnt lgkmcnt(5)
    v_mfma_f32_16x16x32_bf16 v[32:35], v[20:23], v[216:219], v[32:35]
    ds_read_b128 v[16:19], v2 offset:53248
    v_mfma_f32_16x16x32_bf16 v[36:39], v[20:23], v[220:223], v[36:39]
    global_load_dwordx4 v[120:123], v99, s[54:55] offset:0 sc1
    s_waitcnt lgkmcnt(5)
    v_mfma_f32_16x16x32_bf16 v[40:43], v[24:27], v[216:219], v[40:43]
    ds_read_b128 v[20:23], v2 offset:54272
    v_mfma_f32_16x16x32_bf16 v[44:47], v[24:27], v[220:223], v[44:47]
    s_waitcnt lgkmcnt(5)
    v_mfma_f32_16x16x32_bf16 v[32:35], v[28:31], v[224:227], v[32:35]
    ds_read_b128 v[24:27], v2 offset:55296
    v_mfma_f32_16x16x32_bf16 v[36:39], v[28:31], v[228:231], v[36:39]
    s_waitcnt lgkmcnt(5)
    v_mfma_f32_16x16x32_bf16 v[40:43], v[4:7], v[224:227], v[40:43]
    ds_read_b128 v[28:31], v2 offset:56320
    v_mfma_f32_16x16x32_bf16 v[44:47], v[4:7], v[228:231], v[44:47]
    s_waitcnt lgkmcnt(5)
    v_mfma_f32_16x16x32_bf16 v[32:35], v[8:11], v[232:235], v[32:35]
    v_mfma_f32_16x16x32_bf16 v[36:39], v[8:11], v[236:239], v[36:39]
    s_waitcnt lgkmcnt(4)
    v_mfma_f32_16x16x32_bf16 v[40:43], v[12:15], v[232:235], v[40:43]
    v_mfma_f32_16x16x32_bf16 v[44:47], v[12:15], v[236:239], v[44:47]
    s_waitcnt lgkmcnt(3)
    v_mfma_f32_16x16x32_bf16 v[32:35], v[16:19], v[240:243], v[32:35]
    v_mfma_f32_16x16x32_bf16 v[36:39], v[16:19], v[244:247], v[36:39]
    s_waitcnt lgkmcnt(2)
    v_mfma_f32_16x16x32_bf16 v[40:43], v[20:23], v[240:243], v[40:43]
    v_mfma_f32_16x16x32_bf16 v[44:47], v[20:23], v[244:247], v[44:47]
    s_waitcnt lgkmcnt(1)
    v_mfma_f32_16x16x32_bf16 v[32:35], v[24:27], v[248:251], v[32:35]
    v_mfma_f32_16x16x32_bf16 v[36:39], v[24:27], v[252:255], v[36:39]
    s_waitcnt lgkmcnt(0)
    v_mfma_f32_16x16x32_bf16 v[40:43], v[28:31], v[248:251], v[40:43]
    v_mfma_f32_16x16x32_bf16 v[44:47], v[28:31], v[252:255], v[44:47]
    s_mul_i32 s24, s25, 5120
    v_add_u32 v1, s24, v1
    v_add_u32 v2, s24, v2
    v_add_u32 v3, s24, v3
    ds_read_b128 v[220:223], v2 offset:57344
    ds_read_b128 v[224:227], v2 offset:58368
    ds_read_b128 v[228:231], v2 offset:59392
    ds_read_b128 v[232:235], v2 offset:60416
    ds_read_b128 v[236:239], v2 offset:61440
    ds_read_b128 v[240:243], v3 offset:2048
    ds_read_b128 v[244:247], v3 offset:3072
    ds_read_b128 v[248:251], v3 offset:4096
    v_pk_mul_f32 v[32:33], v[32:33], v[40:41]
    v_pk_mul_f32 v[34:35], v[34:35], v[42:43]
    v_pk_mul_f32 v[36:37], v[36:37], v[44:45]
    v_pk_mul_f32 v[38:39], v[38:39], v[46:47]
    v_add_u32 v0, s29, v98
    v_cvt_pk_bf16_f32 v32, v32, v33
    v_cvt_pk_bf16_f32 v33, v34, v35
    global_store_dwordx2 v0, v[32:33], s[16:17] sc1
    v_cvt_pk_bf16_f32 v36, v36, v37
    v_cvt_pk_bf16_f32 v37, v38, v39
    global_store_dwordx2 v0, v[36:37], s[18:19] sc1
    s_barrier
    s_waitcnt vmcnt(6)
    v_max_u32 v0, v100, v104
    v_cmp_eq_u32 vcc, -1, v0
    s_cbranch_vccnz .adaLN_cond__spectral_gfnet__glu_gated_bilinear__prompt_kernel_hs93
.adaLN_cond__spectral_gfnet__glu_gated_bilinear__prompt_kernel_hb94:
    s_waitcnt lgkmcnt(7)
    v_mfma_f32_16x16x32_bf16 v[4:7], v[220:223], v[100:103], 0
    ds_read_b128 v[252:255], v3 offset:5120
    global_load_dwordx4 v[124:127], v99, s[52:53] offset:2048 sc1
    v_mfma_f32_16x16x32_bf16 v[64:67], v[220:223], v[104:107], 0
    global_load_dwordx4 v[128:131], v99, s[54:55] offset:2048 sc1
    s_waitcnt lgkmcnt(7)
    v_mfma_f32_16x16x32_bf16 v[8:11], v[224:227], v[100:103], 0
    ds_read_b128 v[220:223], v3 offset:6144
    v_add_u32 v99, 8192, v97
    v_mfma_f32_16x16x32_bf16 v[68:71], v[224:227], v[104:107], 0
    global_load_dwordx4 v[132:135], v99, s[52:53] offset:-4096 sc1
    s_waitcnt lgkmcnt(7)
    v_mfma_f32_16x16x32_bf16 v[12:15], v[228:231], v[100:103], 0
    ds_read_b128 v[224:227], v3 offset:12288
    global_load_dwordx4 v[136:139], v99, s[54:55] offset:-4096 sc1
    v_mfma_f32_16x16x32_bf16 v[72:75], v[228:231], v[104:107], 0
    global_load_dwordx4 v[140:143], v99, s[52:53] offset:-2048 sc1
    s_waitcnt lgkmcnt(7)
    v_mfma_f32_16x16x32_bf16 v[16:19], v[232:235], v[100:103], 0
    ds_read_b128 v[228:231], v3 offset:13312
    global_load_dwordx4 v[144:147], v99, s[54:55] offset:-2048 sc1
    v_mfma_f32_16x16x32_bf16 v[76:79], v[232:235], v[104:107], 0
    global_load_dwordx4 v[148:151], v99, s[52:53] offset:0 sc1
    s_waitcnt lgkmcnt(7)
    v_mfma_f32_16x16x32_bf16 v[20:23], v[236:239], v[100:103], 0
    ds_read_b128 v[232:235], v3 offset:14336
    global_load_dwordx4 v[152:155], v99, s[54:55] offset:0 sc1
    v_mfma_f32_16x16x32_bf16 v[80:83], v[236:239], v[104:107], 0
    s_waitcnt vmcnt(12)
    v_max_u32 v0, v108, v112
    v_cmp_eq_u32 vcc, -1, v0
    s_cbranch_vccnz .adaLN_cond__spectral_gfnet__glu_gated_bilinear__prompt_kernel_hs95
.adaLN_cond__spectral_gfnet__glu_gated_bilinear__prompt_kernel_hb96:
    s_waitcnt lgkmcnt(7)
    v_mfma_f32_16x16x32_bf16 v[4:7], v[240:243], v[108:111], v[4:7]
    ds_read_b128 v[236:239], v3 offset:15360
    v_mfma_f32_16x16x32_bf16 v[64:67], v[240:243], v[112:115], v[64:67]
    s_waitcnt lgkmcnt(7)
    v_mfma_f32_16x16x32_bf16 v[8:11], v[244:247], v[108:111], v[8:11]
    ds_read_b128 v[240:243], v3 offset:16384
    v_mfma_f32_16x16x32_bf16 v[68:71], v[244:247], v[112:115], v[68:71]
    s_waitcnt lgkmcnt(7)
    v_mfma_f32_16x16x32_bf16 v[12:15], v[248:251], v[108:111], v[12:15]
    ds_read_b128 v[244:247], v3 offset:22528
    v_mfma_f32_16x16x32_bf16 v[72:75], v[248:251], v[112:115], v[72:75]
    s_waitcnt lgkmcnt(7)
    v_mfma_f32_16x16x32_bf16 v[16:19], v[252:255], v[108:111], v[16:19]
    ds_read_b128 v[248:251], v3 offset:23552
    v_mfma_f32_16x16x32_bf16 v[76:79], v[252:255], v[112:115], v[76:79]
    s_waitcnt lgkmcnt(7)
    v_mfma_f32_16x16x32_bf16 v[20:23], v[220:223], v[108:111], v[20:23]
    ds_read_b128 v[252:255], v3 offset:24576
    v_mfma_f32_16x16x32_bf16 v[80:83], v[220:223], v[112:115], v[80:83]
    s_waitcnt vmcnt(10)
    v_max_u32 v0, v116, v120
    v_cmp_eq_u32 vcc, -1, v0
    s_cbranch_vccnz .adaLN_cond__spectral_gfnet__glu_gated_bilinear__prompt_kernel_hs97
.adaLN_cond__spectral_gfnet__glu_gated_bilinear__prompt_kernel_hb98:
    s_waitcnt lgkmcnt(7)
    v_mfma_f32_16x16x32_bf16 v[4:7], v[224:227], v[116:119], v[4:7]
    ds_read_b128 v[220:223], v3 offset:25600
    v_mfma_f32_16x16x32_bf16 v[64:67], v[224:227], v[120:123], v[64:67]
    s_waitcnt lgkmcnt(7)
    v_mfma_f32_16x16x32_bf16 v[8:11], v[228:231], v[116:119], v[8:11]
    ds_read_b128 v[224:227], v3 offset:26624
    v_mfma_f32_16x16x32_bf16 v[68:71], v[228:231], v[120:123], v[68:71]
    s_waitcnt lgkmcnt(7)
    v_mfma_f32_16x16x32_bf16 v[12:15], v[232:235], v[116:119], v[12:15]
    ds_read_b128 v[228:231], v1 offset:0
    v_mfma_f32_16x16x32_bf16 v[72:75], v[232:235], v[120:123], v[72:75]
    s_waitcnt lgkmcnt(7)
    v_mfma_f32_16x16x32_bf16 v[16:19], v[236:239], v[116:119], v[16:19]
    ds_read_b128 v[232:235], v1 offset:1024
    v_mfma_f32_16x16x32_bf16 v[76:79], v[236:239], v[120:123], v[76:79]
    s_waitcnt lgkmcnt(7)
    v_mfma_f32_16x16x32_bf16 v[20:23], v[240:243], v[116:119], v[20:23]
    ds_read_b128 v[236:239], v1 offset:2048
    v_mfma_f32_16x16x32_bf16 v[80:83], v[240:243], v[120:123], v[80:83]
    s_waitcnt vmcnt(6)
    v_max_u32 v0, v124, v128
    v_cmp_eq_u32 vcc, -1, v0
    s_cbranch_vccnz .adaLN_cond__spectral_gfnet__glu_gated_bilinear__prompt_kernel_hs99
.adaLN_cond__spectral_gfnet__glu_gated_bilinear__prompt_kernel_hb100:
    s_waitcnt lgkmcnt(7)
    v_mfma_f32_16x16x32_bf16 v[4:7], v[244:247], v[124:127], v[4:7]
    ds_read_b128 v[240:243], v1 offset:3072
    v_add_u32 v99, 30720, v97
    v_mfma_f32_16x16x32_bf16 v[64:67], v[244:247], v[128:131], v[64:67]
    global_load_dwordx4 v[156:159], v99, s[52:53] offset:-4096 sc1
    s_waitcnt lgkmcnt(7)
    v_mfma_f32_16x16x32_bf16 v[8:11], v[248:251], v[124:127], v[8:11]
    ds_read_b128 v[244:247], v1 offset:4096
    global_load_dwordx4 v[160:163], v99, s[54:55] offset:-4096 sc1
    v_mfma_f32_16x16x32_bf16 v[68:71], v[248:251], v[128:131], v[68:71]
    global_load_dwordx4 v[164:167], v99, s[52:53] offset:-2048 sc1
    s_waitcnt lgkmcnt(7)
    v_mfma_f32_16x16x32_bf16 v[12:15], v[252:255], v[124:127], v[12:15]
    ds_read_b128 v[248:251], v1 offset:10240
    global_load_dwordx4 v[168:171], v99, s[54:55] offset:-2048 sc1
    v_mfma_f32_16x16x32_bf16 v[72:75], v[252:255], v[128:131], v[72:75]
    global_load_dwordx4 v[172:175], v99, s[52:53] offset:0 sc1
    s_waitcnt lgkmcnt(7)
    v_mfma_f32_16x16x32_bf16 v[16:19], v[220:223], v[124:127], v[16:19]
    ds_read_b128 v[252:255], v1 offset:11264
    global_load_dwordx4 v[176:179], v99, s[54:55] offset:0 sc1
    v_mfma_f32_16x16x32_bf16 v[76:79], v[220:223], v[128:131], v[76:79]
    global_load_dwordx4 v[180:183], v99, s[52:53] offset:2048 sc1
    s_waitcnt lgkmcnt(7)
    v_mfma_f32_16x16x32_bf16 v[20:23], v[224:227], v[124:127], v[20:23]
    ds_read_b128 v[220:223], v1 offset:12288
    global_load_dwordx4 v[184:187], v99, s[54:55] offset:2048 sc1
    v_mfma_f32_16x16x32_bf16 v[80:83], v[224:227], v[128:131], v[80:83]
    s_waitcnt vmcnt(12)
    v_max_u32 v0, v132, v136
    v_cmp_eq_u32 vcc, -1, v0
    s_cbranch_vccnz .adaLN_cond__spectral_gfnet__glu_gated_bilinear__prompt_kernel_hs101
.adaLN_cond__spectral_gfnet__glu_gated_bilinear__prompt_kernel_hb102:
    s_waitcnt lgkmcnt(7)
    v_mfma_f32_16x16x32_bf16 v[4:7], v[228:231], v[132:135], v[4:7]
    ds_read_b128 v[224:227], v1 offset:13312
    s_and_b32 s21, s37, 7
    v_mfma_f32_16x16x32_bf16 v[64:67], v[228:231], v[136:139], v[64:67]
    v_bfe_u32 v58, v97, 4, 4
    s_waitcnt lgkmcnt(7)
    v_mfma_f32_16x16x32_bf16 v[8:11], v[232:235], v[132:135], v[8:11]
    ds_read_b128 v[228:231], v1 offset:14336
    v_lshrrev_b32 v59, 8, v97
    v_mfma_f32_16x16x32_bf16 v[68:71], v[232:235], v[136:139], v[68:71]
    s_mul_i32 s22, s21, 160
    s_waitcnt lgkmcnt(7)
    v_mfma_f32_16x16x32_bf16 v[12:15], v[236:239], v[132:135], v[12:15]
    ds_read_b128 v[232:235], v1 offset:20480
    v_lshl_add_u32 v62, v59, 3, s22
    v_mfma_f32_16x16x32_bf16 v[72:75], v[236:239], v[136:139], v[72:75]
    v_lshl_add_u32 v59, v59, 4, s22
    s_waitcnt lgkmcnt(7)
    v_mfma_f32_16x16x32_bf16 v[16:19], v[240:243], v[132:135], v[16:19]
    ds_read_b128 v[236:239], v1 offset:21504
    v_mul_u32_u24 v60, 160, v58
    v_mfma_f32_16x16x32_bf16 v[76:79], v[240:243], v[136:139], v[76:79]
    s_mul_i32 s24, s26, 2560
    s_sub_u32 s24, s24, s22
    s_waitcnt lgkmcnt(7)
    v_mfma_f32_16x16x32_bf16 v[20:23], v[244:247], v[132:135], v[20:23]
    ds_read_b128 v[240:243], v1 offset:22528
    s_add_u32 s24, s24, 112640
    v_mfma_f32_16x16x32_bf16 v[80:83], v[244:247], v[136:139], v[80:83]
    v_add3_u32 v63, v60, v62, s24
    s_waitcnt vmcnt(10)
    v_max_u32 v0, v140, v144
    v_cmp_eq_u32 vcc, -1, v0
    s_cbranch_vccnz .adaLN_cond__spectral_gfnet__glu_gated_bilinear__prompt_kernel_hs103
.adaLN_cond__spectral_gfnet__glu_gated_bilinear__prompt_kernel_hb104:
    s_waitcnt lgkmcnt(7)
    v_mfma_f32_16x16x32_bf16 v[4:7], v[248:251], v[140:143], v[4:7]
    ds_read_b128 v[244:247], v1 offset:23552
    v_add3_u32 v60, v60, v59, s24
    v_mfma_f32_16x16x32_bf16 v[64:67], v[248:251], v[144:147], v[64:67]
    v_mul_u32_u24 v61, 40960, v58
    s_waitcnt lgkmcnt(7)
    v_mfma_f32_16x16x32_bf16 v[8:11], v[252:255], v[140:143], v[8:11]
    ds_read_b128 v[248:251], v1 offset:24576
    v_add_u32 v58, v61, v62
    v_mfma_f32_16x16x32_bf16 v[68:71], v[252:255], v[144:147], v[68:71]
    v_add_u32 v61, v61, v59
    s_waitcnt lgkmcnt(7)
    v_mfma_f32_16x16x32_bf16 v[12:15], v[220:223], v[140:143], v[12:15]
    ds_read_b128 v[252:255], v1 offset:30720
    s_lshl_b32 s22, s26, 9
    s_add_u32 s22, s22, s20
    v_mfma_f32_16x16x32_bf16 v[72:75], v[220:223], v[144:147], v[72:75]
    s_mul_i32 s22, s22, 1280
    s_waitcnt lgkmcnt(7)
    v_mfma_f32_16x16x32_bf16 v[16:19], v[224:227], v[140:143], v[16:19]
    ds_read_b128 v[220:223], v1 offset:31744
    s_add_u32 s44, s44, s22
    s_addc_u32 s45, s45, 0
    v_mfma_f32_16x16x32_bf16 v[76:79], v[224:227], v[144:147], v[76:79]
    s_lshl_b32 s24, s2, 9
    s_add_u32 s24, s24, 655616
    s_waitcnt lgkmcnt(7)
    v_mfma_f32_16x16x32_bf16 v[20:23], v[228:231], v[140:143], v[20:23]
    ds_read_b128 v[224:227], v1 offset:32768
    s_mul_i32 s22, s21, 160
    s_sub_u32 s24, s24, s22
    v_mfma_f32_16x16x32_bf16 v[80:83], v[228:231], v[144:147], v[80:83]
    s_add_u32 s18, s6, s24
    s_addc_u32 s19, s7, 0
    s_waitcnt vmcnt(8)
    v_max_u32 v0, v148, v152
    v_cmp_eq_u32 vcc, -1, v0
    s_cbranch_vccnz .adaLN_cond__spectral_gfnet__glu_gated_bilinear__prompt_kernel_hs105
.adaLN_cond__spectral_gfnet__glu_gated_bilinear__prompt_kernel_hb106:
    s_waitcnt lgkmcnt(7)
    v_mfma_f32_16x16x32_bf16 v[4:7], v[232:235], v[148:151], v[4:7]
    ds_read_b128 v[228:231], v1 offset:33792
    global_load_dwordx4 v[84:87], v59, s[18:19] offset:0 sc1
    v_mfma_f32_16x16x32_bf16 v[64:67], v[232:235], v[152:155], v[64:67]
    global_load_dwordx4 v[88:91], v59, s[18:19] offset:64 sc1
    s_waitcnt lgkmcnt(7)
    v_mfma_f32_16x16x32_bf16 v[8:11], v[236:239], v[148:151], v[8:11]
    ds_read_b128 v[232:235], v1 offset:34816
    global_load_dwordx2 v[92:93], v62, s[18:19] offset:128 sc1
    v_mfma_f32_16x16x32_bf16 v[68:71], v[236:239], v[152:155], v[68:71]
    s_waitcnt lgkmcnt(7)
    v_mfma_f32_16x16x32_bf16 v[12:15], v[240:243], v[148:151], v[12:15]
    ds_read_b128 v[236:239], v1 offset:40960
    v_mfma_f32_16x16x32_bf16 v[72:75], v[240:243], v[152:155], v[72:75]
    s_waitcnt lgkmcnt(7)
    v_mfma_f32_16x16x32_bf16 v[16:19], v[244:247], v[148:151], v[16:19]
    ds_read_b128 v[240:243], v1 offset:41984
    v_mfma_f32_16x16x32_bf16 v[76:79], v[244:247], v[152:155], v[76:79]
    s_waitcnt lgkmcnt(7)
    v_mfma_f32_16x16x32_bf16 v[20:23], v[248:251], v[148:151], v[20:23]
    ds_read_b128 v[244:247], v1 offset:43008
    v_mfma_f32_16x16x32_bf16 v[80:83], v[248:251], v[152:155], v[80:83]
    s_waitcnt vmcnt(9)
    v_max_u32 v0, v156, v160
    v_cmp_eq_u32 vcc, -1, v0
    s_cbranch_vccnz .adaLN_cond__spectral_gfnet__glu_gated_bilinear__prompt_kernel_hs107
.adaLN_cond__spectral_gfnet__glu_gated_bilinear__prompt_kernel_hb108:
    s_waitcnt lgkmcnt(7)
    v_mfma_f32_16x16x32_bf16 v[4:7], v[252:255], v[156:159], v[4:7]
    ds_read_b128 v[248:251], v1 offset:44032
    v_mfma_f32_16x16x32_bf16 v[64:67], v[252:255], v[160:163], v[64:67]
    s_waitcnt lgkmcnt(7)
    v_mfma_f32_16x16x32_bf16 v[8:11], v[220:223], v[156:159], v[8:11]
    ds_read_b128 v[252:255], v1 offset:45056
    v_mfma_f32_16x16x32_bf16 v[68:71], v[220:223], v[160:163], v[68:71]
    s_waitcnt lgkmcnt(7)
    v_mfma_f32_16x16x32_bf16 v[12:15], v[224:227], v[156:159], v[12:15]
    ds_read_b128 v[220:223], v1 offset:51200
    v_mfma_f32_16x16x32_bf16 v[72:75], v[224:227], v[160:163], v[72:75]
    s_waitcnt lgkmcnt(7)
    v_mfma_f32_16x16x32_bf16 v[16:19], v[228:231], v[156:159], v[16:19]
    ds_read_b128 v[224:227], v1 offset:52224
    v_mfma_f32_16x16x32_bf16 v[76:79], v[228:231], v[160:163], v[76:79]
    s_waitcnt lgkmcnt(7)
    v_mfma_f32_16x16x32_bf16 v[20:23], v[232:235], v[156:159], v[20:23]
    ds_read_b128 v[228:231], v1 offset:53248
    v_mfma_f32_16x16x32_bf16 v[80:83], v[232:235], v[160:163], v[80:83]
    s_waitcnt vmcnt(7)
    v_max_u32 v0, v164, v168
    v_cmp_eq_u32 vcc, -1, v0
    s_cbranch_vccnz .adaLN_cond__spectral_gfnet__glu_gated_bilinear__prompt_kernel_hs109
.adaLN_cond__spectral_gfnet__glu_gated_bilinear__prompt_kernel_hb110:
    s_waitcnt lgkmcnt(7)
    v_mfma_f32_16x16x32_bf16 v[4:7], v[236:239], v[164:167], v[4:7]
    ds_read_b128 v[232:235], v1 offset:54272
    v_add_u32 v99, 47104, v98
    v_mfma_f32_16x16x32_bf16 v[64:67], v[236:239], v[168:171], v[64:67]
    global_load_dwordx2 v[188:189], v99, s[52:53] offset:-4096 sc1
    s_waitcnt lgkmcnt(7)
    v_mfma_f32_16x16x32_bf16 v[8:11], v[240:243], v[164:167], v[8:11]
    ds_read_b128 v[236:239], v1 offset:55296
    global_load_dwordx2 v[190:191], v99, s[52:53] offset:-3584 sc1
    v_mfma_f32_16x16x32_bf16 v[68:71], v[240:243], v[168:171], v[68:71]
    global_load_dwordx2 v[192:193], v99, s[54:55] offset:-4096 sc1
    s_waitcnt lgkmcnt(7)
    v_mfma_f32_16x16x32_bf16 v[12:15], v[244:247], v[164:167], v[12:15]
    ds_read_b128 v[240:243], v1 offset:61440
    global_load_dwordx2 v[194:195], v99, s[54:55] offset:-3584 sc1
    v_mfma_f32_16x16x32_bf16 v[72:75], v[244:247], v[168:171], v[72:75]
    global_load_dwordx2 v[196:197], v99, s[52:53] offset:-2048 sc1
    s_waitcnt lgkmcnt(7)
    v_mfma_f32_16x16x32_bf16 v[16:19], v[248:251], v[164:167], v[16:19]
    ds_read_b128 v[244:247], v1 offset:62464
    global_load_dwordx2 v[198:199], v99, s[52:53] offset:-1536 sc1
    v_mfma_f32_16x16x32_bf16 v[76:79], v[248:251], v[168:171], v[76:79]
    global_load_dwordx2 v[200:201], v99, s[54:55] offset:-2048 sc1
    s_waitcnt lgkmcnt(7)
    v_mfma_f32_16x16x32_bf16 v[20:23], v[252:255], v[164:167], v[20:23]
    ds_read_b128 v[248:251], v1 offset:63488
    global_load_dwordx2 v[202:203], v99, s[54:55] offset:-1536 sc1
    v_mfma_f32_16x16x32_bf16 v[80:83], v[252:255], v[168:171], v[80:83]
    global_load_dwordx2 v[204:205], v99, s[52:53] offset:0 sc1
    s_waitcnt vmcnt(14)
    v_max_u32 v0, v172, v176
    v_cmp_eq_u32 vcc, -1, v0
    s_cbranch_vccnz .adaLN_cond__spectral_gfnet__glu_gated_bilinear__prompt_kernel_hs111
.adaLN_cond__spectral_gfnet__glu_gated_bilinear__prompt_kernel_hb112:
    s_waitcnt lgkmcnt(7)
    v_mfma_f32_16x16x32_bf16 v[4:7], v[220:223], v[172:175], v[4:7]
    ds_read_b128 v[252:255], v1 offset:64512
    global_load_dwordx2 v[206:207], v99, s[52:53] offset:512 sc1
    v_mfma_f32_16x16x32_bf16 v[64:67], v[220:223], v[176:179], v[64:67]
    global_load_dwordx2 v[208:209], v99, s[54:55] offset:0 sc1
    s_waitcnt lgkmcnt(7)
    v_mfma_f32_16x16x32_bf16 v[8:11], v[224:227], v[172:175], v[8:11]
    ds_read_b128 v[220:223], v2 offset:0
    global_load_dwordx2 v[210:211], v99, s[54:55] offset:512 sc1
    v_mfma_f32_16x16x32_bf16 v[68:71], v[224:227], v[176:179], v[68:71]
    global_load_dwordx2 v[212:213], v99, s[52:53] offset:2048 sc1
    s_waitcnt lgkmcnt(7)
    v_mfma_f32_16x16x32_bf16 v[12:15], v[228:231], v[172:175], v[12:15]
    ds_read_b128 v[224:227], v2 offset:6144
    global_load_dwordx2 v[214:215], v99, s[52:53] offset:2560 sc1
    v_mfma_f32_16x16x32_bf16 v[72:75], v[228:231], v[176:179], v[72:75]
    global_load_dwordx2 v[216:217], v99, s[54:55] offset:2048 sc1
    s_waitcnt lgkmcnt(7)
    v_mfma_f32_16x16x32_bf16 v[16:19], v[232:235], v[172:175], v[16:19]
    ds_read_b128 v[228:231], v2 offset:7168
    global_load_dwordx2 v[218:219], v99, s[54:55] offset:2560 sc1
    v_mfma_f32_16x16x32_bf16 v[76:79], v[232:235], v[176:179], v[76:79]
    s_waitcnt lgkmcnt(7)
    v_mfma_f32_16x16x32_bf16 v[20:23], v[236:239], v[172:175], v[20:23]
    ds_read_b128 v[232:235], v2 offset:8192
    v_mfma_f32_16x16x32_bf16 v[80:83], v[236:239], v[176:179], v[80:83]
    s_barrier
    ds_read_b128 v[48:51], v60
    ds_read_b128 v[52:55], v60 offset:64
    ds_read_b64 v[56:57], v63 offset:128
    s_waitcnt lgkmcnt(0)
    s_waitcnt vmcnt(19)
    v_max_u32 v0, v180, v184
    v_cmp_eq_u32 vcc, -1, v0
    s_cbranch_vccnz .adaLN_cond__spectral_gfnet__glu_gated_bilinear__prompt_kernel_hs113
.adaLN_cond__spectral_gfnet__glu_gated_bilinear__prompt_kernel_hb114:
    s_waitcnt lgkmcnt(7)
    v_mfma_f32_16x16x32_bf16 v[4:7], v[240:243], v[180:183], v[4:7]
    ds_read_b128 v[236:239], v2 offset:9216
    v_mfma_f32_16x16x32_bf16 v[64:67], v[240:243], v[184:187], v[64:67]
    s_waitcnt lgkmcnt(7)
    v_mfma_f32_16x16x32_bf16 v[8:11], v[244:247], v[180:183], v[8:11]
    ds_read_b128 v[240:243], v2 offset:10240
    v_mfma_f32_16x16x32_bf16 v[68:71], v[244:247], v[184:187], v[68:71]
    s_waitcnt lgkmcnt(7)
    v_mfma_f32_16x16x32_bf16 v[12:15], v[248:251], v[180:183], v[12:15]
    ds_read_b128 v[244:247], v2 offset:16384
    v_mfma_f32_16x16x32_bf16 v[72:75], v[248:251], v[184:187], v[72:75]
    s_waitcnt lgkmcnt(7)
    v_mfma_f32_16x16x32_bf16 v[16:19], v[252:255], v[180:183], v[16:19]
    ds_read_b128 v[248:251], v2 offset:17408
    v_mfma_f32_16x16x32_bf16 v[76:79], v[252:255], v[184:187], v[76:79]
    s_waitcnt lgkmcnt(7)
    v_mfma_f32_16x16x32_bf16 v[20:23], v[220:223], v[180:183], v[20:23]
    ds_read_b128 v[252:255], v2 offset:18432
    v_mfma_f32_16x16x32_bf16 v[80:83], v[220:223], v[184:187], v[80:83]
    s_waitcnt vmcnt(12)
    v_max3_u32 v0, v188, v190, v192
    v_max_u32 v0, v0, v194
    v_cmp_eq_u32 vcc, -1, v0
    s_cbranch_vccnz .adaLN_cond__spectral_gfnet__glu_gated_bilinear__prompt_kernel_hs115
.adaLN_cond__spectral_gfnet__glu_gated_bilinear__prompt_kernel_hb116:
    s_waitcnt lgkmcnt(7)
    v_mfma_f32_16x16x32_bf16 v[4:7], v[224:227], v[188:191], v[4:7]
    ds_read_b128 v[220:223], v2 offset:19456
    v_lshlrev_b32 v100, 16, v48
    v_mfma_f32_16x16x32_bf16 v[64:67], v[224:227], v[192:195], v[64:67]
    v_and_b32 v101, s14, v48
    s_waitcnt lgkmcnt(7)
    v_mfma_f32_16x16x32_bf16 v[8:11], v[228:231], v[188:191], v[8:11]
    ds_read_b128 v[224:227], v2 offset:20480
    v_lshlrev_b32 v120, 16, v84
    v_mfma_f32_16x16x32_bf16 v[68:71], v[228:231], v[192:195], v[68:71]
    v_and_b32 v121, s14, v84
    s_waitcnt lgkmcnt(7)
    v_mfma_f32_16x16x32_bf16 v[12:15], v[232:235], v[188:191], v[12:15]
    ds_read_b128 v[228:231], v2 offset:26624
    v_lshlrev_b32 v102, 16, v49
    v_mfma_f32_16x16x32_bf16 v[72:75], v[232:235], v[192:195], v[72:75]
    v_and_b32 v103, s14, v49
    s_waitcnt lgkmcnt(7)
    v_mfma_f32_16x16x32_bf16 v[16:19], v[236:239], v[188:191], v[16:19]
    ds_read_b128 v[232:235], v2 offset:27648
    v_lshlrev_b32 v122, 16, v85
    v_mfma_f32_16x16x32_bf16 v[76:79], v[236:239], v[192:195], v[76:79]
    v_and_b32 v123, s14, v85
    s_waitcnt lgkmcnt(7)
    v_mfma_f32_16x16x32_bf16 v[20:23], v[240:243], v[188:191], v[20:23]
    ds_read_b128 v[236:239], v2 offset:28672
    v_lshlrev_b32 v104, 16, v50
    v_mfma_f32_16x16x32_bf16 v[80:83], v[240:243], v[192:195], v[80:83]
    v_and_b32 v105, s14, v50
    s_waitcnt vmcnt(8)
    v_max3_u32 v0, v196, v198, v200
    v_max_u32 v0, v0, v202
    v_cmp_eq_u32 vcc, -1, v0
    s_cbranch_vccnz .adaLN_cond__spectral_gfnet__glu_gated_bilinear__prompt_kernel_hs117
.adaLN_cond__spectral_gfnet__glu_gated_bilinear__prompt_kernel_hb118:
    s_waitcnt lgkmcnt(7)
    v_mfma_f32_16x16x32_bf16 v[4:7], v[244:247], v[196:199], v[4:7]
    ds_read_b128 v[240:243], v2 offset:29696
    v_lshlrev_b32 v124, 16, v86
    v_mfma_f32_16x16x32_bf16 v[64:67], v[244:247], v[200:203], v[64:67]
    v_and_b32 v125, s14, v86
    s_waitcnt lgkmcnt(7)
    v_mfma_f32_16x16x32_bf16 v[8:11], v[248:251], v[196:199], v[8:11]
    ds_read_b128 v[244:247], v2 offset:30720
    v_lshlrev_b32 v106, 16, v51
    v_mfma_f32_16x16x32_bf16 v[68:71], v[248:251], v[200:203], v[68:71]
    v_and_b32 v107, s14, v51
    s_waitcnt lgkmcnt(7)
    v_mfma_f32_16x16x32_bf16 v[12:15], v[252:255], v[196:199], v[12:15]
    ds_read_b128 v[248:251], v2 offset:36864
    v_lshlrev_b32 v126, 16, v87
    v_mfma_f32_16x16x32_bf16 v[72:75], v[252:255], v[200:203], v[72:75]
    v_and_b32 v127, s14, v87
    s_waitcnt lgkmcnt(7)
    v_mfma_f32_16x16x32_bf16 v[16:19], v[220:223], v[196:199], v[16:19]
    ds_read_b128 v[252:255], v2 offset:37888
    v_lshlrev_b32 v108, 16, v52
    v_mfma_f32_16x16x32_bf16 v[76:79], v[220:223], v[200:203], v[76:79]
    v_and_b32 v109, s14, v52
    s_waitcnt lgkmcnt(7)
    v_mfma_f32_16x16x32_bf16 v[20:23], v[224:227], v[196:199], v[20:23]
    ds_read_b128 v[220:223], v2 offset:38912
    v_lshlrev_b32 v128, 16, v88
    v_mfma_f32_16x16x32_bf16 v[80:83], v[224:227], v[200:203], v[80:83]
    v_and_b32 v129, s14, v88
    s_waitcnt vmcnt(4)
    v_max3_u32 v0, v204, v206, v208
    v_max_u32 v0, v0, v210
    v_cmp_eq_u32 vcc, -1, v0
    s_cbranch_vccnz .adaLN_cond__spectral_gfnet__glu_gated_bilinear__prompt_kernel_hs119
.adaLN_cond__spectral_gfnet__glu_gated_bilinear__prompt_kernel_hb120:
    s_waitcnt lgkmcnt(7)
    v_mfma_f32_16x16x32_bf16 v[4:7], v[228:231], v[204:207], v[4:7]
    ds_read_b128 v[224:227], v2 offset:39936
    v_lshlrev_b32 v110, 16, v53
    v_mfma_f32_16x16x32_bf16 v[64:67], v[228:231], v[208:211], v[64:67]
    v_and_b32 v111, s14, v53
    s_waitcnt lgkmcnt(7)
    v_mfma_f32_16x16x32_bf16 v[8:11], v[232:235], v[204:207], v[8:11]
    ds_read_b128 v[228:231], v2 offset:40960
    v_lshlrev_b32 v130, 16, v89
    v_mfma_f32_16x16x32_bf16 v[68:71], v[232:235], v[208:211], v[68:71]
    v_and_b32 v131, s14, v89
    s_waitcnt lgkmcnt(7)
    v_mfma_f32_16x16x32_bf16 v[12:15], v[236:239], v[204:207], v[12:15]
    v_lshlrev_b32 v112, 16, v54
    v_mfma_f32_16x16x32_bf16 v[72:75], v[236:239], v[208:211], v[72:75]
    v_and_b32 v113, s14, v54
    s_waitcnt lgkmcnt(6)
    v_mfma_f32_16x16x32_bf16 v[16:19], v[240:243], v[204:207], v[16:19]
    v_lshlrev_b32 v132, 16, v90
    v_mfma_f32_16x16x32_bf16 v[76:79], v[240:243], v[208:211], v[76:79]
    v_and_b32 v133, s14, v90
    s_waitcnt lgkmcnt(5)
    v_mfma_f32_16x16x32_bf16 v[20:23], v[244:247], v[204:207], v[20:23]
    v_lshlrev_b32 v114, 16, v55
    v_mfma_f32_16x16x32_bf16 v[80:83], v[244:247], v[208:211], v[80:83]
    v_and_b32 v115, s14, v55
    s_waitcnt vmcnt(0)
    v_max3_u32 v0, v212, v214, v216
    v_max_u32 v0, v0, v218
    v_cmp_eq_u32 vcc, -1, v0
    s_cbranch_vccnz .adaLN_cond__spectral_gfnet__glu_gated_bilinear__prompt_kernel_hs121
.adaLN_cond__spectral_gfnet__glu_gated_bilinear__prompt_kernel_hb122:
    s_waitcnt lgkmcnt(4)
    v_mfma_f32_16x16x32_bf16 v[4:7], v[248:251], v[212:215], v[4:7]
    v_lshlrev_b32 v134, 16, v91
    v_mfma_f32_16x16x32_bf16 v[64:67], v[248:251], v[216:219], v[64:67]
    v_and_b32 v135, s14, v91
    s_waitcnt lgkmcnt(3)
    v_mfma_f32_16x16x32_bf16 v[8:11], v[252:255], v[212:215], v[8:11]
    v_lshlrev_b32 v116, 16, v56
    v_mfma_f32_16x16x32_bf16 v[68:71], v[252:255], v[216:219], v[68:71]
    v_and_b32 v117, s14, v56
    s_waitcnt lgkmcnt(2)
    v_mfma_f32_16x16x32_bf16 v[12:15], v[220:223], v[212:215], v[12:15]
    v_lshlrev_b32 v136, 16, v92
    v_mfma_f32_16x16x32_bf16 v[72:75], v[220:223], v[216:219], v[72:75]
    v_and_b32 v137, s14, v92
    s_waitcnt lgkmcnt(1)
    v_mfma_f32_16x16x32_bf16 v[16:19], v[224:227], v[212:215], v[16:19]
    v_lshlrev_b32 v118, 16, v57
    v_mfma_f32_16x16x32_bf16 v[76:79], v[224:227], v[216:219], v[76:79]
    v_and_b32 v119, s14, v57
    s_waitcnt lgkmcnt(0)
    v_mfma_f32_16x16x32_bf16 v[20:23], v[228:231], v[212:215], v[20:23]
    v_lshlrev_b32 v138, 16, v93
    v_mfma_f32_16x16x32_bf16 v[80:83], v[228:231], v[216:219], v[80:83]
    v_and_b32 v139, s14, v93
    s_xor_b32 s24, s26, 1
    s_mul_i32 s24, s24, 5120
    s_add_u32 s24, s24, 143360
    v_add_u32 v1, s24, v97
    s_mul_i32 s24, s26, 5120
    v_add_u32 v2, s24, v97
    v_add_u32 v3, 122880, v2
    ds_write_b128 v1, v[64:67] offset:0
    ds_write_b128 v1, v[68:71] offset:1024
    ds_write_b128 v1, v[72:75] offset:2048
    ds_write_b128 v1, v[76:79] offset:3072
    ds_write_b128 v1, v[80:83] offset:4096
    s_waitcnt lgkmcnt(0)
    s_barrier
    ds_read_b128 v[140:143], v2 offset:0
    ds_read_b128 v[144:147], v2 offset:20480
    ds_read_b128 v[148:151], v2 offset:40960
    ds_read_b128 v[152:155], v3 offset:0
    ds_read_b128 v[156:159], v3 offset:20480
    ds_read_b128 v[160:163], v2 offset:1024
    ds_read_b128 v[164:167], v2 offset:21504
    ds_read_b128 v[168:171], v2 offset:41984
    ds_read_b128 v[172:175], v3 offset:1024
    ds_read_b128 v[176:179], v3 offset:21504
    ds_read_b128 v[180:183], v2 offset:2048
    ds_read_b128 v[184:187], v2 offset:22528
    ds_read_b128 v[188:191], v2 offset:43008
    ds_read_b128 v[192:195], v3 offset:2048
    ds_read_b128 v[196:199], v3 offset:22528
    s_waitcnt lgkmcnt(10)
    ds_read_b128 v[200:203], v2 offset:3072
    ds_read_b128 v[204:207], v2 offset:23552
    ds_read_b128 v[208:211], v2 offset:44032
    ds_read_b128 v[212:215], v3 offset:3072
    ds_read_b128 v[216:219], v3 offset:23552
    v_pk_add_f32 v[140:141], v[140:141], v[144:145]
    v_pk_add_f32 v[148:149], v[148:149], v[152:153]
    v_pk_add_f32 v[4:5], v[4:5], v[156:157]
    v_pk_add_f32 v[140:141], v[140:141], v[148:149]
    v_pk_add_f32 v[4:5], v[4:5], v[140:141]
    v_pk_fma_f32 v[4:5], v[4:5], v[120:121], v[100:101]
    v_cvt_pk_bf16_f32 v24, v4, v5
    v_pk_add_f32 v[142:143], v[142:143], v[146:147]
    v_pk_add_f32 v[150:151], v[150:151], v[154:155]
    v_pk_add_f32 v[6:7], v[6:7], v[158:159]
    v_pk_add_f32 v[142:143], v[142:143], v[150:151]
    v_pk_add_f32 v[6:7], v[6:7], v[142:143]
    v_pk_fma_f32 v[6:7], v[6:7], v[122:123], v[102:103]
    v_cvt_pk_bf16_f32 v25, v6, v7
    s_waitcnt lgkmcnt(10)
    ds_read_b128 v[220:223], v2 offset:4096
    ds_read_b128 v[224:227], v2 offset:24576
    ds_read_b128 v[228:231], v2 offset:45056
    ds_read_b128 v[232:235], v3 offset:4096
    ds_read_b128 v[236:239], v3 offset:24576
    v_pk_add_f32 v[160:161], v[160:161], v[164:165]
    v_pk_add_f32 v[168:169], v[168:169], v[172:173]
    v_pk_add_f32 v[8:9], v[8:9], v[176:177]
    v_pk_add_f32 v[160:161], v[160:161], v[168:169]
    v_pk_add_f32 v[8:9], v[8:9], v[160:161]
    v_pk_fma_f32 v[8:9], v[8:9], v[124:125], v[104:105]
    v_cvt_pk_bf16_f32 v26, v8, v9
    v_pk_add_f32 v[162:163], v[162:163], v[166:167]
    v_pk_add_f32 v[170:171], v[170:171], v[174:175]
    v_pk_add_f32 v[10:11], v[10:11], v[178:179]
    v_pk_add_f32 v[162:163], v[162:163], v[170:171]
    v_pk_add_f32 v[10:11], v[10:11], v[162:163]
    v_pk_fma_f32 v[10:11], v[10:11], v[126:127], v[106:107]
    v_cvt_pk_bf16_f32 v27, v10, v11
    global_store_dwordx4 v61, v[24:27], s[44:45] offset:0
    s_waitcnt lgkmcnt(10)
    v_pk_add_f32 v[180:181], v[180:181], v[184:185]
    v_pk_add_f32 v[188:189], v[188:189], v[192:193]
    v_pk_add_f32 v[12:13], v[12:13], v[196:197]
    v_pk_add_f32 v[180:181], v[180:181], v[188:189]
    v_pk_add_f32 v[12:13], v[12:13], v[180:181]
    v_pk_fma_f32 v[12:13], v[12:13], v[128:129], v[108:109]
    v_cvt_pk_bf16_f32 v28, v12, v13
    v_pk_add_f32 v[182:183], v[182:183], v[186:187]
    v_pk_add_f32 v[190:191], v[190:191], v[194:195]
    v_pk_add_f32 v[14:15], v[14:15], v[198:199]
    v_pk_add_f32 v[182:183], v[182:183], v[190:191]
    v_pk_add_f32 v[14:15], v[14:15], v[182:183]
    v_pk_fma_f32 v[14:15], v[14:15], v[130:131], v[110:111]
    v_cvt_pk_bf16_f32 v29, v14, v15
    s_waitcnt lgkmcnt(5)
    v_pk_add_f32 v[200:201], v[200:201], v[204:205]
    v_pk_add_f32 v[208:209], v[208:209], v[212:213]
    v_pk_add_f32 v[16:17], v[16:17], v[216:217]
    v_pk_add_f32 v[200:201], v[200:201], v[208:209]
    v_pk_add_f32 v[16:17], v[16:17], v[200:201]
    v_pk_fma_f32 v[16:17], v[16:17], v[132:133], v[112:113]
    v_cvt_pk_bf16_f32 v30, v16, v17
    v_pk_add_f32 v[202:203], v[202:203], v[206:207]
    v_pk_add_f32 v[210:211], v[210:211], v[214:215]
    v_pk_add_f32 v[18:19], v[18:19], v[218:219]
    v_pk_add_f32 v[202:203], v[202:203], v[210:211]
    v_pk_add_f32 v[18:19], v[18:19], v[202:203]
    v_pk_fma_f32 v[18:19], v[18:19], v[134:135], v[114:115]
    v_cvt_pk_bf16_f32 v31, v18, v19
    global_store_dwordx4 v61, v[28:31], s[44:45] offset:64
    s_waitcnt lgkmcnt(0)
    v_pk_add_f32 v[220:221], v[220:221], v[224:225]
    v_pk_add_f32 v[228:229], v[228:229], v[232:233]
    v_pk_add_f32 v[20:21], v[20:21], v[236:237]
    v_pk_add_f32 v[220:221], v[220:221], v[228:229]
    v_pk_add_f32 v[20:21], v[20:21], v[220:221]
    v_pk_fma_f32 v[20:21], v[20:21], v[136:137], v[116:117]
    v_cvt_pk_bf16_f32 v32, v20, v21
    v_pk_add_f32 v[222:223], v[222:223], v[226:227]
    v_pk_add_f32 v[230:231], v[230:231], v[234:235]
    v_pk_add_f32 v[22:23], v[22:23], v[238:239]
    v_pk_add_f32 v[222:223], v[222:223], v[230:231]
    v_pk_add_f32 v[22:23], v[22:23], v[222:223]
    v_pk_fma_f32 v[22:23], v[22:23], v[138:139], v[118:119]
    v_cvt_pk_bf16_f32 v33, v22, v23
    global_store_dwordx2 v58, v[32:33], s[44:45] offset:128
    s_endpgm
.adaLN_cond__spectral_gfnet__glu_gated_bilinear__prompt_kernel_loader32:
    s_sub_u32 s27, s3, 4
    s_mul_i32 s28, s27, 5120
    s_add_u32 s24, s28, 163840
    s_add_u32 s8, s46, s24
    s_addc_u32 s9, s47, 0
    s_and_b32 s21, s37, 7
    s_mul_i32 s24, s21, 276480
    s_add_u32 s24, s24, 10485760
    s_add_u32 s25, s24, s28
    s_add_u32 s10, s6, s25
    s_addc_u32 s11, s7, 0
    s_mul_i32 s25, s27, 30720
    s_add_u32 s24, s24, s25
    s_add_u32 s24, s24, 153600
    s_add_u32 s12, s6, s24
    s_addc_u32 s13, s7, 0
    v_mov_b32 v1, v61
    v_add_u32 v4, 4096, v61
    s_lshl_b32 s24, s27, 11
    s_sub_u32 s24, 24576, s24
    v_add_u32 v5, s24, v61
    s_mov_b32 s42, 0
    s_barrier
    s_add_u32 m0, s28, 0
    s_nop 0
    global_load_lds_dwordx4 v1, s[8:9] offset:0
    global_load_lds_dwordx4 v1, s[8:9] offset:1024
    global_load_lds_dwordx4 v1, s[8:9] offset:2048
    global_load_lds_dwordx4 v1, s[8:9] offset:3072
    s_add_u32 m0, s28, 4096
    s_nop 0
    global_load_lds_dwordx4 v4, s[8:9]
    s_add_u32 s8, s8, 20480
    s_addc_u32 s9, s9, 0
    s_lshr_b32 s24, s37, 3
    s_lshl_b32 s23, s36, 1
    s_add_u32 s23, s23, s24
    s_mul_i32 s23, s23, 221184
    s_add_u32 s24, s23, 17825792
    s_add_u32 s30, s6, s24
    s_addc_u32 s31, s7, 0
    s_lshl_b32 s24, s27, 12
    s_add_u32 s23, s23, s24
    s_add_u32 s23, s23, 17840128
    s_add_u32 s52, s6, s23
    s_addc_u32 s53, s7, 0
    s_add_u32 s54, s52, 55296
    s_addc_u32 s55, s53, 0
    s_add_u32 s16, s54, 55296
    s_addc_u32 s17, s55, 0
    s_add_u32 s18, s16, 55296
    s_addc_u32 s19, s17, 0
    s_barrier
    s_add_u32 m0, s28, 20480
    s_nop 0
    global_load_lds_dwordx4 v1, s[8:9] offset:0
    global_load_lds_dwordx4 v1, s[8:9] offset:1024
    global_load_lds_dwordx4 v1, s[8:9] offset:2048
    global_load_lds_dwordx4 v1, s[8:9] offset:3072
    s_add_u32 m0, s28, 24576
    s_nop 0
    global_load_lds_dwordx4 v4, s[8:9]
    s_add_u32 s8, s8, 20480
    s_addc_u32 s9, s9, 0
    s_barrier
    s_add_u32 m0, s28, 40960
    s_nop 0
    global_load_lds_dwordx4 v1, s[8:9] offset:0
    global_load_lds_dwordx4 v1, s[8:9] offset:1024
    global_load_lds_dwordx4 v1, s[8:9] offset:2048
    global_load_lds_dwordx4 v1, s[8:9] offset:3072
    s_add_u32 m0, s28, 45056
    s_nop 0
    global_load_lds_dwordx4 v4, s[8:9]
    s_add_u32 s8, s8, 20480
    s_addc_u32 s9, s9, 0
    global_load_dwordx4 v[136:139], v1, s[12:13] offset:0
    global_load_dwordx4 v[140:143], v1, s[12:13] offset:1024
    s_barrier
    s_add_u32 m0, s28, 61440
    s_nop 0
    global_load_lds_dwordx4 v1, s[8:9] offset:0
    global_load_lds_dwordx4 v1, s[8:9] offset:1024
    global_load_lds_dwordx4 v1, s[8:9] offset:2048
    global_load_lds_dwordx4 v1, s[8:9] offset:3072
    s_add_u32 m0, s28, 65536
    s_nop 0
    global_load_lds_dwordx4 v4, s[8:9]
    s_add_u32 s8, s8, 20480
    s_addc_u32 s9, s9, 0
    global_load_dwordx4 v[144:147], v1, s[12:13] offset:2048
    global_load_dwordx4 v[148:151], v1, s[12:13] offset:3072
    s_add_u32 s12, s12, 4096
    s_addc_u32 s13, s13, 0
    s_barrier
    s_add_u32 m0, s28, 81920
    s_nop 0
    global_load_lds_dwordx4 v1, s[8:9] offset:0
    global_load_lds_dwordx4 v1, s[8:9] offset:1024
    global_load_lds_dwordx4 v1, s[8:9] offset:2048
    global_load_lds_dwordx4 v1, s[8:9] offset:3072
    s_add_u32 m0, s28, 86016
    s_nop 0
    global_load_lds_dwordx4 v4, s[8:9]
    s_add_u32 s8, s8, 20480
    s_addc_u32 s9, s9, 0
    global_load_dwordx4 v[152:155], v1, s[12:13] offset:0
    global_load_dwordx4 v[156:159], v1, s[12:13] offset:1024
    s_barrier
    s_add_u32 m0, s28, 102400
    s_nop 0
    global_load_lds_dwordx4 v1, s[8:9] offset:0
    global_load_lds_dwordx4 v1, s[8:9] offset:1024
    global_load_lds_dwordx4 v1, s[8:9] offset:2048
    global_load_lds_dwordx4 v1, s[8:9] offset:3072
    s_add_u32 m0, s28, 106496
    s_nop 0
    global_load_lds_dwordx4 v4, s[8:9]
    s_add_u32 s8, s8, 20480
    s_addc_u32 s9, s9, 0
    global_load_dwordx4 v[160:163], v1, s[12:13] offset:2048
    global_load_dwordx4 v[164:167], v1, s[12:13] offset:3072
    s_add_u32 s12, s12, 4096
    s_addc_u32 s13, s13, 0
    s_waitcnt vmcnt(33)
    s_barrier
    s_mov_b32 s8, s10
    s_mov_b32 s9, s11
    s_add_u32 m0, s28, 122880
    s_nop 0
    global_load_lds_dwordx4 v1, s[8:9] offset:0
    global_load_lds_dwordx4 v1, s[8:9] offset:1024
    global_load_lds_dwordx4 v1, s[8:9] offset:2048
    global_load_lds_dwordx4 v1, s[8:9] offset:3072
    s_add_u32 m0, s28, 126976
    s_nop 0
    global_load_lds_dwordx4 v4, s[8:9]
    s_add_u32 s8, s8, 20480
    s_addc_u32 s9, s9, 0
    global_load_dwordx4 v[168:171], v1, s[12:13] offset:0
    global_load_dwordx4 v[172:175], v1, s[12:13] offset:1024
    s_waitcnt vmcnt(35)
    s_barrier
    s_add_u32 m0, s28, 143360
    s_nop 0
    global_load_lds_dwordx4 v1, s[8:9] offset:0
    global_load_lds_dwordx4 v1, s[8:9] offset:1024
    global_load_lds_dwordx4 v1, s[8:9] offset:2048
    global_load_lds_dwordx4 v1, s[8:9] offset:3072
    s_add_u32 m0, s28, 147456
    s_nop 0
    global_load_lds_dwordx4 v4, s[8:9]
    s_add_u32 s8, s8, 20480
    s_addc_u32 s9, s9, 0
    global_load_dwordx4 v[176:179], v1, s[12:13] offset:2048
    global_load_dwordx4 v[180:183], v1, s[12:13] offset:3072
    s_add_u32 s12, s12, 4096
    s_addc_u32 s13, s13, 0
    s_waitcnt vmcnt(37)
    s_barrier
    s_add_u32 m0, s28, 0
    s_nop 0
    global_load_lds_dwordx4 v1, s[8:9] offset:0
    global_load_lds_dwordx4 v1, s[8:9] offset:1024
    global_load_lds_dwordx4 v1, s[8:9] offset:2048
    global_load_lds_dwordx4 v1, s[8:9] offset:3072
    s_add_u32 m0, s28, 4096
    s_nop 0
    global_load_lds_dwordx4 v4, s[8:9]
    s_add_u32 s8, s8, 20480
    s_addc_u32 s9, s9, 0
    global_load_dwordx4 v[184:187], v1, s[12:13] offset:0
    global_load_dwordx4 v[188:191], v1, s[12:13] offset:1024
    s_waitcnt vmcnt(37)
    s_barrier
    s_add_u32 m0, s28, 20480
    s_nop 0
    global_load_lds_dwordx4 v1, s[8:9] offset:0
    global_load_lds_dwordx4 v1, s[8:9] offset:1024
    global_load_lds_dwordx4 v1, s[8:9] offset:2048
    global_load_lds_dwordx4 v1, s[8:9] offset:3072
    s_add_u32 m0, s28, 24576
    s_nop 0
    global_load_lds_dwordx4 v4, s[8:9]
    s_add_u32 s8, s8, 20480
    s_addc_u32 s9, s9, 0
    global_load_dwordx4 v[192:195], v1, s[12:13] offset:2048
    global_load_dwordx4 v[196:199], v1, s[12:13] offset:3072
    s_add_u32 s12, s12, 4096
    s_addc_u32 s13, s13, 0
    s_waitcnt vmcnt(37)
    s_barrier
    s_add_u32 m0, s28, 40960
    s_nop 0
    global_load_lds_dwordx4 v1, s[8:9] offset:0
    global_load_lds_dwordx4 v1, s[8:9] offset:1024
    global_load_lds_dwordx4 v1, s[8:9] offset:2048
    global_load_lds_dwordx4 v1, s[8:9] offset:3072
    s_add_u32 m0, s28, 45056
    s_nop 0
    global_load_lds_dwordx4 v4, s[8:9]
    s_add_u32 s8, s8, 20480
    s_addc_u32 s9, s9, 0
    global_load_dwordx4 v[88:91], v1, s[52:53] offset:0 sc1
    global_load_dwordx4 v[92:95], v1, s[54:55] offset:0 sc1
    global_load_dwordx4 v[96:99], v1, s[16:17] offset:0 sc1
    global_load_dwordx4 v[100:103], v1, s[18:19] offset:0 sc1
    s_waitcnt vmcnt(39)
    s_barrier
    s_add_u32 m0, s28, 61440
    s_nop 0
    global_load_lds_dwordx4 v1, s[8:9] offset:0
    global_load_lds_dwordx4 v1, s[8:9] offset:1024
    global_load_lds_dwordx4 v1, s[8:9] offset:2048
    global_load_lds_dwordx4 v1, s[8:9] offset:3072
    s_add_u32 m0, s28, 65536
    s_nop 0
    global_load_lds_dwordx4 v4, s[8:9]
    s_add_u32 s8, s8, 20480
    s_addc_u32 s9, s9, 0
    global_load_dwordx4 v[104:107], v1, s[52:53] offset:1024 sc1
    global_load_dwordx4 v[108:111], v1, s[54:55] offset:1024 sc1
    global_load_dwordx4 v[112:115], v1, s[16:17] offset:1024 sc1
    global_load_dwordx4 v[116:119], v1, s[18:19] offset:1024 sc1
    global_load_dwordx4 v[120:123], v1, s[52:53] offset:2048 sc1
    global_load_dwordx4 v[124:127], v1, s[54:55] offset:2048 sc1
    global_load_dwordx4 v[128:131], v1, s[16:17] offset:2048 sc1
    global_load_dwordx4 v[132:135], v1, s[18:19] offset:2048 sc1
    s_waitcnt vmcnt(45)
    s_barrier
    s_add_u32 m0, s28, 81920
    s_nop 0
    global_load_lds_dwordx4 v1, s[8:9] offset:0
    global_load_lds_dwordx4 v1, s[8:9] offset:1024
    global_load_lds_dwordx4 v1, s[8:9] offset:2048
    global_load_lds_dwordx4 v1, s[8:9] offset:3072
    s_add_u32 m0, s28, 86016
    s_nop 0
    global_load_lds_dwordx4 v4, s[8:9]
    s_add_u32 s8, s8, 20480
    s_addc_u32 s9, s9, 0
    s_waitcnt vmcnt(18)
    v_max3_u32 v0, v88, v92, v96
    v_max_u32 v0, v0, v100
    v_cmp_eq_u32 vcc, -1, v0
    s_cbranch_vccnz .adaLN_cond__spectral_gfnet__glu_gated_bilinear__prompt_kernel_hs123
.adaLN_cond__spectral_gfnet__glu_gated_bilinear__prompt_kernel_hb124:
    v_mfma_f32_16x16x32_bf16 v[8:11], v[136:139], v[88:91], 0
    v_mfma_f32_16x16x32_bf16 v[28:31], v[136:139], v[92:95], 0
    v_mfma_f32_16x16x32_bf16 v[48:51], v[136:139], v[96:99], 0
    v_mfma_f32_16x16x32_bf16 v[68:71], v[136:139], v[100:103], 0
    v_mfma_f32_16x16x32_bf16 v[12:15], v[140:143], v[88:91], 0
    v_mfma_f32_16x16x32_bf16 v[32:35], v[140:143], v[92:95], 0
    v_mfma_f32_16x16x32_bf16 v[52:55], v[140:143], v[96:99], 0
    v_mfma_f32_16x16x32_bf16 v[72:75], v[140:143], v[100:103], 0
    v_mfma_f32_16x16x32_bf16 v[16:19], v[144:147], v[88:91], 0
    v_mfma_f32_16x16x32_bf16 v[36:39], v[144:147], v[92:95], 0
    v_mfma_f32_16x16x32_bf16 v[56:59], v[144:147], v[96:99], 0
    v_mfma_f32_16x16x32_bf16 v[76:79], v[144:147], v[100:103], 0
    v_mfma_f32_16x16x32_bf16 v[20:23], v[148:151], v[88:91], 0
    v_mfma_f32_16x16x32_bf16 v[40:43], v[148:151], v[92:95], 0
    v_mfma_f32_16x16x32_bf16 v[60:63], v[148:151], v[96:99], 0
    v_mfma_f32_16x16x32_bf16 v[80:83], v[148:151], v[100:103], 0
    v_mfma_f32_16x16x32_bf16 v[24:27], v[152:155], v[88:91], 0
    v_mfma_f32_16x16x32_bf16 v[44:47], v[152:155], v[92:95], 0
    v_mfma_f32_16x16x32_bf16 v[64:67], v[152:155], v[96:99], 0
    v_mfma_f32_16x16x32_bf16 v[84:87], v[152:155], v[100:103], 0
    s_waitcnt vmcnt(13)
    s_barrier
    s_mul_i32 s24, s27, 3072
    s_min_u32 s24, s24, 7168
    s_sub_u32 s25, s28, s24
    s_sub_u32 s8, s8, s25
    s_subb_u32 s9, s9, 0
    s_add_u32 m0, s24, 102400
    s_nop 0
    global_load_lds_dwordx4 v1, s[8:9] offset:0
    global_load_lds_dwordx4 v1, s[8:9] offset:1024
    global_load_lds_dwordx4 v1, s[8:9] offset:2048
    s_lshr_b32 s25, s37, 3
    s_lshl_b32 s26, s36, 1
    s_add_u32 s25, s25, s26
    s_mul_i32 s25, s25, 81920
    s_mul_i32 s26, s21, 160
    s_add_u32 s25, s25, s26
    s_add_u32 s25, s25, 7340032
    s_add_u32 s8, s6, s25
    s_addc_u32 s9, s7, 0
    v_add_u32 v6, s24, v1
    v_add_u32 v6, 0, v6
    v_lshrrev_b32 v7, 4, v6
    v_mul_u32_u24 v7, 6554, v7
    v_lshrrev_b32 v7, 16, v7
    v_mul_u32_u24 v7, 1120, v7
    v_add_u32 v6, v6, v7
    s_add_u32 m0, s24, 112640
    s_nop 0
    global_load_lds_dwordx4 v6, s[8:9] sc1
    v_add_u32 v6, s24, v1
    v_add_u32 v6, 1024, v6
    v_lshrrev_b32 v7, 4, v6
    v_mul_u32_u24 v7, 6554, v7
    v_lshrrev_b32 v7, 16, v7
    v_mul_u32_u24 v7, 1120, v7
    v_add_u32 v6, v6, v7
    s_add_u32 m0, s24, 113664
    s_nop 0
    global_load_lds_dwordx4 v6, s[8:9] sc1
    v_add_u32 v6, s24, v1
    v_add_u32 v6, 2048, v6
    v_lshrrev_b32 v7, 4, v6
    v_mul_u32_u24 v7, 6554, v7
    v_lshrrev_b32 v7, 16, v7
    v_mul_u32_u24 v7, 1120, v7
    v_add_u32 v6, v6, v7
    s_add_u32 m0, s24, 114688
    s_nop 0
    global_load_lds_dwordx4 v6, s[8:9] sc1
    s_waitcnt vmcnt(15)
    v_max3_u32 v0, v104, v108, v112
    v_max_u32 v0, v0, v116
    v_cmp_eq_u32 vcc, -1, v0
    s_cbranch_vccnz .adaLN_cond__spectral_gfnet__glu_gated_bilinear__prompt_kernel_hs125
.adaLN_cond__spectral_gfnet__glu_gated_bilinear__prompt_kernel_hb126:
    v_mfma_f32_16x16x32_bf16 v[8:11], v[156:159], v[104:107], v[8:11]
    v_mfma_f32_16x16x32_bf16 v[28:31], v[156:159], v[108:111], v[28:31]
    global_load_dwordx4 v[88:91], v1, s[52:53] offset:3072 sc1
    v_mfma_f32_16x16x32_bf16 v[48:51], v[156:159], v[112:115], v[48:51]
    v_mfma_f32_16x16x32_bf16 v[68:71], v[156:159], v[116:119], v[68:71]
    global_load_dwordx4 v[92:95], v1, s[54:55] offset:3072 sc1
    v_mfma_f32_16x16x32_bf16 v[12:15], v[160:163], v[104:107], v[12:15]
    v_mfma_f32_16x16x32_bf16 v[32:35], v[160:163], v[108:111], v[32:35]
    global_load_dwordx4 v[96:99], v1, s[16:17] offset:3072 sc1
    v_mfma_f32_16x16x32_bf16 v[52:55], v[160:163], v[112:115], v[52:55]
    v_mfma_f32_16x16x32_bf16 v[72:75], v[160:163], v[116:119], v[72:75]
    global_load_dwordx4 v[100:103], v1, s[18:19] offset:3072 sc1
    v_mfma_f32_16x16x32_bf16 v[16:19], v[164:167], v[104:107], v[16:19]
    v_mfma_f32_16x16x32_bf16 v[36:39], v[164:167], v[108:111], v[36:39]
    global_load_dwordx4 v[136:139], v5, s[52:53] offset:0 sc1
    v_mfma_f32_16x16x32_bf16 v[56:59], v[164:167], v[112:115], v[56:59]
    v_mfma_f32_16x16x32_bf16 v[76:79], v[164:167], v[116:119], v[76:79]
    global_load_dwordx4 v[140:143], v5, s[54:55] offset:0 sc1
    v_mfma_f32_16x16x32_bf16 v[20:23], v[168:171], v[104:107], v[20:23]
    v_mfma_f32_16x16x32_bf16 v[40:43], v[168:171], v[108:111], v[40:43]
    global_load_dwordx4 v[144:147], v5, s[16:17] offset:0 sc1
    v_mfma_f32_16x16x32_bf16 v[60:63], v[168:171], v[112:115], v[60:63]
    v_mfma_f32_16x16x32_bf16 v[80:83], v[168:171], v[116:119], v[80:83]
    global_load_dwordx4 v[148:151], v5, s[18:19] offset:0 sc1
    v_mfma_f32_16x16x32_bf16 v[24:27], v[172:175], v[104:107], v[24:27]
    v_mfma_f32_16x16x32_bf16 v[44:47], v[172:175], v[108:111], v[44:47]
    v_mfma_f32_16x16x32_bf16 v[64:67], v[172:175], v[112:115], v[64:67]
    v_mfma_f32_16x16x32_bf16 v[84:87], v[172:175], v[116:119], v[84:87]
    s_waitcnt vmcnt(19)
    v_max3_u32 v0, v120, v124, v128
    v_max_u32 v0, v0, v132
    v_cmp_eq_u32 vcc, -1, v0
    s_cbranch_vccnz .adaLN_cond__spectral_gfnet__glu_gated_bilinear__prompt_kernel_hs127
.adaLN_cond__spectral_gfnet__glu_gated_bilinear__prompt_kernel_hb128:
    v_mfma_f32_16x16x32_bf16 v[8:11], v[176:179], v[120:123], v[8:11]
    v_mfma_f32_16x16x32_bf16 v[28:31], v[176:179], v[124:127], v[28:31]
    global_load_dwordx4 v[104:107], v5, s[52:53] offset:1024 sc1
    v_mfma_f32_16x16x32_bf16 v[48:51], v[176:179], v[128:131], v[48:51]
    v_mfma_f32_16x16x32_bf16 v[68:71], v[176:179], v[132:135], v[68:71]
    global_load_dwordx4 v[108:111], v5, s[54:55] offset:1024 sc1
    v_mfma_f32_16x16x32_bf16 v[12:15], v[180:183], v[120:123], v[12:15]
    v_mfma_f32_16x16x32_bf16 v[32:35], v[180:183], v[124:127], v[32:35]
    global_load_dwordx4 v[112:115], v5, s[16:17] offset:1024 sc1
    v_mfma_f32_16x16x32_bf16 v[52:55], v[180:183], v[128:131], v[52:55]
    v_mfma_f32_16x16x32_bf16 v[72:75], v[180:183], v[132:135], v[72:75]
    global_load_dwordx4 v[116:119], v5, s[18:19] offset:1024 sc1
    v_mfma_f32_16x16x32_bf16 v[16:19], v[184:187], v[120:123], v[16:19]
    v_mfma_f32_16x16x32_bf16 v[36:39], v[184:187], v[124:127], v[36:39]
    v_mfma_f32_16x16x32_bf16 v[56:59], v[184:187], v[128:131], v[56:59]
    v_mfma_f32_16x16x32_bf16 v[76:79], v[184:187], v[132:135], v[76:79]
    v_mfma_f32_16x16x32_bf16 v[20:23], v[188:191], v[120:123], v[20:23]
    v_mfma_f32_16x16x32_bf16 v[40:43], v[188:191], v[124:127], v[40:43]
    v_mfma_f32_16x16x32_bf16 v[60:63], v[188:191], v[128:131], v[60:63]
    v_mfma_f32_16x16x32_bf16 v[80:83], v[188:191], v[132:135], v[80:83]
    v_mfma_f32_16x16x32_bf16 v[24:27], v[192:195], v[120:123], v[24:27]
    v_mfma_f32_16x16x32_bf16 v[44:47], v[192:195], v[124:127], v[44:47]
    v_mfma_f32_16x16x32_bf16 v[64:67], v[192:195], v[128:131], v[64:67]
    v_mfma_f32_16x16x32_bf16 v[84:87], v[192:195], v[132:135], v[84:87]
    s_waitcnt vmcnt(8)
    v_max3_u32 v0, v88, v92, v96
    v_max_u32 v0, v0, v100
    v_cmp_eq_u32 vcc, -1, v0
    s_cbranch_vccnz .adaLN_cond__spectral_gfnet__glu_gated_bilinear__prompt_kernel_hs129
.adaLN_cond__spectral_gfnet__glu_gated_bilinear__prompt_kernel_hb130:
    v_mfma_f32_16x16x32_bf16 v[8:11], v[196:199], v[88:91], v[8:11]
    v_mfma_f32_16x16x32_bf16 v[28:31], v[196:199], v[92:95], v[28:31]
    v_mfma_f32_16x16x32_bf16 v[48:51], v[196:199], v[96:99], v[48:51]
    v_mfma_f32_16x16x32_bf16 v[68:71], v[196:199], v[100:103], v[68:71]
    v_mfma_f32_16x16x32_bf16 v[12:15], v[200:203], v[88:91], v[12:15]
    v_mfma_f32_16x16x32_bf16 v[32:35], v[200:203], v[92:95], v[32:35]
    v_mfma_f32_16x16x32_bf16 v[52:55], v[200:203], v[96:99], v[52:55]
    v_mfma_f32_16x16x32_bf16 v[72:75], v[200:203], v[100:103], v[72:75]
    v_mfma_f32_16x16x32_bf16 v[16:19], v[204:207], v[88:91], v[16:19]
    v_mfma_f32_16x16x32_bf16 v[36:39], v[204:207], v[92:95], v[36:39]
    v_mfma_f32_16x16x32_bf16 v[56:59], v[204:207], v[96:99], v[56:59]
    v_mfma_f32_16x16x32_bf16 v[76:79], v[204:207], v[100:103], v[76:79]
    v_mfma_f32_16x16x32_bf16 v[20:23], v[208:211], v[88:91], v[20:23]
    v_mfma_f32_16x16x32_bf16 v[40:43], v[208:211], v[92:95], v[40:43]
    v_mfma_f32_16x16x32_bf16 v[60:63], v[208:211], v[96:99], v[60:63]
    v_mfma_f32_16x16x32_bf16 v[80:83], v[208:211], v[100:103], v[80:83]
    v_mfma_f32_16x16x32_bf16 v[24:27], v[212:215], v[88:91], v[24:27]
    v_mfma_f32_16x16x32_bf16 v[44:47], v[212:215], v[92:95], v[44:47]
    v_mfma_f32_16x16x32_bf16 v[64:67], v[212:215], v[96:99], v[64:67]
    v_mfma_f32_16x16x32_bf16 v[84:87], v[212:215], v[100:103], v[84:87]
    s_waitcnt vmcnt(4)
    v_max3_u32 v0, v136, v140, v144
    v_max_u32 v0, v0, v148
    v_cmp_eq_u32 vcc, -1, v0
    s_cbranch_vccnz .adaLN_cond__spectral_gfnet__glu_gated_bilinear__prompt_kernel_hs131
.adaLN_cond__spectral_gfnet__glu_gated_bilinear__prompt_kernel_hb132:
    v_mfma_f32_16x16x32_bf16 v[8:11], v[216:219], v[136:139], v[8:11]
    v_mfma_f32_16x16x32_bf16 v[28:31], v[216:219], v[140:143], v[28:31]
    v_mfma_f32_16x16x32_bf16 v[48:51], v[216:219], v[144:147], v[48:51]
    v_mfma_f32_16x16x32_bf16 v[68:71], v[216:219], v[148:151], v[68:71]
    v_mfma_f32_16x16x32_bf16 v[12:15], v[220:223], v[136:139], v[12:15]
    v_mfma_f32_16x16x32_bf16 v[32:35], v[220:223], v[140:143], v[32:35]
    v_mfma_f32_16x16x32_bf16 v[52:55], v[220:223], v[144:147], v[52:55]
    v_mfma_f32_16x16x32_bf16 v[72:75], v[220:223], v[148:151], v[72:75]
    v_mfma_f32_16x16x32_bf16 v[16:19], v[224:227], v[136:139], v[16:19]
    v_mfma_f32_16x16x32_bf16 v[36:39], v[224:227], v[140:143], v[36:39]
    v_mfma_f32_16x16x32_bf16 v[56:59], v[224:227], v[144:147], v[56:59]
    v_mfma_f32_16x16x32_bf16 v[76:79], v[224:227], v[148:151], v[76:79]
    v_mfma_f32_16x16x32_bf16 v[20:23], v[228:231], v[136:139], v[20:23]
    v_mfma_f32_16x16x32_bf16 v[40:43], v[228:231], v[140:143], v[40:43]
    v_mfma_f32_16x16x32_bf16 v[60:63], v[228:231], v[144:147], v[60:63]
    v_mfma_f32_16x16x32_bf16 v[80:83], v[228:231], v[148:151], v[80:83]
    v_mfma_f32_16x16x32_bf16 v[24:27], v[232:235], v[136:139], v[24:27]
    v_mfma_f32_16x16x32_bf16 v[44:47], v[232:235], v[140:143], v[44:47]
    v_mfma_f32_16x16x32_bf16 v[64:67], v[232:235], v[144:147], v[64:67]
    v_mfma_f32_16x16x32_bf16 v[84:87], v[232:235], v[148:151], v[84:87]
    s_waitcnt vmcnt(0)
    v_max3_u32 v0, v104, v108, v112
    v_max_u32 v0, v0, v116
    v_cmp_eq_u32 vcc, -1, v0
    s_cbranch_vccnz .adaLN_cond__spectral_gfnet__glu_gated_bilinear__prompt_kernel_hs133
.adaLN_cond__spectral_gfnet__glu_gated_bilinear__prompt_kernel_hb134:
    v_mfma_f32_16x16x32_bf16 v[8:11], v[236:239], v[104:107], v[8:11]
    v_mfma_f32_16x16x32_bf16 v[28:31], v[236:239], v[108:111], v[28:31]
    v_mfma_f32_16x16x32_bf16 v[48:51], v[236:239], v[112:115], v[48:51]
    v_mfma_f32_16x16x32_bf16 v[68:71], v[236:239], v[116:119], v[68:71]
    v_mfma_f32_16x16x32_bf16 v[12:15], v[240:243], v[104:107], v[12:15]
    v_mfma_f32_16x16x32_bf16 v[32:35], v[240:243], v[108:111], v[32:35]
    v_mfma_f32_16x16x32_bf16 v[52:55], v[240:243], v[112:115], v[52:55]
    v_mfma_f32_16x16x32_bf16 v[72:75], v[240:243], v[116:119], v[72:75]
    v_mfma_f32_16x16x32_bf16 v[16:19], v[244:247], v[104:107], v[16:19]
    v_mfma_f32_16x16x32_bf16 v[36:39], v[244:247], v[108:111], v[36:39]
    v_mfma_f32_16x16x32_bf16 v[56:59], v[244:247], v[112:115], v[56:59]
    v_mfma_f32_16x16x32_bf16 v[76:79], v[244:247], v[116:119], v[76:79]
    v_mfma_f32_16x16x32_bf16 v[20:23], v[248:251], v[104:107], v[20:23]
    v_mfma_f32_16x16x32_bf16 v[40:43], v[248:251], v[108:111], v[40:43]
    v_mfma_f32_16x16x32_bf16 v[60:63], v[248:251], v[112:115], v[60:63]
    v_mfma_f32_16x16x32_bf16 v[80:83], v[248:251], v[116:119], v[80:83]
    v_mfma_f32_16x16x32_bf16 v[24:27], v[252:255], v[104:107], v[24:27]
    v_mfma_f32_16x16x32_bf16 v[44:47], v[252:255], v[108:111], v[44:47]
    v_mfma_f32_16x16x32_bf16 v[64:67], v[252:255], v[112:115], v[64:67]
    v_mfma_f32_16x16x32_bf16 v[84:87], v[252:255], v[116:119], v[84:87]
    s_barrier
    s_mul_i32 s24, s27, 20480
    s_cmp_eq_u32 s27, 3
    s_cselect_b32 s24, 122880, s24
    v_add_u32 v2, s24, v1
    ds_write_b128 v2, v[8:11] offset:0
    ds_write_b128 v2, v[12:15] offset:1024
    ds_write_b128 v2, v[16:19] offset:2048
    ds_write_b128 v2, v[20:23] offset:3072
    ds_write_b128 v2, v[24:27] offset:4096
    ds_write_b128 v2, v[28:31] offset:5120
    ds_write_b128 v2, v[32:35] offset:6144
    ds_write_b128 v2, v[36:39] offset:7168
    ds_write_b128 v2, v[40:43] offset:8192
    ds_write_b128 v2, v[44:47] offset:9216
    ds_write_b128 v2, v[48:51] offset:10240
    ds_write_b128 v2, v[52:55] offset:11264
    ds_write_b128 v2, v[56:59] offset:12288
    ds_write_b128 v2, v[60:63] offset:13312
    ds_write_b128 v2, v[64:67] offset:14336
    ds_write_b128 v2, v[68:71] offset:15360
    ds_write_b128 v2, v[72:75] offset:16384
    ds_write_b128 v2, v[76:79] offset:17408
    ds_write_b128 v2, v[80:83] offset:18432
    ds_write_b128 v2, v[84:87] offset:19456
    s_waitcnt lgkmcnt(0)
    s_barrier
.adaLN_cond__spectral_gfnet__glu_gated_bilinear__prompt_kernel_done1:
    s_endpgm
.adaLN_cond__spectral_gfnet__glu_gated_bilinear__prompt_kernel_tl11:
    v_mov_b32 v126, 0
    global_load_dword v127, v126, s[46:47] sc1
    s_add_u32 s42, s42, 1
    s_waitcnt vmcnt(0)
    v_readfirstlane_b32 s49, v127
    s_cmp_gt_u32 s42, 0x20000
    s_cbranch_scc1 .adaLN_cond__spectral_gfnet__glu_gated_bilinear__prompt_kernel_tok12
    s_cmp_eq_u32 s49, 0
    s_cbranch_scc1 .adaLN_cond__spectral_gfnet__glu_gated_bilinear__prompt_kernel_tl11
    s_branch .adaLN_cond__spectral_gfnet__glu_gated_bilinear__prompt_kernel_tok12
.adaLN_cond__spectral_gfnet__glu_gated_bilinear__prompt_kernel_gr22:
    s_add_u32 s42, s42, 1
    s_cmp_gt_u32 s42, 0x20000
    s_cbranch_scc1 .adaLN_cond__spectral_gfnet__glu_gated_bilinear__prompt_kernel_gok21
    s_sleep 8
    s_branch .adaLN_cond__spectral_gfnet__glu_gated_bilinear__prompt_kernel_gl20
.adaLN_cond__spectral_gfnet__glu_gated_bilinear__prompt_kernel_rt30:
    s_add_u32 s42, s42, 1
    s_cmp_gt_u32 s42, 0x20000
    s_cbranch_scc1 .adaLN_cond__spectral_gfnet__glu_gated_bilinear__prompt_kernel_ok29
    s_sleep 2
    s_branch .adaLN_cond__spectral_gfnet__glu_gated_bilinear__prompt_kernel_pl28
.adaLN_cond__spectral_gfnet__glu_gated_bilinear__prompt_kernel_rt36:
    s_add_u32 s42, s42, 1
    s_cmp_gt_u32 s42, 0x20000
    s_cbranch_scc1 .adaLN_cond__spectral_gfnet__glu_gated_bilinear__prompt_kernel_ok35
    s_sleep 3
    s_branch .adaLN_cond__spectral_gfnet__glu_gated_bilinear__prompt_kernel_pl34
.adaLN_cond__spectral_gfnet__glu_gated_bilinear__prompt_kernel_pr54:
    s_add_u32 s42, s42, 1
    s_cmp_gt_u32 s42, 0x20000
    s_cbranch_scc1 .adaLN_cond__spectral_gfnet__glu_gated_bilinear__prompt_kernel_pok53
    s_waitcnt vmcnt(0)
    s_branch .adaLN_cond__spectral_gfnet__glu_gated_bilinear__prompt_kernel_pl52
.adaLN_cond__spectral_gfnet__glu_gated_bilinear__prompt_kernel_stub55:
    s_add_u32 s24, s38, 0
    s_and_b32 s24, s24, 3
    s_mul_i32 s24, s24, 5120
    v_add_u32 v0, s24, v1
    global_load_dwordx4 v[104:107], v0, s[50:51] offset:-1024 sc1
    v_add_u32 v0, 20480, v0
    global_load_dwordx4 v[108:111], v0, s[50:51] offset:-1024 sc1
    s_add_u32 s42, s42, 1
    s_waitcnt vmcnt(0)
    s_cmp_gt_u32 s42, 0x20000
    s_cbranch_scc1 .adaLN_cond__spectral_gfnet__glu_gated_bilinear__prompt_kernel_back56
    v_bitop3_b32 v0, v104, v108, 1 bitop3:0xa8
    v_cmp_eq_u32 vcc, 1, v0
    s_cbranch_vccnz .adaLN_cond__spectral_gfnet__glu_gated_bilinear__prompt_kernel_stub55
    s_branch .adaLN_cond__spectral_gfnet__glu_gated_bilinear__prompt_kernel_back56
.adaLN_cond__spectral_gfnet__glu_gated_bilinear__prompt_kernel_stub57:
    s_add_u32 s24, s38, 0
    s_and_b32 s24, s24, 3
    s_mul_i32 s24, s24, 5120
    v_add_u32 v0, s24, v1
    global_load_dwordx4 v[112:115], v0, s[50:51] offset:0 sc1
    v_add_u32 v0, 20480, v0
    global_load_dwordx4 v[116:119], v0, s[50:51] offset:0 sc1
    s_add_u32 s42, s42, 1
    s_waitcnt vmcnt(0)
    s_cmp_gt_u32 s42, 0x20000
    s_cbranch_scc1 .adaLN_cond__spectral_gfnet__glu_gated_bilinear__prompt_kernel_back58
    v_bitop3_b32 v0, v112, v116, 1 bitop3:0xa8
    v_cmp_eq_u32 vcc, 1, v0
    s_cbranch_vccnz .adaLN_cond__spectral_gfnet__glu_gated_bilinear__prompt_kernel_stub57
    s_branch .adaLN_cond__spectral_gfnet__glu_gated_bilinear__prompt_kernel_back58
.adaLN_cond__spectral_gfnet__glu_gated_bilinear__prompt_kernel_stub59:
    s_add_u32 s24, s38, 0
    s_and_b32 s24, s24, 3
    s_mul_i32 s24, s24, 5120
    v_add_u32 v0, s24, v1
    global_load_dwordx4 v[120:123], v0, s[50:51] offset:1024 sc1
    v_add_u32 v0, 20480, v0
    global_load_dwordx4 v[124:127], v0, s[50:51] offset:1024 sc1
    s_add_u32 s42, s42, 1
    s_waitcnt vmcnt(0)
    s_cmp_gt_u32 s42, 0x20000
    s_cbranch_scc1 .adaLN_cond__spectral_gfnet__glu_gated_bilinear__prompt_kernel_back60
    v_bitop3_b32 v0, v120, v124, 1 bitop3:0xa8
    v_cmp_eq_u32 vcc, 1, v0
    s_cbranch_vccnz .adaLN_cond__spectral_gfnet__glu_gated_bilinear__prompt_kernel_stub59
    s_branch .adaLN_cond__spectral_gfnet__glu_gated_bilinear__prompt_kernel_back60
.adaLN_cond__spectral_gfnet__glu_gated_bilinear__prompt_kernel_stub61:
    s_add_u32 s24, s38, 0
    s_and_b32 s24, s24, 3
    s_mul_i32 s24, s24, 5120
    v_add_u32 v0, s24, v1
    global_load_dwordx4 v[128:131], v0, s[50:51] offset:2048 sc1
    v_add_u32 v0, 20480, v0
    global_load_dwordx4 v[132:135], v0, s[50:51] offset:2048 sc1
    s_add_u32 s42, s42, 1
    s_waitcnt vmcnt(0)
    s_cmp_gt_u32 s42, 0x20000
    s_cbranch_scc1 .adaLN_cond__spectral_gfnet__glu_gated_bilinear__prompt_kernel_back62
    v_bitop3_b32 v0, v128, v132, 1 bitop3:0xa8
    v_cmp_eq_u32 vcc, 1, v0
    s_cbranch_vccnz .adaLN_cond__spectral_gfnet__glu_gated_bilinear__prompt_kernel_stub61
    s_branch .adaLN_cond__spectral_gfnet__glu_gated_bilinear__prompt_kernel_back62
.adaLN_cond__spectral_gfnet__glu_gated_bilinear__prompt_kernel_stub63:
    s_add_u32 s24, s38, 1
    s_and_b32 s24, s24, 3
    s_mul_i32 s24, s24, 5120
    v_add_u32 v0, s24, v1
    global_load_dwordx4 v[136:139], v0, s[50:51] offset:-2048 sc1
    v_add_u32 v0, 20480, v0
    global_load_dwordx4 v[140:143], v0, s[50:51] offset:-2048 sc1
    s_add_u32 s42, s42, 1
    s_waitcnt vmcnt(0)
    s_cmp_gt_u32 s42, 0x20000
    s_cbranch_scc1 .adaLN_cond__spectral_gfnet__glu_gated_bilinear__prompt_kernel_back64
    v_bitop3_b32 v0, v136, v140, 1 bitop3:0xa8
    v_cmp_eq_u32 vcc, 1, v0
    s_cbranch_vccnz .adaLN_cond__spectral_gfnet__glu_gated_bilinear__prompt_kernel_stub63
    s_branch .adaLN_cond__spectral_gfnet__glu_gated_bilinear__prompt_kernel_back64
.adaLN_cond__spectral_gfnet__glu_gated_bilinear__prompt_kernel_stub65:
    s_add_u32 s24, s38, 1
    s_and_b32 s24, s24, 3
    s_mul_i32 s24, s24, 5120
    v_add_u32 v0, s24, v1
    global_load_dwordx4 v[144:147], v0, s[50:51] offset:-1024 sc1
    v_add_u32 v0, 20480, v0
    global_load_dwordx4 v[148:151], v0, s[50:51] offset:-1024 sc1
    s_add_u32 s42, s42, 1
    s_waitcnt vmcnt(0)
    s_cmp_gt_u32 s42, 0x20000
    s_cbranch_scc1 .adaLN_cond__spectral_gfnet__glu_gated_bilinear__prompt_kernel_back66
    v_bitop3_b32 v0, v144, v148, 1 bitop3:0xa8
    v_cmp_eq_u32 vcc, 1, v0
    s_cbranch_vccnz .adaLN_cond__spectral_gfnet__glu_gated_bilinear__prompt_kernel_stub65
    s_branch .adaLN_cond__spectral_gfnet__glu_gated_bilinear__prompt_kernel_back66
.adaLN_cond__spectral_gfnet__glu_gated_bilinear__prompt_kernel_stub67:
    s_add_u32 s24, s38, 1
    s_and_b32 s24, s24, 3
    s_mul_i32 s24, s24, 5120
    v_add_u32 v0, s24, v1
    global_load_dwordx4 v[152:155], v0, s[50:51] offset:0 sc1
    v_add_u32 v0, 20480, v0
    global_load_dwordx4 v[156:159], v0, s[50:51] offset:0 sc1
    s_add_u32 s42, s42, 1
    s_waitcnt vmcnt(0)
    s_cmp_gt_u32 s42, 0x20000
    s_cbranch_scc1 .adaLN_cond__spectral_gfnet__glu_gated_bilinear__prompt_kernel_back68
    v_bitop3_b32 v0, v152, v156, 1 bitop3:0xa8
    v_cmp_eq_u32 vcc, 1, v0
    s_cbranch_vccnz .adaLN_cond__spectral_gfnet__glu_gated_bilinear__prompt_kernel_stub67
    s_branch .adaLN_cond__spectral_gfnet__glu_gated_bilinear__prompt_kernel_back68
.adaLN_cond__spectral_gfnet__glu_gated_bilinear__prompt_kernel_stub69:
    s_add_u32 s24, s38, 1
    s_and_b32 s24, s24, 3
    s_mul_i32 s24, s24, 5120
    v_add_u32 v0, s24, v1
    global_load_dwordx4 v[160:163], v0, s[50:51] offset:1024 sc1
    v_add_u32 v0, 20480, v0
    global_load_dwordx4 v[164:167], v0, s[50:51] offset:1024 sc1
    s_add_u32 s42, s42, 1
    s_waitcnt vmcnt(0)
    s_cmp_gt_u32 s42, 0x20000
    s_cbranch_scc1 .adaLN_cond__spectral_gfnet__glu_gated_bilinear__prompt_kernel_back70
    v_bitop3_b32 v0, v160, v164, 1 bitop3:0xa8
    v_cmp_eq_u32 vcc, 1, v0
    s_cbranch_vccnz .adaLN_cond__spectral_gfnet__glu_gated_bilinear__prompt_kernel_stub69
    s_branch .adaLN_cond__spectral_gfnet__glu_gated_bilinear__prompt_kernel_back70
.adaLN_cond__spectral_gfnet__glu_gated_bilinear__prompt_kernel_stub71:
    s_add_u32 s24, s38, 1
    s_and_b32 s24, s24, 3
    s_mul_i32 s24, s24, 5120
    v_add_u32 v0, s24, v1
    global_load_dwordx4 v[168:171], v0, s[50:51] offset:2048 sc1
    v_add_u32 v0, 20480, v0
    global_load_dwordx4 v[172:175], v0, s[50:51] offset:2048 sc1
    s_add_u32 s42, s42, 1
    s_waitcnt vmcnt(0)
    s_cmp_gt_u32 s42, 0x20000
    s_cbranch_scc1 .adaLN_cond__spectral_gfnet__glu_gated_bilinear__prompt_kernel_back72
    v_bitop3_b32 v0, v168, v172, 1 bitop3:0xa8
    v_cmp_eq_u32 vcc, 1, v0
    s_cbranch_vccnz .adaLN_cond__spectral_gfnet__glu_gated_bilinear__prompt_kernel_stub71
    s_branch .adaLN_cond__spectral_gfnet__glu_gated_bilinear__prompt_kernel_back72
.adaLN_cond__spectral_gfnet__glu_gated_bilinear__prompt_kernel_stub73:
    s_add_u32 s24, s38, 2
    s_and_b32 s24, s24, 3
    s_mul_i32 s24, s24, 5120
    v_add_u32 v0, s24, v1
    global_load_dwordx4 v[176:179], v0, s[50:51] offset:-2048 sc1
    v_add_u32 v0, 20480, v0
    global_load_dwordx4 v[180:183], v0, s[50:51] offset:-2048 sc1
    s_add_u32 s42, s42, 1
    s_waitcnt vmcnt(0)
    s_cmp_gt_u32 s42, 0x20000
    s_cbranch_scc1 .adaLN_cond__spectral_gfnet__glu_gated_bilinear__prompt_kernel_back74
    v_bitop3_b32 v0, v176, v180, 1 bitop3:0xa8
    v_cmp_eq_u32 vcc, 1, v0
    s_cbranch_vccnz .adaLN_cond__spectral_gfnet__glu_gated_bilinear__prompt_kernel_stub73
    s_branch .adaLN_cond__spectral_gfnet__glu_gated_bilinear__prompt_kernel_back74
.adaLN_cond__spectral_gfnet__glu_gated_bilinear__prompt_kernel_stub75:
    s_add_u32 s24, s38, 2
    s_and_b32 s24, s24, 3
    s_mul_i32 s24, s24, 5120
    v_add_u32 v0, s24, v1
    global_load_dwordx4 v[184:187], v0, s[50:51] offset:-1024 sc1
    v_add_u32 v0, 20480, v0
    global_load_dwordx4 v[188:191], v0, s[50:51] offset:-1024 sc1
    s_add_u32 s42, s42, 1
    s_waitcnt vmcnt(0)
    s_cmp_gt_u32 s42, 0x20000
    s_cbranch_scc1 .adaLN_cond__spectral_gfnet__glu_gated_bilinear__prompt_kernel_back76
    v_bitop3_b32 v0, v184, v188, 1 bitop3:0xa8
    v_cmp_eq_u32 vcc, 1, v0
    s_cbranch_vccnz .adaLN_cond__spectral_gfnet__glu_gated_bilinear__prompt_kernel_stub75
    s_branch .adaLN_cond__spectral_gfnet__glu_gated_bilinear__prompt_kernel_back76
.adaLN_cond__spectral_gfnet__glu_gated_bilinear__prompt_kernel_stub77:
    s_add_u32 s24, s38, 2
    s_and_b32 s24, s24, 3
    s_mul_i32 s24, s24, 5120
    v_add_u32 v0, s24, v1
    global_load_dwordx4 v[192:195], v0, s[50:51] offset:0 sc1
    v_add_u32 v0, 20480, v0
    global_load_dwordx4 v[196:199], v0, s[50:51] offset:0 sc1
    s_add_u32 s42, s42, 1
    s_waitcnt vmcnt(0)
    s_cmp_gt_u32 s42, 0x20000
    s_cbranch_scc1 .adaLN_cond__spectral_gfnet__glu_gated_bilinear__prompt_kernel_back78
    v_bitop3_b32 v0, v192, v196, 1 bitop3:0xa8
    v_cmp_eq_u32 vcc, 1, v0
    s_cbranch_vccnz .adaLN_cond__spectral_gfnet__glu_gated_bilinear__prompt_kernel_stub77
    s_branch .adaLN_cond__spectral_gfnet__glu_gated_bilinear__prompt_kernel_back78
.adaLN_cond__spectral_gfnet__glu_gated_bilinear__prompt_kernel_stub79:
    s_add_u32 s24, s38, 2
    s_and_b32 s24, s24, 3
    s_mul_i32 s24, s24, 5120
    v_add_u32 v0, s24, v1
    global_load_dwordx4 v[200:203], v0, s[50:51] offset:1024 sc1
    v_add_u32 v0, 20480, v0
    global_load_dwordx4 v[204:207], v0, s[50:51] offset:1024 sc1
    s_add_u32 s42, s42, 1
    s_waitcnt vmcnt(0)
    s_cmp_gt_u32 s42, 0x20000
    s_cbranch_scc1 .adaLN_cond__spectral_gfnet__glu_gated_bilinear__prompt_kernel_back80
    v_bitop3_b32 v0, v200, v204, 1 bitop3:0xa8
    v_cmp_eq_u32 vcc, 1, v0
    s_cbranch_vccnz .adaLN_cond__spectral_gfnet__glu_gated_bilinear__prompt_kernel_stub79
    s_branch .adaLN_cond__spectral_gfnet__glu_gated_bilinear__prompt_kernel_back80
.adaLN_cond__spectral_gfnet__glu_gated_bilinear__prompt_kernel_stub81:
    s_add_u32 s24, s38, 2
    s_and_b32 s24, s24, 3
    s_mul_i32 s24, s24, 5120
    v_add_u32 v0, s24, v1
    global_load_dwordx4 v[208:211], v0, s[50:51] offset:2048 sc1
    v_add_u32 v0, 20480, v0
    global_load_dwordx4 v[212:215], v0, s[50:51] offset:2048 sc1
    s_add_u32 s42, s42, 1
    s_waitcnt vmcnt(0)
    s_cmp_gt_u32 s42, 0x20000
    s_cbranch_scc1 .adaLN_cond__spectral_gfnet__glu_gated_bilinear__prompt_kernel_back82
    v_bitop3_b32 v0, v208, v212, 1 bitop3:0xa8
    v_cmp_eq_u32 vcc, 1, v0
    s_cbranch_vccnz .adaLN_cond__spectral_gfnet__glu_gated_bilinear__prompt_kernel_stub81
    s_branch .adaLN_cond__spectral_gfnet__glu_gated_bilinear__prompt_kernel_back82
.adaLN_cond__spectral_gfnet__glu_gated_bilinear__prompt_kernel_stub83:
    s_add_u32 s24, s38, 3
    s_and_b32 s24, s24, 3
    s_mul_i32 s24, s24, 5120
    v_add_u32 v0, s24, v1
    global_load_dwordx4 v[216:219], v0, s[50:51] offset:-2048 sc1
    v_add_u32 v0, 20480, v0
    global_load_dwordx4 v[220:223], v0, s[50:51] offset:-2048 sc1
    s_add_u32 s42, s42, 1
    s_waitcnt vmcnt(0)
    s_cmp_gt_u32 s42, 0x20000
    s_cbranch_scc1 .adaLN_cond__spectral_gfnet__glu_gated_bilinear__prompt_kernel_back84
    v_bitop3_b32 v0, v216, v220, 1 bitop3:0xa8
    v_cmp_eq_u32 vcc, 1, v0
    s_cbranch_vccnz .adaLN_cond__spectral_gfnet__glu_gated_bilinear__prompt_kernel_stub83
    s_branch .adaLN_cond__spectral_gfnet__glu_gated_bilinear__prompt_kernel_back84
.adaLN_cond__spectral_gfnet__glu_gated_bilinear__prompt_kernel_stub85:
    s_add_u32 s24, s38, 3
    s_and_b32 s24, s24, 3
    s_mul_i32 s24, s24, 5120
    v_add_u32 v0, s24, v1
    global_load_dwordx4 v[224:227], v0, s[50:51] offset:-1024 sc1
    v_add_u32 v0, 20480, v0
    global_load_dwordx4 v[228:231], v0, s[50:51] offset:-1024 sc1
    s_add_u32 s42, s42, 1
    s_waitcnt vmcnt(0)
    s_cmp_gt_u32 s42, 0x20000
    s_cbranch_scc1 .adaLN_cond__spectral_gfnet__glu_gated_bilinear__prompt_kernel_back86
    v_bitop3_b32 v0, v224, v228, 1 bitop3:0xa8
    v_cmp_eq_u32 vcc, 1, v0
    s_cbranch_vccnz .adaLN_cond__spectral_gfnet__glu_gated_bilinear__prompt_kernel_stub85
    s_branch .adaLN_cond__spectral_gfnet__glu_gated_bilinear__prompt_kernel_back86
.adaLN_cond__spectral_gfnet__glu_gated_bilinear__prompt_kernel_stub87:
    s_add_u32 s24, s38, 3
    s_and_b32 s24, s24, 3
    s_mul_i32 s24, s24, 5120
    v_add_u32 v0, s24, v1
    global_load_dwordx4 v[232:235], v0, s[50:51] offset:0 sc1
    v_add_u32 v0, 20480, v0
    global_load_dwordx4 v[236:239], v0, s[50:51] offset:0 sc1
    s_add_u32 s42, s42, 1
    s_waitcnt vmcnt(0)
    s_cmp_gt_u32 s42, 0x20000
    s_cbranch_scc1 .adaLN_cond__spectral_gfnet__glu_gated_bilinear__prompt_kernel_back88
    v_bitop3_b32 v0, v232, v236, 1 bitop3:0xa8
    v_cmp_eq_u32 vcc, 1, v0
    s_cbranch_vccnz .adaLN_cond__spectral_gfnet__glu_gated_bilinear__prompt_kernel_stub87
    s_branch .adaLN_cond__spectral_gfnet__glu_gated_bilinear__prompt_kernel_back88
.adaLN_cond__spectral_gfnet__glu_gated_bilinear__prompt_kernel_stub89:
    s_add_u32 s24, s38, 3
    s_and_b32 s24, s24, 3
    s_mul_i32 s24, s24, 5120
    v_add_u32 v0, s24, v1
    global_load_dwordx4 v[240:243], v0, s[50:51] offset:1024 sc1
    v_add_u32 v0, 20480, v0
    global_load_dwordx4 v[244:247], v0, s[50:51] offset:1024 sc1
    s_add_u32 s42, s42, 1
    s_waitcnt vmcnt(0)
    s_cmp_gt_u32 s42, 0x20000
    s_cbranch_scc1 .adaLN_cond__spectral_gfnet__glu_gated_bilinear__prompt_kernel_back90
    v_bitop3_b32 v0, v240, v244, 1 bitop3:0xa8
    v_cmp_eq_u32 vcc, 1, v0
    s_cbranch_vccnz .adaLN_cond__spectral_gfnet__glu_gated_bilinear__prompt_kernel_stub89
    s_branch .adaLN_cond__spectral_gfnet__glu_gated_bilinear__prompt_kernel_back90
.adaLN_cond__spectral_gfnet__glu_gated_bilinear__prompt_kernel_stub91:
    s_add_u32 s24, s38, 3
    s_and_b32 s24, s24, 3
    s_mul_i32 s24, s24, 5120
    v_add_u32 v0, s24, v1
    global_load_dwordx4 v[248:251], v0, s[50:51] offset:2048 sc1
    v_add_u32 v0, 20480, v0
    global_load_dwordx4 v[252:255], v0, s[50:51] offset:2048 sc1
    s_add_u32 s42, s42, 1
    s_waitcnt vmcnt(0)
    s_cmp_gt_u32 s42, 0x20000
    s_cbranch_scc1 .adaLN_cond__spectral_gfnet__glu_gated_bilinear__prompt_kernel_back92
    v_bitop3_b32 v0, v248, v252, 1 bitop3:0xa8
    v_cmp_eq_u32 vcc, 1, v0
    s_cbranch_vccnz .adaLN_cond__spectral_gfnet__glu_gated_bilinear__prompt_kernel_stub91
    s_branch .adaLN_cond__spectral_gfnet__glu_gated_bilinear__prompt_kernel_back92
.adaLN_cond__spectral_gfnet__glu_gated_bilinear__prompt_kernel_hs93:
    s_sleep 4
    v_add_u32 v0, 0, v97
    global_load_dwordx4 v[100:103], v0, s[52:53] offset:-4096 sc1
    global_load_dwordx4 v[104:107], v0, s[54:55] offset:-4096 sc1
    s_add_u32 s42, s42, 1
    s_waitcnt vmcnt(0)
    s_cmp_gt_u32 s42, 0x20000
    s_cbranch_scc1 .adaLN_cond__spectral_gfnet__glu_gated_bilinear__prompt_kernel_hb94
    v_max_u32 v0, v100, v104
    v_cmp_eq_u32 vcc, -1, v0
    s_cbranch_vccnz .adaLN_cond__spectral_gfnet__glu_gated_bilinear__prompt_kernel_hs93
    s_branch .adaLN_cond__spectral_gfnet__glu_gated_bilinear__prompt_kernel_hb94
.adaLN_cond__spectral_gfnet__glu_gated_bilinear__prompt_kernel_hs95:
    s_sleep 4
    v_add_u32 v0, 0, v97
    global_load_dwordx4 v[108:111], v0, s[52:53] offset:-2048 sc1
    global_load_dwordx4 v[112:115], v0, s[54:55] offset:-2048 sc1
    s_add_u32 s42, s42, 1
    s_waitcnt vmcnt(0)
    s_cmp_gt_u32 s42, 0x20000
    s_cbranch_scc1 .adaLN_cond__spectral_gfnet__glu_gated_bilinear__prompt_kernel_hb96
    v_max_u32 v0, v108, v112
    v_cmp_eq_u32 vcc, -1, v0
    s_cbranch_vccnz .adaLN_cond__spectral_gfnet__glu_gated_bilinear__prompt_kernel_hs95
    s_branch .adaLN_cond__spectral_gfnet__glu_gated_bilinear__prompt_kernel_hb96
.adaLN_cond__spectral_gfnet__glu_gated_bilinear__prompt_kernel_hs97:
    s_sleep 4
    v_add_u32 v0, 0, v97
    global_load_dwordx4 v[116:119], v0, s[52:53] offset:0 sc1
    global_load_dwordx4 v[120:123], v0, s[54:55] offset:0 sc1
    s_add_u32 s42, s42, 1
    s_waitcnt vmcnt(0)
    s_cmp_gt_u32 s42, 0x20000
    s_cbranch_scc1 .adaLN_cond__spectral_gfnet__glu_gated_bilinear__prompt_kernel_hb98
    v_max_u32 v0, v116, v120
    v_cmp_eq_u32 vcc, -1, v0
    s_cbranch_vccnz .adaLN_cond__spectral_gfnet__glu_gated_bilinear__prompt_kernel_hs97
    s_branch .adaLN_cond__spectral_gfnet__glu_gated_bilinear__prompt_kernel_hb98
.adaLN_cond__spectral_gfnet__glu_gated_bilinear__prompt_kernel_hs99:
    s_sleep 4
    v_add_u32 v0, 0, v97
    global_load_dwordx4 v[124:127], v0, s[52:53] offset:2048 sc1
    global_load_dwordx4 v[128:131], v0, s[54:55] offset:2048 sc1
    s_add_u32 s42, s42, 1
    s_waitcnt vmcnt(0)
    s_cmp_gt_u32 s42, 0x20000
    s_cbranch_scc1 .adaLN_cond__spectral_gfnet__glu_gated_bilinear__prompt_kernel_hb100
    v_max_u32 v0, v124, v128
    v_cmp_eq_u32 vcc, -1, v0
    s_cbranch_vccnz .adaLN_cond__spectral_gfnet__glu_gated_bilinear__prompt_kernel_hs99
    s_branch .adaLN_cond__spectral_gfnet__glu_gated_bilinear__prompt_kernel_hb100
.adaLN_cond__spectral_gfnet__glu_gated_bilinear__prompt_kernel_hs101:
    s_sleep 4
    v_add_u32 v0, 8192, v97
    global_load_dwordx4 v[132:135], v0, s[52:53] offset:-4096 sc1
    global_load_dwordx4 v[136:139], v0, s[54:55] offset:-4096 sc1
    s_add_u32 s42, s42, 1
    s_waitcnt vmcnt(0)
    s_cmp_gt_u32 s42, 0x20000
    s_cbranch_scc1 .adaLN_cond__spectral_gfnet__glu_gated_bilinear__prompt_kernel_hb102
    v_max_u32 v0, v132, v136
    v_cmp_eq_u32 vcc, -1, v0
    s_cbranch_vccnz .adaLN_cond__spectral_gfnet__glu_gated_bilinear__prompt_kernel_hs101
    s_branch .adaLN_cond__spectral_gfnet__glu_gated_bilinear__prompt_kernel_hb102
.adaLN_cond__spectral_gfnet__glu_gated_bilinear__prompt_kernel_hs103:
    s_sleep 4
    v_add_u32 v0, 8192, v97
    global_load_dwordx4 v[140:143], v0, s[52:53] offset:-2048 sc1
    global_load_dwordx4 v[144:147], v0, s[54:55] offset:-2048 sc1
    s_add_u32 s42, s42, 1
    s_waitcnt vmcnt(0)
    s_cmp_gt_u32 s42, 0x20000
    s_cbranch_scc1 .adaLN_cond__spectral_gfnet__glu_gated_bilinear__prompt_kernel_hb104
    v_max_u32 v0, v140, v144
    v_cmp_eq_u32 vcc, -1, v0
    s_cbranch_vccnz .adaLN_cond__spectral_gfnet__glu_gated_bilinear__prompt_kernel_hs103
    s_branch .adaLN_cond__spectral_gfnet__glu_gated_bilinear__prompt_kernel_hb104
.adaLN_cond__spectral_gfnet__glu_gated_bilinear__prompt_kernel_hs105:
    s_sleep 4
    v_add_u32 v0, 8192, v97
    global_load_dwordx4 v[148:151], v0, s[52:53] offset:0 sc1
    global_load_dwordx4 v[152:155], v0, s[54:55] offset:0 sc1
    s_add_u32 s42, s42, 1
    s_waitcnt vmcnt(0)
    s_cmp_gt_u32 s42, 0x20000
    s_cbranch_scc1 .adaLN_cond__spectral_gfnet__glu_gated_bilinear__prompt_kernel_hb106
    v_max_u32 v0, v148, v152
    v_cmp_eq_u32 vcc, -1, v0
    s_cbranch_vccnz .adaLN_cond__spectral_gfnet__glu_gated_bilinear__prompt_kernel_hs105
    s_branch .adaLN_cond__spectral_gfnet__glu_gated_bilinear__prompt_kernel_hb106
.adaLN_cond__spectral_gfnet__glu_gated_bilinear__prompt_kernel_hs107:
    s_sleep 4
    v_add_u32 v0, 30720, v97
    global_load_dwordx4 v[156:159], v0, s[52:53] offset:-4096 sc1
    global_load_dwordx4 v[160:163], v0, s[54:55] offset:-4096 sc1
    s_add_u32 s42, s42, 1
    s_waitcnt vmcnt(0)
    s_cmp_gt_u32 s42, 0x20000
    s_cbranch_scc1 .adaLN_cond__spectral_gfnet__glu_gated_bilinear__prompt_kernel_hb108
    v_max_u32 v0, v156, v160
    v_cmp_eq_u32 vcc, -1, v0
    s_cbranch_vccnz .adaLN_cond__spectral_gfnet__glu_gated_bilinear__prompt_kernel_hs107
    s_branch .adaLN_cond__spectral_gfnet__glu_gated_bilinear__prompt_kernel_hb108
.adaLN_cond__spectral_gfnet__glu_gated_bilinear__prompt_kernel_hs109:
    s_sleep 4
    v_add_u32 v0, 30720, v97
    global_load_dwordx4 v[164:167], v0, s[52:53] offset:-2048 sc1
    global_load_dwordx4 v[168:171], v0, s[54:55] offset:-2048 sc1
    s_add_u32 s42, s42, 1
    s_waitcnt vmcnt(0)
    s_cmp_gt_u32 s42, 0x20000
    s_cbranch_scc1 .adaLN_cond__spectral_gfnet__glu_gated_bilinear__prompt_kernel_hb110
    v_max_u32 v0, v164, v168
    v_cmp_eq_u32 vcc, -1, v0
    s_cbranch_vccnz .adaLN_cond__spectral_gfnet__glu_gated_bilinear__prompt_kernel_hs109
    s_branch .adaLN_cond__spectral_gfnet__glu_gated_bilinear__prompt_kernel_hb110
.adaLN_cond__spectral_gfnet__glu_gated_bilinear__prompt_kernel_hs111:
    s_sleep 4
    v_add_u32 v0, 30720, v97
    global_load_dwordx4 v[172:175], v0, s[52:53] offset:0 sc1
    global_load_dwordx4 v[176:179], v0, s[54:55] offset:0 sc1
    s_add_u32 s42, s42, 1
    s_waitcnt vmcnt(0)
    s_cmp_gt_u32 s42, 0x20000
    s_cbranch_scc1 .adaLN_cond__spectral_gfnet__glu_gated_bilinear__prompt_kernel_hb112
    v_max_u32 v0, v172, v176
    v_cmp_eq_u32 vcc, -1, v0
    s_cbranch_vccnz .adaLN_cond__spectral_gfnet__glu_gated_bilinear__prompt_kernel_hs111
    s_branch .adaLN_cond__spectral_gfnet__glu_gated_bilinear__prompt_kernel_hb112
.adaLN_cond__spectral_gfnet__glu_gated_bilinear__prompt_kernel_hs113:
    s_sleep 4
    v_add_u32 v0, 30720, v97
    global_load_dwordx4 v[180:183], v0, s[52:53] offset:2048 sc1
    global_load_dwordx4 v[184:187], v0, s[54:55] offset:2048 sc1
    s_add_u32 s42, s42, 1
    s_waitcnt vmcnt(0)
    s_cmp_gt_u32 s42, 0x20000
    s_cbranch_scc1 .adaLN_cond__spectral_gfnet__glu_gated_bilinear__prompt_kernel_hb114
    v_max_u32 v0, v180, v184
    v_cmp_eq_u32 vcc, -1, v0
    s_cbranch_vccnz .adaLN_cond__spectral_gfnet__glu_gated_bilinear__prompt_kernel_hs113
    s_branch .adaLN_cond__spectral_gfnet__glu_gated_bilinear__prompt_kernel_hb114
.adaLN_cond__spectral_gfnet__glu_gated_bilinear__prompt_kernel_hs115:
    s_sleep 4
    v_add_u32 v0, 47104, v98
    global_load_dwordx2 v[188:189], v0, s[52:53] offset:-4096 sc1
    global_load_dwordx2 v[190:191], v0, s[52:53] offset:-3584 sc1
    global_load_dwordx2 v[192:193], v0, s[54:55] offset:-4096 sc1
    global_load_dwordx2 v[194:195], v0, s[54:55] offset:-3584 sc1
    s_add_u32 s42, s42, 1
    s_waitcnt vmcnt(0)
    s_cmp_gt_u32 s42, 0x20000
    s_cbranch_scc1 .adaLN_cond__spectral_gfnet__glu_gated_bilinear__prompt_kernel_hb116
    v_max3_u32 v0, v188, v190, v192
    v_max_u32 v0, v0, v194
    v_cmp_eq_u32 vcc, -1, v0
    s_cbranch_vccnz .adaLN_cond__spectral_gfnet__glu_gated_bilinear__prompt_kernel_hs115
    s_branch .adaLN_cond__spectral_gfnet__glu_gated_bilinear__prompt_kernel_hb116
.adaLN_cond__spectral_gfnet__glu_gated_bilinear__prompt_kernel_hs117:
    s_sleep 4
    v_add_u32 v0, 47104, v98
    global_load_dwordx2 v[196:197], v0, s[52:53] offset:-2048 sc1
    global_load_dwordx2 v[198:199], v0, s[52:53] offset:-1536 sc1
    global_load_dwordx2 v[200:201], v0, s[54:55] offset:-2048 sc1
    global_load_dwordx2 v[202:203], v0, s[54:55] offset:-1536 sc1
    s_add_u32 s42, s42, 1
    s_waitcnt vmcnt(0)
    s_cmp_gt_u32 s42, 0x20000
    s_cbranch_scc1 .adaLN_cond__spectral_gfnet__glu_gated_bilinear__prompt_kernel_hb118
    v_max3_u32 v0, v196, v198, v200
    v_max_u32 v0, v0, v202
    v_cmp_eq_u32 vcc, -1, v0
    s_cbranch_vccnz .adaLN_cond__spectral_gfnet__glu_gated_bilinear__prompt_kernel_hs117
    s_branch .adaLN_cond__spectral_gfnet__glu_gated_bilinear__prompt_kernel_hb118
.adaLN_cond__spectral_gfnet__glu_gated_bilinear__prompt_kernel_hs119:
    s_sleep 4
    v_add_u32 v0, 47104, v98
    global_load_dwordx2 v[204:205], v0, s[52:53] offset:0 sc1
    global_load_dwordx2 v[206:207], v0, s[52:53] offset:512 sc1
    global_load_dwordx2 v[208:209], v0, s[54:55] offset:0 sc1
    global_load_dwordx2 v[210:211], v0, s[54:55] offset:512 sc1
    s_add_u32 s42, s42, 1
    s_waitcnt vmcnt(0)
    s_cmp_gt_u32 s42, 0x20000
    s_cbranch_scc1 .adaLN_cond__spectral_gfnet__glu_gated_bilinear__prompt_kernel_hb120
    v_max3_u32 v0, v204, v206, v208
    v_max_u32 v0, v0, v210
    v_cmp_eq_u32 vcc, -1, v0
    s_cbranch_vccnz .adaLN_cond__spectral_gfnet__glu_gated_bilinear__prompt_kernel_hs119
    s_branch .adaLN_cond__spectral_gfnet__glu_gated_bilinear__prompt_kernel_hb120
.adaLN_cond__spectral_gfnet__glu_gated_bilinear__prompt_kernel_hs121:
    s_sleep 4
    v_add_u32 v0, 47104, v98
    global_load_dwordx2 v[212:213], v0, s[52:53] offset:2048 sc1
    global_load_dwordx2 v[214:215], v0, s[52:53] offset:2560 sc1
    global_load_dwordx2 v[216:217], v0, s[54:55] offset:2048 sc1
    global_load_dwordx2 v[218:219], v0, s[54:55] offset:2560 sc1
    s_add_u32 s42, s42, 1
    s_waitcnt vmcnt(0)
    s_cmp_gt_u32 s42, 0x20000
    s_cbranch_scc1 .adaLN_cond__spectral_gfnet__glu_gated_bilinear__prompt_kernel_hb122
    v_max3_u32 v0, v212, v214, v216
    v_max_u32 v0, v0, v218
    v_cmp_eq_u32 vcc, -1, v0
    s_cbranch_vccnz .adaLN_cond__spectral_gfnet__glu_gated_bilinear__prompt_kernel_hs121
    s_branch .adaLN_cond__spectral_gfnet__glu_gated_bilinear__prompt_kernel_hb122
.adaLN_cond__spectral_gfnet__glu_gated_bilinear__prompt_kernel_hs123:
    s_sleep 4
    global_load_dwordx4 v[88:91], v1, s[52:53] offset:0 sc1
    global_load_dwordx4 v[92:95], v1, s[54:55] offset:0 sc1
    global_load_dwordx4 v[96:99], v1, s[16:17] offset:0 sc1
    global_load_dwordx4 v[100:103], v1, s[18:19] offset:0 sc1
    s_add_u32 s42, s42, 1
    s_waitcnt vmcnt(0)
    s_cmp_gt_u32 s42, 0x20000
    s_cbranch_scc1 .adaLN_cond__spectral_gfnet__glu_gated_bilinear__prompt_kernel_hb124
    v_max3_u32 v0, v88, v92, v96
    v_max_u32 v0, v0, v100
    v_cmp_eq_u32 vcc, -1, v0
    s_cbranch_vccnz .adaLN_cond__spectral_gfnet__glu_gated_bilinear__prompt_kernel_hs123
    s_branch .adaLN_cond__spectral_gfnet__glu_gated_bilinear__prompt_kernel_hb124
.adaLN_cond__spectral_gfnet__glu_gated_bilinear__prompt_kernel_hs125:
    s_sleep 4
    global_load_dwordx4 v[104:107], v1, s[52:53] offset:1024 sc1
    global_load_dwordx4 v[108:111], v1, s[54:55] offset:1024 sc1
    global_load_dwordx4 v[112:115], v1, s[16:17] offset:1024 sc1
    global_load_dwordx4 v[116:119], v1, s[18:19] offset:1024 sc1
    s_add_u32 s42, s42, 1
    s_waitcnt vmcnt(0)
    s_cmp_gt_u32 s42, 0x20000
    s_cbranch_scc1 .adaLN_cond__spectral_gfnet__glu_gated_bilinear__prompt_kernel_hb126
    v_max3_u32 v0, v104, v108, v112
    v_max_u32 v0, v0, v116
    v_cmp_eq_u32 vcc, -1, v0
    s_cbranch_vccnz .adaLN_cond__spectral_gfnet__glu_gated_bilinear__prompt_kernel_hs125
    s_branch .adaLN_cond__spectral_gfnet__glu_gated_bilinear__prompt_kernel_hb126
.adaLN_cond__spectral_gfnet__glu_gated_bilinear__prompt_kernel_hs127:
    s_sleep 4
    global_load_dwordx4 v[120:123], v1, s[52:53] offset:2048 sc1
    global_load_dwordx4 v[124:127], v1, s[54:55] offset:2048 sc1
    global_load_dwordx4 v[128:131], v1, s[16:17] offset:2048 sc1
    global_load_dwordx4 v[132:135], v1, s[18:19] offset:2048 sc1
    s_add_u32 s42, s42, 1
    s_waitcnt vmcnt(0)
    s_cmp_gt_u32 s42, 0x20000
    s_cbranch_scc1 .adaLN_cond__spectral_gfnet__glu_gated_bilinear__prompt_kernel_hb128
    v_max3_u32 v0, v120, v124, v128
    v_max_u32 v0, v0, v132
    v_cmp_eq_u32 vcc, -1, v0
    s_cbranch_vccnz .adaLN_cond__spectral_gfnet__glu_gated_bilinear__prompt_kernel_hs127
    s_branch .adaLN_cond__spectral_gfnet__glu_gated_bilinear__prompt_kernel_hb128
.adaLN_cond__spectral_gfnet__glu_gated_bilinear__prompt_kernel_hs129:
    s_sleep 4
    global_load_dwordx4 v[88:91], v1, s[52:53] offset:3072 sc1
    global_load_dwordx4 v[92:95], v1, s[54:55] offset:3072 sc1
    global_load_dwordx4 v[96:99], v1, s[16:17] offset:3072 sc1
    global_load_dwordx4 v[100:103], v1, s[18:19] offset:3072 sc1
    s_add_u32 s42, s42, 1
    s_waitcnt vmcnt(0)
    s_cmp_gt_u32 s42, 0x20000
    s_cbranch_scc1 .adaLN_cond__spectral_gfnet__glu_gated_bilinear__prompt_kernel_hb130
    v_max3_u32 v0, v88, v92, v96
    v_max_u32 v0, v0, v100
    v_cmp_eq_u32 vcc, -1, v0
    s_cbranch_vccnz .adaLN_cond__spectral_gfnet__glu_gated_bilinear__prompt_kernel_hs129
    s_branch .adaLN_cond__spectral_gfnet__glu_gated_bilinear__prompt_kernel_hb130
.adaLN_cond__spectral_gfnet__glu_gated_bilinear__prompt_kernel_hs131:
    s_sleep 4
    global_load_dwordx4 v[136:139], v5, s[52:53] offset:0 sc1
    global_load_dwordx4 v[140:143], v5, s[54:55] offset:0 sc1
    global_load_dwordx4 v[144:147], v5, s[16:17] offset:0 sc1
    global_load_dwordx4 v[148:151], v5, s[18:19] offset:0 sc1
    s_add_u32 s42, s42, 1
    s_waitcnt vmcnt(0)
    s_cmp_gt_u32 s42, 0x20000
    s_cbranch_scc1 .adaLN_cond__spectral_gfnet__glu_gated_bilinear__prompt_kernel_hb132
    v_max3_u32 v0, v136, v140, v144
    v_max_u32 v0, v0, v148
    v_cmp_eq_u32 vcc, -1, v0
    s_cbranch_vccnz .adaLN_cond__spectral_gfnet__glu_gated_bilinear__prompt_kernel_hs131
    s_branch .adaLN_cond__spectral_gfnet__glu_gated_bilinear__prompt_kernel_hb132
.adaLN_cond__spectral_gfnet__glu_gated_bilinear__prompt_kernel_hs133:
    s_sleep 4
    global_load_dwordx4 v[104:107], v5, s[52:53] offset:1024 sc1
    global_load_dwordx4 v[108:111], v5, s[54:55] offset:1024 sc1
    global_load_dwordx4 v[112:115], v5, s[16:17] offset:1024 sc1
    global_load_dwordx4 v[116:119], v5, s[18:19] offset:1024 sc1
    s_add_u32 s42, s42, 1
    s_waitcnt vmcnt(0)
    s_cmp_gt_u32 s42, 0x20000
    s_cbranch_scc1 .adaLN_cond__spectral_gfnet__glu_gated_bilinear__prompt_kernel_hb134
    v_max3_u32 v0, v104, v108, v112
    v_max_u32 v0, v0, v116
    v_cmp_eq_u32 vcc, -1, v0
    s_cbranch_vccnz .adaLN_cond__spectral_gfnet__glu_gated_bilinear__prompt_kernel_hs133
    s_branch .adaLN_cond__spectral_gfnet__glu_gated_bilinear__prompt_kernel_hb134
.adaLN_cond__spectral_gfnet__glu_gated_bilinear__prompt_kernel_end:
pf_code_end:
.section .rodata,"a"
.p2align 8
pf_tab_begin:
.p2align 6
.amdhsa_kernel adaLN_cond__spectral_gfnet__glu_gated_bilinear__prompt_kernel
  .amdhsa_next_free_vgpr 256
  .amdhsa_next_free_sgpr 56
  .amdhsa_accum_offset 256
  .amdhsa_group_segment_fixed_size 0
  .amdhsa_kernarg_size 96
  .amdhsa_user_sgpr_count 2
  .amdhsa_user_sgpr_kernarg_segment_ptr 1
  .amdhsa_system_sgpr_workgroup_id_x 1
.end_amdhsa_kernel
.p2align 8
.type tab1,@object
tab1:
.long 0x3f803f80,0x3f803f80,0x3f803f80,0x3f803f80,0x3f7d3f80,0x3f643f73,0x3f353f4f,0x3ee83f16
.long 0x3f733f80,0x3f163f4f,0x3e9e,0xbf16be9e,0x3f643f80,0x3e203f16,0xbf35be9e,0xbf7dbf73
.long 0x3f4f3f80,0xbe9e3e9e,0xbf80bf4f,0xbe9ebf4f,0x3f353f80,0xbf350000,0xbf35bf80,0x3f350000
.long 0x3f163f80,0xbf73be9e,0xbf4f,0x3f733f4f,0x3ee83f80,0xbf7dbf16,0x3f35be9e,0x3e203f73
.long 0x3e9e3f80,0xbf4fbf4f,0x3f803e9e,0xbf4f3e9e,0x3e203f80,0xbee8bf73,0x3f353f4f,0xbf64bf16
.long 0x3f80,0xbf80,0x3f80,0xbf80,0xbe203f80,0x3ee8bf73,0xbf353f4f,0x3f64bf16
.long 0xbe9e3f80,0x3f4fbf4f,0xbf803e9e,0x3f4f3e9e,0xbee83f80,0x3f7dbf16,0xbf35be9e,0xbe203f73
.long 0xbf163f80,0x3f73be9e,0xbf4f,0xbf733f4f,0xbf353f80,0x3f350000,0x3f35bf80,0xbf350000
.long 0x3f803f80,0x3f803f80,0x3f803f80,0x3f803f80,0x3e203e9e,0xbe200000,0xbee8be9e,0xbf35bf16
.long 0xbf73bf4f,0xbf73bf80,0xbf16bf4f,0xbe9e,0xbee8bf4f,0x3ee80000,0x3f7d3f4f,0x3f353f73
.long 0x3f4f3e9e,0x3f4f3f80,0xbe9e3e9e,0xbf80bf4f,0x3f353f80,0xbf350000,0xbf35bf80,0x3f350000
.long 0xbf163e9e,0xbf16bf80,0x3f733e9e,0x3f4f,0xbf64bf4f,0x3f640000,0xbe203f4f,0xbf35bf73
.long 0x3e9ebf4f,0x3e9e3f80,0xbf4fbf4f,0x3f803e9e,0x3f7d3e9e,0xbf7d0000,0x3f64be9e,0xbf353f16
.long 0x3f80,0xbf80,0x3f80,0xbf80,0xbf7d3e9e,0x3f7d0000,0xbf64be9e,0x3f353f16
.long 0xbe9ebf4f,0xbe9e3f80,0x3f4fbf4f,0xbf803e9e,0x3f64bf4f,0xbf640000,0x3e203f4f,0x3f35bf73
.long 0x3f163e9e,0x3f16bf80,0xbf733e9e,0x3f4f,0xbf353f80,0x3f350000,0x3f35bf80,0xbf350000
.long 0x3f803f80,0x3f803f80,0x3f803f80,0x3f803f80,0xbf64bf4f,0xbf7dbf73,0xbf7dbf80,0xbf64bf73
.long 0x3f163e9e,0x3f733f4f,0x3f733f80,0x3f163f4f,0xbe203e9e,0xbf64bf16,0xbf64bf80,0xbe20bf16
.long 0xbe9ebf4f,0x3f4f3e9e,0x3f4f3f80,0xbe9e3e9e,0x3f353f80,0xbf350000,0xbf35bf80,0x3f350000
.long 0xbf73bf4f,0x3f16be9e,0x3f163f80,0xbf73be9e,0x3f7d3e9e,0xbee83f16,0xbee8bf80,0x3f7d3f16
.long 0xbf4f3e9e,0x3e9ebf4f,0x3e9e3f80,0xbf4fbf4f,0x3ee8bf4f,0xbe203f73,0xbe20bf80,0x3ee83f73
.long 0x3f80,0xbf80,0x3f80,0xbf80,0xbee8bf4f,0x3e203f73,0x3e20bf80,0xbee83f73
.long 0x3f4f3e9e,0xbe9ebf4f,0xbe9e3f80,0x3f4fbf4f,0xbf7d3e9e,0x3ee83f16,0x3ee8bf80,0xbf7d3f16
.long 0x3f73bf4f,0xbf16be9e,0xbf163f80,0x3f73be9e,0xbf353f80,0x3f350000,0x3f35bf80,0xbf350000
.long 0x3f803f80,0x3f803f80,0x3f803f80,0x3f803f80,0xbf35bf4f,0xbee8bf16,0xbe20be9e,0x3e200000
.long 0x3e9e,0xbf16be9e,0xbf73bf4f,0xbf73bf80,0x3f353e9e,0x3f7d3f73,0x3ee83f4f,0xbee80000
.long 0xbf80bf4f,0xbe9ebf4f,0x3f4f3e9e,0x3f4f3f80,0x3f353f80,0xbf350000,0xbf35bf80,0x3f350000
.long 0xbf4f,0x3f733f4f,0xbf163e9e,0xbf16bf80,0xbf353e9e,0xbe20bf73,0x3f643f4f,0xbf640000
.long 0x3f803e9e,0xbf4f3e9e,0x3e9ebf4f,0x3e9e3f80,0xbf35bf4f,0x3f643f16,0xbf7dbe9e,0x3f7d0000
.long 0x3f80,0xbf80,0x3f80,0xbf80,0x3f35bf4f,0xbf643f16,0x3f7dbe9e,0xbf7d0000
.long 0xbf803e9e,0x3f4f3e9e,0xbe9ebf4f,0xbe9e3f80,0x3f353e9e,0x3e20bf73,0xbf643f4f,0x3f640000
.long 0xbf4f,0xbf733f4f,0x3f163e9e,0x3f16bf80,0xbf353f80,0x3f350000,0x3f35bf80,0xbf350000
.long 0x80008000,0x80008000,0x80008000,0x80008000,0xbe208000,0xbee8be9e,0xbf35bf16,0xbf64bf4f
.long 0xbe9e8000,0xbf4fbf16,0xbf80bf73,0xbf4fbf73,0xbee88000,0xbf7dbf4f,0xbf35bf73,0x3e20be9e
.long 0xbf168000,0xbf73bf73,0x8000bf16,0x3f733f16,0xbf358000,0xbf35bf80,0x3f358000,0x3f353f80
.long 0xbf4f8000,0xbe9ebf73,0x3f803f16,0xbe9e3f16,0xbf648000,0x3e20bf4f,0x3f353f73,0xbf7dbe9e
.long 0xbf738000,0x3f16bf16,0x80003f73,0xbf16bf73,0xbf7d8000,0x3f64be9e,0xbf353f16,0x3ee8bf4f
.long 0xbf808000,0x3f808000,0xbf808000,0x3f808000,0xbf7d8000,0x3f643e9e,0xbf35bf16,0x3ee83f4f
.long 0xbf738000,0x3f163f16,0x8000bf73,0xbf163f73,0xbf648000,0x3e203f4f,0x3f35bf73,0xbf7d3e9e
.long 0xbf4f8000,0xbe9e3f73,0x3f80bf16,0xbe9ebf16,0xbf358000,0xbf353f80,0x3f358000,0x3f35bf80
.long 0x80008000,0x80008000,0x80008000,0x80008000,0xbf7dbf73,0xbf7dbf80,0xbf64bf73,0xbf35bf4f
.long 0xbe9ebf16,0x3e9e8000,0x3f4f3f16,0x3f803f73,0x3f643f16,0x3f643f80,0x3e203f16,0xbf35be9e
.long 0x3f163f73,0xbf168000,0xbf73bf73,0x8000bf16,0xbf358000,0xbf35bf80,0x3f358000,0x3f353f80
.long 0xbf4fbf73,0x3f4f8000,0x3e9e3f73,0xbf80bf16,0x3ee8bf16,0x3ee83f80,0xbf7dbf16,0x3f35be9e
.long 0x3f733f16,0xbf738000,0x3f16bf16,0x80003f73,0xbe203f73,0xbe20bf80,0x3ee83f73,0xbf35bf4f
.long 0xbf808000,0x3f808000,0xbf808000,0x3f808000,0xbe20bf73,0xbe203f80,0x3ee8bf73,0xbf353f4f
.long 0x3f73bf16,0xbf738000,0x3f163f16,0x8000bf73,0x3ee83f16,0x3ee8bf80,0xbf7d3f16,0x3f353e9e
.long 0xbf4f3f73,0x3f4f8000,0x3e9ebf73,0xbf803f16,0xbf358000,0xbf353f80,0x3f358000,0x3f35bf80
.long 0x80008000,0x80008000,0x80008000,0x80008000,0xbee8bf16,0xbe20be9e,0x3e208000,0x3ee83e9e
.long 0x3f4f3f73,0x3e9e3f16,0xbe9e8000,0xbf4fbf16,0xbf7dbf73,0xbee8bf4f,0x3ee88000,0x3f7d3f4f
.long 0x3f733f16,0x3f163f73,0xbf168000,0xbf73bf73,0xbf358000,0xbf35bf80,0x3f358000,0x3f353f80
.long 0x3e9ebf16,0x3f4f3f73,0xbf4f8000,0xbe9ebf73,0x3e203f73,0xbf64bf4f,0x3f648000,0xbe203f4f
.long 0xbf16bf73,0x3f733f16,0xbf738000,0x3f16bf16,0x3f643f16,0xbf7dbe9e,0x3f7d8000,0xbf643e9e
.long 0xbf808000,0x3f808000,0xbf808000,0x3f808000,0x3f64bf16,0xbf7d3e9e,0x3f7d8000,0xbf64be9e
.long 0xbf163f73,0x3f73bf16,0xbf738000,0x3f163f16,0x3e20bf73,0xbf643f4f,0x3f648000,0xbe20bf4f
.long 0x3e9e3f16,0x3f4fbf73,0xbf4f8000,0xbe9e3f73,0xbf358000,0xbf353f80,0x3f358000,0x3f35bf80
.long 0x80008000,0x80008000,0x80008000,0x80008000,0x3f353f16,0x3f643f4f,0x3f7d3f73,0x3f7d3f80
.long 0xbf80bf73,0xbf4fbf73,0xbe9ebf16,0x3e9e8000,0x3f353f73,0xbe203e9e,0xbf64bf16,0xbf64bf80
.long 0x8000bf16,0x3f733f16,0x3f163f73,0xbf168000,0xbf358000,0xbf35bf80,0x3f358000,0x3f353f80
.long 0x3f803f16,0xbe9e3f16,0xbf4fbf73,0x3f4f8000,0xbf35bf73,0x3f7d3e9e,0xbee83f16,0xbee8bf80
.long 0x80003f73,0xbf16bf73,0x3f733f16,0xbf738000,0x3f35bf16,0xbee83f4f,0x3e20bf73,0x3e203f80
.long 0xbf808000,0x3f808000,0xbf808000,0x3f808000,0x3f353f16,0xbee8bf4f,0x3e203f73,0x3e20bf80
.long 0x8000bf73,0xbf163f73,0x3f73bf16,0xbf738000,0xbf353f73,0x3f7dbe9e,0xbee8bf16,0xbee83f80
.long 0x3f80bf16,0xbe9ebf16,0xbf4f3f73,0x3f4f8000,0xbf358000,0xbf353f80,0x3f358000,0x3f35bf80
.long 0xbf4f3f80,0x3e9e3e9e,0x3f80bf4f,0x3e9ebf4f,0xbf643f80,0xbe203f16,0x3f35be9e,0x3f7dbf73
.long 0xbf733f80,0xbf163f4f,0x3e9e,0x3f16be9e,0xbf7d3f80,0xbf643f73,0xbf353f4f,0xbee83f16
.long 0xbf803f80,0xbf803f80,0xbf803f80,0xbf803f80,0x0,0x0,0x0,0x0
.long 0x0,0x0,0x0,0x0,0x0,0x0,0x0,0x0
.long 0x0,0x0,0x0,0x0,0x0,0x0,0x0,0x0
.long 0x0,0x0,0x0,0x0,0x0,0x0,0x0,0x0
.long 0x0,0x0,0x0,0x0,0x0,0x0,0x0,0x0
.long 0x0,0x0,0x0,0x0,0x0,0x0,0x0,0x0
.long 0xbf4f3e9e,0xbf4f3f80,0x3e9e3e9e,0x3f80bf4f,0x3ee8bf4f,0xbee80000,0xbf7d3f4f,0xbf353f73
.long 0x3f73bf4f,0x3f73bf80,0x3f16bf4f,0xbe9e,0xbe203e9e,0x3e200000,0x3ee8be9e,0x3f35bf16
.long 0xbf803f80,0xbf803f80,0xbf803f80,0xbf803f80,0x0,0x0,0x0,0x0
.long 0x0,0x0,0x0,0x0,0x0,0x0,0x0,0x0
.long 0x0,0x0,0x0,0x0,0x0,0x0,0x0,0x0
.long 0x0,0x0,0x0,0x0,0x0,0x0,0x0,0x0
.long 0x0,0x0,0x0,0x0,0x0,0x0,0x0,0x0
.long 0x0,0x0,0x0,0x0,0x0,0x0,0x0,0x0
.long 0x3e9ebf4f,0xbf4f3e9e,0xbf4f3f80,0x3e9e3e9e,0x3e203e9e,0x3f64bf16,0x3f64bf80,0x3e20bf16
.long 0xbf163e9e,0xbf733f4f,0xbf733f80,0xbf163f4f,0x3f64bf4f,0x3f7dbf73,0x3f7dbf80,0x3f64bf73
.long 0xbf803f80,0xbf803f80,0xbf803f80,0xbf803f80,0x0,0x0,0x0,0x0
.long 0x0,0x0,0x0,0x0,0x0,0x0,0x0,0x0
.long 0x0,0x0,0x0,0x0,0x0,0x0,0x0,0x0
.long 0x0,0x0,0x0,0x0,0x0,0x0,0x0,0x0
.long 0x0,0x0,0x0,0x0,0x0,0x0,0x0,0x0
.long 0x0,0x0,0x0,0x0,0x0,0x0,0x0,0x0
.long 0x3f80bf4f,0x3e9ebf4f,0xbf4f3e9e,0xbf4f3f80,0xbf353e9e,0xbf7d3f73,0xbee83f4f,0x3ee80000
.long 0x3e9e,0x3f16be9e,0x3f73bf4f,0x3f73bf80,0x3f35bf4f,0x3ee8bf16,0x3e20be9e,0xbe200000
.long 0xbf803f80,0xbf803f80,0xbf803f80,0xbf803f80,0x0,0x0,0x0,0x0
.long 0x0,0x0,0x0,0x0,0x0,0x0,0x0,0x0
.long 0x0,0x0,0x0,0x0,0x0,0x0,0x0,0x0
.long 0x0,0x0,0x0,0x0,0x0,0x0,0x0,0x0
.long 0x0,0x0,0x0,0x0,0x0,0x0,0x0,0x0
.long 0x0,0x0,0x0,0x0,0x0,0x0,0x0,0x0
.long 0xbf168000,0xbf733f73,0x80003f16,0x3f73bf16,0xbee88000,0xbf7d3f4f,0xbf353f73,0x3e203e9e
.long 0xbe9e8000,0xbf4f3f16,0xbf803f73,0xbf4f3f73,0xbe208000,0xbee83e9e,0xbf353f16,0xbf643f4f
.long 0x80008000,0x80008000,0x80008000,0x80008000,0x0,0x0,0x0,0x0
.long 0x0,0x0,0x0,0x0,0x0,0x0,0x0,0x0
.long 0x0,0x0,0x0,0x0,0x0,0x0,0x0,0x0
.long 0x0,0x0,0x0,0x0,0x0,0x0,0x0,0x0
.long 0x0,0x0,0x0,0x0,0x0,0x0,0x0,0x0
.long 0x0,0x0,0x0,0x0,0x0,0x0,0x0,0x0
.long 0x3f16bf73,0xbf168000,0xbf733f73,0x80003f16,0x3f64bf16,0x3f64bf80,0x3e20bf16,0xbf353e9e
.long 0xbe9e3f16,0x3e9e8000,0x3f4fbf16,0x3f80bf73,0xbf7d3f73,0xbf7d3f80,0xbf643f73,0xbf353f4f
.long 0x80008000,0x80008000,0x80008000,0x80008000,0x0,0x0,0x0,0x0
.long 0x0,0x0,0x0,0x0,0x0,0x0,0x0,0x0
.long 0x0,0x0,0x0,0x0,0x0,0x0,0x0,0x0
.long 0x0,0x0,0x0,0x0,0x0,0x0,0x0,0x0
.long 0x0,0x0,0x0,0x0,0x0,0x0,0x0,0x0
.long 0x0,0x0,0x0,0x0,0x0,0x0,0x0,0x0
.long 0x3f73bf16,0x3f16bf73,0xbf168000,0xbf733f73,0xbf7d3f73,0xbee83f4f,0x3ee88000,0x3f7dbf4f
.long 0x3f4fbf73,0x3e9ebf16,0xbe9e8000,0xbf4f3f16,0xbee83f16,0xbe203e9e,0x3e208000,0x3ee8be9e
.long 0x80008000,0x80008000,0x80008000,0x80008000,0x0,0x0,0x0,0x0
.long 0x0,0x0,0x0,0x0,0x0,0x0,0x0,0x0
.long 0x0,0x0,0x0,0x0,0x0,0x0,0x0,0x0
.long 0x0,0x0,0x0,0x0,0x0,0x0,0x0,0x0
.long 0x0,0x0,0x0,0x0,0x0,0x0,0x0,0x0
.long 0x0,0x0,0x0,0x0,0x0,0x0,0x0,0x0
.long 0x80003f16,0x3f73bf16,0x3f16bf73,0xbf168000,0x3f35bf73,0xbe20be9e,0xbf643f16,0xbf643f80
.long 0xbf803f73,0xbf4f3f73,0xbe9e3f16,0x3e9e8000,0x3f35bf16,0x3f64bf4f,0x3f7dbf73,0x3f7dbf80
.long 0x80008000,0x80008000,0x80008000,0x80008000,0x0,0x0,0x0,0x0
.long 0x0,0x0,0x0,0x0,0x0,0x0,0x0,0x0
.long 0x0,0x0,0x0,0x0,0x0,0x0,0x0,0x0
.long 0x0,0x0,0x0,0x0,0x0,0x0,0x0,0x0
.long 0x0,0x0,0x0,0x0,0x0,0x0,0x0,0x0
.long 0x0,0x0,0x0,0x0,0x0,0x0,0x0,0x0
.long 0x3f803f80,0x3f803f80,0x3f803f80,0x3f803f80,0x3ee83e9e,0x3f353f16,0x3f643f4f,0x3f7d3f73
.long 0xbf16bf4f,0xbe9e,0x3f163e9e,0x3f733f4f,0xbf7dbf4f,0xbf35bf73,0x3e20be9e,0x3f643f16
.long 0xbe9e3e9e,0xbf80bf4f,0xbe9ebf4f,0x3f4f3e9e,0x3f353f80,0xbf350000,0xbf35bf80,0x3f350000
.long 0x3f733e9e,0x3f4f,0xbf73bf4f,0x3f16be9e,0x3e20bf4f,0x3f353f73,0xbf7dbe9e,0x3ee8bf16
.long 0xbf4fbf4f,0x3f803e9e,0xbf4f3e9e,0x3e9ebf4f,0xbf643e9e,0x3f35bf16,0xbee83f4f,0x3e20bf73
.long 0x3f80,0xbf80,0x3f80,0xbf80,0x3f643e9e,0xbf35bf16,0x3ee83f4f,0xbe20bf73
.long 0x3f4fbf4f,0xbf803e9e,0x3f4f3e9e,0xbe9ebf4f,0xbe20bf4f,0xbf353f73,0x3f7dbe9e,0xbee8bf16
.long 0xbf733e9e,0x3f4f,0x3f73bf4f,0xbf16be9e,0xbf353f80,0x3f350000,0x3f35bf80,0xbf350000
.long 0x0,0x0,0x0,0x0,0x0,0x0,0x0,0x0
.long 0x0,0x0,0x0,0x0,0x0,0x0,0x0,0x0
.long 0x0,0x0,0x0,0x0,0x0,0x0,0x0,0x0
.long 0x0,0x0,0x0,0x0,0x0,0x0,0x0,0x0
.long 0x0,0x0,0x0,0x0,0x0,0x0,0x0,0x0
.long 0x0,0x0,0x0,0x0,0x0,0x0,0x0,0x0
.long 0x0,0x0,0x0,0x0,0x0,0x0,0x0,0x0
.long 0x0,0x0,0x0,0x0,0x0,0x0,0x0,0x0
.long 0x0,0x0,0x0,0x0,0x0,0x0,0x0,0x0
.long 0x0,0x0,0x0,0x0,0x0,0x0,0x0,0x0
.long 0x0,0x0,0x0,0x0,0x0,0x0,0x0,0x0
.long 0x0,0x0,0x0,0x0,0x0,0x0,0x0,0x0
.long 0x0,0x0,0x0,0x0,0x0,0x0,0x0,0x0
.long 0x0,0x0,0x0,0x0,0x0,0x0,0x0,0x0
.long 0x0,0x0,0x0,0x0,0x0,0x0,0x0,0x0
.long 0x0,0x0,0x0,0x0,0x0,0x0,0x0,0x0
.long 0x0,0x0,0x0,0x0,0x0,0x0,0x0,0x0
.long 0x0,0x0,0x0,0x0,0x0,0x0,0x0,0x0
.long 0x0,0x0,0x0,0x0,0x0,0x0,0x0,0x0
.long 0x0,0x0,0x0,0x0,0x0,0x0,0x0,0x0
.long 0x0,0x0,0x0,0x0,0x0,0x0,0x0,0x0
.long 0x0,0x0,0x0,0x0,0x0,0x0,0x0,0x0
.long 0x0,0x0,0x0,0x0,0x0,0x0,0x0,0x0
.long 0x0,0x0,0x0,0x0,0x0,0x0,0x0,0x0
.long 0x80008000,0x80008000,0x80008000,0x80008000,0x3f643f73,0x3f353f4f,0x3ee83f16,0x3e203e9e
.long 0x3f4f3f16,0x3f803f73,0x3f4f3f73,0x3e9e3f16,0xbe20bf16,0x3f353e9e,0x3f7d3f73,0x3ee83f4f
.long 0xbf73bf73,0x8000bf16,0x3f733f16,0x3f163f73,0xbf358000,0xbf35bf80,0x3f358000,0x3f353f80
.long 0x3e9e3f73,0xbf80bf16,0x3e9ebf16,0x3f4f3f73,0x3f7d3f16,0xbf353e9e,0xbe20bf73,0x3f643f4f
.long 0x3f16bf16,0x80003f73,0xbf16bf73,0x3f733f16,0xbee8bf73,0x3f353f4f,0xbf64bf16,0x3f7d3e9e
.long 0xbf808000,0x3f808000,0xbf808000,0x3f808000,0xbee83f73,0x3f35bf4f,0xbf643f16,0x3f7dbe9e
.long 0x3f163f16,0x8000bf73,0xbf163f73,0x3f73bf16,0x3f7dbf16,0xbf35be9e,0xbe203f73,0x3f64bf4f
.long 0x3e9ebf73,0xbf803f16,0x3e9e3f16,0x3f4fbf73,0xbf358000,0xbf353f80,0x3f358000,0x3f35bf80
.long 0x0,0x0,0x0,0x0,0x0,0x0,0x0,0x0
.long 0x0,0x0,0x0,0x0,0x0,0x0,0x0,0x0
.long 0x0,0x0,0x0,0x0,0x0,0x0,0x0,0x0
.long 0x0,0x0,0x0,0x0,0x0,0x0,0x0,0x0
.long 0x0,0x0,0x0,0x0,0x0,0x0,0x0,0x0
.long 0x0,0x0,0x0,0x0,0x0,0x0,0x0,0x0
.long 0x0,0x0,0x0,0x0,0x0,0x0,0x0,0x0
.long 0x0,0x0,0x0,0x0,0x0,0x0,0x0,0x0
.long 0x0,0x0,0x0,0x0,0x0,0x0,0x0,0x0
.long 0x0,0x0,0x0,0x0,0x0,0x0,0x0,0x0
.long 0x0,0x0,0x0,0x0,0x0,0x0,0x0,0x0
.long 0x0,0x0,0x0,0x0,0x0,0x0,0x0,0x0
.long 0x0,0x0,0x0,0x0,0x0,0x0,0x0,0x0
.long 0x0,0x0,0x0,0x0,0x0,0x0,0x0,0x0
.long 0x0,0x0,0x0,0x0,0x0,0x0,0x0,0x0
.long 0x0,0x0,0x0,0x0,0x0,0x0,0x0,0x0
.long 0x0,0x0,0x0,0x0,0x0,0x0,0x0,0x0
.long 0x0,0x0,0x0,0x0,0x0,0x0,0x0,0x0
.long 0x0,0x0,0x0,0x0,0x0,0x0,0x0,0x0
.long 0x0,0x0,0x0,0x0,0x0,0x0,0x0,0x0
.long 0x0,0x0,0x0,0x0,0x0,0x0,0x0,0x0
.long 0x0,0x0,0x0,0x0,0x0,0x0,0x0,0x0
.long 0x0,0x0,0x0,0x0,0x0,0x0,0x0,0x0
.long 0x0,0x0,0x0,0x0,0x0,0x0,0x0,0x0
.long 0x3e9e3e9e,0x3f80bf4f,0x3e9ebf4f,0xbf4f3e9e,0x3f7dbf4f,0x3f35bf73,0xbe20be9e,0xbf643f16
.long 0x3f16bf4f,0xbe9e,0xbf163e9e,0xbf733f4f,0xbee83e9e,0xbf353f16,0xbf643f4f,0xbf7d3f73
.long 0xbf803f80,0xbf803f80,0xbf803f80,0xbf803f80,0x0,0x0,0x0,0x0
.long 0x0,0x0,0x0,0x0,0x0,0x0,0x0,0x0
.long 0x0,0x0,0x0,0x0,0x0,0x0,0x0,0x0
.long 0x0,0x0,0x0,0x0,0x0,0x0,0x0,0x0
.long 0x0,0x0,0x0,0x0,0x0,0x0,0x0,0x0
.long 0x0,0x0,0x0,0x0,0x0,0x0,0x0,0x0
.long 0x0,0x0,0x0,0x0,0x0,0x0,0x0,0x0
.long 0x0,0x0,0x0,0x0,0x0,0x0,0x0,0x0
.long 0x0,0x0,0x0,0x0,0x0,0x0,0x0,0x0
.long 0x0,0x0,0x0,0x0,0x0,0x0,0x0,0x0
.long 0x0,0x0,0x0,0x0,0x0,0x0,0x0,0x0
.long 0x0,0x0,0x0,0x0,0x0,0x0,0x0,0x0
.long 0x0,0x0,0x0,0x0,0x0,0x0,0x0,0x0
.long 0x0,0x0,0x0,0x0,0x0,0x0,0x0,0x0
.long 0x0,0x0,0x0,0x0,0x0,0x0,0x0,0x0
.long 0x0,0x0,0x0,0x0,0x0,0x0,0x0,0x0
.long 0x0,0x0,0x0,0x0,0x0,0x0,0x0,0x0
.long 0x0,0x0,0x0,0x0,0x0,0x0,0x0,0x0
.long 0x0,0x0,0x0,0x0,0x0,0x0,0x0,0x0
.long 0x0,0x0,0x0,0x0,0x0,0x0,0x0,0x0
.long 0x0,0x0,0x0,0x0,0x0,0x0,0x0,0x0
.long 0x0,0x0,0x0,0x0,0x0,0x0,0x0,0x0
.long 0x0,0x0,0x0,0x0,0x0,0x0,0x0,0x0
.long 0x0,0x0,0x0,0x0,0x0,0x0,0x0,0x0
.long 0x0,0x0,0x0,0x0,0x0,0x0,0x0,0x0
.long 0x0,0x0,0x0,0x0,0x0,0x0,0x0,0x0
.long 0x0,0x0,0x0,0x0,0x0,0x0,0x0,0x0
.long 0x0,0x0,0x0,0x0,0x0,0x0,0x0,0x0
.long 0x0,0x0,0x0,0x0,0x0,0x0,0x0,0x0
.long 0x0,0x0,0x0,0x0,0x0,0x0,0x0,0x0
.long 0xbf733f73,0x80003f16,0x3f73bf16,0x3f16bf73,0xbe203f16,0x3f35be9e,0x3f7dbf73,0x3ee8bf4f
.long 0x3f4fbf16,0x3f80bf73,0x3f4fbf73,0x3e9ebf16,0x3f64bf73,0x3f35bf4f,0x3ee8bf16,0x3e20be9e
.long 0x80008000,0x80008000,0x80008000,0x80008000,0x0,0x0,0x0,0x0
.long 0x0,0x0,0x0,0x0,0x0,0x0,0x0,0x0
.long 0x0,0x0,0x0,0x0,0x0,0x0,0x0,0x0
.long 0x0,0x0,0x0,0x0,0x0,0x0,0x0,0x0
.long 0x0,0x0,0x0,0x0,0x0,0x0,0x0,0x0
.long 0x0,0x0,0x0,0x0,0x0,0x0,0x0,0x0
.long 0x0,0x0,0x0,0x0,0x0,0x0,0x0,0x0
.long 0x0,0x0,0x0,0x0,0x0,0x0,0x0,0x0
.long 0x0,0x0,0x0,0x0,0x0,0x0,0x0,0x0
.long 0x0,0x0,0x0,0x0,0x0,0x0,0x0,0x0
.long 0x0,0x0,0x0,0x0,0x0,0x0,0x0,0x0
.long 0x0,0x0,0x0,0x0,0x0,0x0,0x0,0x0
.long 0x0,0x0,0x0,0x0,0x0,0x0,0x0,0x0
.long 0x0,0x0,0x0,0x0,0x0,0x0,0x0,0x0
.long 0x0,0x0,0x0,0x0,0x0,0x0,0x0,0x0
.long 0x0,0x0,0x0,0x0,0x0,0x0,0x0,0x0
.long 0x0,0x0,0x0,0x0,0x0,0x0,0x0,0x0
.long 0x0,0x0,0x0,0x0,0x0,0x0,0x0,0x0
.long 0x0,0x0,0x0,0x0,0x0,0x0,0x0,0x0
.long 0x0,0x0,0x0,0x0,0x0,0x0,0x0,0x0
.long 0x0,0x0,0x0,0x0,0x0,0x0,0x0,0x0
.long 0x0,0x0,0x0,0x0,0x0,0x0,0x0,0x0
.long 0x0,0x0,0x0,0x0,0x0,0x0,0x0,0x0
.long 0x0,0x0,0x0,0x0,0x0,0x0,0x0,0x0
.long 0x0,0x0,0x0,0x0,0x0,0x0,0x0,0x0
.long 0x0,0x0,0x0,0x0,0x0,0x0,0x0,0x0
.long 0x0,0x0,0x0,0x0,0x0,0x0,0x0,0x0
.long 0x0,0x0,0x0,0x0,0x0,0x0,0x0,0x0
.long 0x0,0x0,0x0,0x0,0x0,0x0,0x0,0x0
.long 0x0,0x0,0x0,0x0,0x0,0x0,0x0,0x0
.long 0x3f803f80,0x3f803f80,0x0,0x0,0x3f6d3f80,0x3ec43f35,0x3ec40000,0x3f6d3f35
.long 0x3f353f80,0xbf350000,0x3f350000,0x3f353f80,0x3ec43f80,0xbf6dbf35,0x3f6d0000,0xbec43f35
.long 0x3f80,0xbf80,0x3f800000,0xbf800000,0xbec43f80,0x3f6dbf35,0x3f6d0000,0xbec4bf35
.long 0xbf353f80,0x3f350000,0x3f350000,0x3f35bf80,0xbf6d3f80,0xbec43f35,0x3ec40000,0x3f6dbf35
.long 0xbf803f80,0xbf803f80,0x0,0x0,0xbf6d3f80,0xbec43f35,0xbec40000,0xbf6d3f35
.long 0xbf353f80,0x3f350000,0xbf350000,0xbf353f80,0xbec43f80,0x3f6dbf35,0xbf6d0000,0x3ec43f35
.long 0x3f80,0xbf80,0xbf800000,0x3f800000,0x3ec43f80,0xbf6dbf35,0xbf6d0000,0x3ec4bf35
.long 0x3f353f80,0xbf350000,0xbf350000,0xbf35bf80,0x3f6d3f80,0x3ec43f35,0xbec40000,0xbf6dbf35
.long 0x3f803f80,0x3f803f80,0x0,0x0,0xbec40000,0xbf6dbf35,0x3f6d3f80,0x3ec43f35
.long 0xbf35bf80,0x3f350000,0xbf350000,0xbf35bf80,0x3f6d0000,0xbec43f35,0xbec4bf80,0x3f6d3f35
.long 0x3f80,0xbf80,0x3f800000,0xbf800000,0xbf6d0000,0x3ec43f35,0xbec43f80,0x3f6dbf35
.long 0x3f35bf80,0xbf350000,0xbf350000,0xbf353f80,0x3ec40000,0x3f6dbf35,0x3f6dbf80,0x3ec4bf35
.long 0xbf803f80,0xbf803f80,0x0,0x0,0x3ec40000,0x3f6dbf35,0xbf6d3f80,0xbec43f35
.long 0x3f35bf80,0xbf350000,0x3f350000,0x3f35bf80,0xbf6d0000,0x3ec43f35,0x3ec4bf80,0xbf6d3f35
.long 0x3f80,0xbf80,0xbf800000,0x3f800000,0x3f6d0000,0xbec43f35,0x3ec43f80,0xbf6dbf35
.long 0xbf35bf80,0x3f350000,0x3f350000,0x3f353f80,0xbec40000,0xbf6dbf35,0xbf6dbf80,0xbec4bf35
.long 0x3f803f80,0x3f803f80,0x0,0x0,0xbf6dbf80,0xbec4bf35,0xbec40000,0xbf6dbf35
.long 0x3f353f80,0xbf350000,0x3f350000,0x3f353f80,0xbec4bf80,0x3f6d3f35,0xbf6d0000,0x3ec4bf35
.long 0x3f80,0xbf80,0x3f800000,0xbf800000,0x3ec4bf80,0xbf6d3f35,0xbf6d0000,0x3ec43f35
.long 0xbf353f80,0x3f350000,0x3f350000,0x3f35bf80,0x3f6dbf80,0x3ec4bf35,0xbec40000,0xbf6d3f35
.long 0xbf803f80,0xbf803f80,0x0,0x0,0x3f6dbf80,0x3ec4bf35,0x3ec40000,0x3f6dbf35
.long 0xbf353f80,0x3f350000,0xbf350000,0xbf353f80,0x3ec4bf80,0xbf6d3f35,0x3f6d0000,0xbec4bf35
.long 0x3f80,0xbf80,0xbf800000,0x3f800000,0xbec4bf80,0x3f6d3f35,0x3f6d0000,0xbec43f35
.long 0x3f353f80,0xbf350000,0xbf350000,0xbf35bf80,0xbf6dbf80,0xbec4bf35,0x3ec40000,0x3f6d3f35
.long 0x3f803f80,0x3f803f80,0x0,0x0,0x3ec40000,0x3f6d3f35,0xbf6dbf80,0xbec4bf35
.long 0xbf35bf80,0x3f350000,0xbf350000,0xbf35bf80,0xbf6d0000,0x3ec4bf35,0x3ec43f80,0xbf6dbf35
.long 0x3f80,0xbf80,0x3f800000,0xbf800000,0x3f6d0000,0xbec4bf35,0x3ec4bf80,0xbf6d3f35
.long 0x3f35bf80,0xbf350000,0xbf350000,0xbf353f80,0xbec40000,0xbf6d3f35,0xbf6d3f80,0xbec43f35
.long 0xbf803f80,0xbf803f80,0x0,0x0,0xbec40000,0xbf6d3f35,0x3f6dbf80,0x3ec4bf35
.long 0x3f35bf80,0xbf350000,0x3f350000,0x3f35bf80,0x3f6d0000,0xbec4bf35,0xbec43f80,0x3f6dbf35
.long 0x3f80,0xbf80,0xbf800000,0x3f800000,0xbf6d0000,0x3ec4bf35,0xbec4bf80,0x3f6d3f35
.long 0xbf35bf80,0x3f350000,0x3f350000,0x3f353f80,0x3ec40000,0x3f6d3f35,0x3f6d3f80,0x3ec43f35
.long 0x80008000,0x80008000,0x3f803f80,0x3f803f80,0xbec48000,0xbf6dbf35,0x3f6d3f80,0x3ec43f35
.long 0xbf358000,0xbf35bf80,0x3f353f80,0xbf350000,0xbf6d8000,0x3ec4bf35,0x3ec43f80,0xbf6dbf35
.long 0xbf808000,0x3f808000,0x3f80,0xbf80,0xbf6d8000,0x3ec43f35,0xbec43f80,0x3f6dbf35
.long 0xbf358000,0xbf353f80,0xbf353f80,0x3f350000,0xbec48000,0xbf6d3f35,0xbf6d3f80,0xbec43f35
.long 0x0,0x0,0x3f80bf80,0x3f80bf80,0xbec40000,0xbf6d3f35,0x3f6dbf80,0x3ec4bf35
.long 0xbf350000,0xbf353f80,0x3f35bf80,0xbf358000,0xbf6d0000,0x3ec43f35,0x3ec4bf80,0xbf6d3f35
.long 0xbf800000,0x3f800000,0x8000bf80,0x80003f80,0xbf6d0000,0x3ec4bf35,0xbec4bf80,0x3f6d3f35
.long 0xbf350000,0xbf35bf80,0xbf35bf80,0x3f358000,0xbec40000,0xbf6dbf35,0xbf6dbf80,0xbec4bf35
.long 0x80008000,0x80008000,0x3f803f80,0x3f803f80,0xbf6dbf80,0xbec4bf35,0xbec40000,0xbf6dbf35
.long 0x3f358000,0x3f353f80,0xbf35bf80,0x3f350000,0x3ec43f80,0xbf6dbf35,0x3f6d0000,0xbec43f35
.long 0xbf808000,0x3f808000,0x3f80,0xbf80,0x3ec4bf80,0xbf6d3f35,0xbf6d0000,0x3ec43f35
.long 0x3f358000,0x3f35bf80,0x3f35bf80,0xbf350000,0xbf6d3f80,0xbec43f35,0x3ec40000,0x3f6dbf35
.long 0x0,0x0,0x3f80bf80,0x3f80bf80,0xbf6d3f80,0xbec43f35,0xbec48000,0xbf6d3f35
.long 0x3f350000,0x3f35bf80,0xbf353f80,0x3f358000,0x3ec4bf80,0xbf6d3f35,0x3f6d8000,0xbec4bf35
.long 0xbf800000,0x3f800000,0x8000bf80,0x80003f80,0x3ec43f80,0xbf6dbf35,0xbf6d8000,0x3ec4bf35
.long 0x3f350000,0x3f353f80,0x3f353f80,0xbf358000,0xbf6dbf80,0xbec4bf35,0x3ec48000,0x3f6d3f35
.long 0x80008000,0x80008000,0x3f803f80,0x3f803f80,0x3ec48000,0x3f6d3f35,0xbf6dbf80,0xbec4bf35
.long 0xbf358000,0xbf35bf80,0x3f353f80,0xbf350000,0x3f6d8000,0xbec43f35,0xbec4bf80,0x3f6d3f35
.long 0xbf808000,0x3f808000,0x3f80,0xbf80,0x3f6d8000,0xbec4bf35,0x3ec4bf80,0xbf6d3f35
.long 0xbf358000,0xbf353f80,0xbf353f80,0x3f350000,0x3ec48000,0x3f6dbf35,0x3f6dbf80,0x3ec4bf35
.long 0x0,0x0,0x3f80bf80,0x3f80bf80,0x3ec40000,0x3f6dbf35,0xbf6d3f80,0xbec43f35
.long 0xbf350000,0xbf353f80,0x3f35bf80,0xbf358000,0x3f6d0000,0xbec4bf35,0xbec43f80,0x3f6dbf35
.long 0xbf800000,0x3f800000,0x8000bf80,0x80003f80,0x3f6d0000,0xbec43f35,0x3ec43f80,0xbf6dbf35
.long 0xbf350000,0xbf35bf80,0xbf35bf80,0x3f358000,0x3ec40000,0x3f6d3f35,0x3f6d3f80,0x3ec43f35
.long 0x80008000,0x80008000,0x3f803f80,0x3f803f80,0x3f6d3f80,0x3ec43f35,0x3ec40000,0x3f6d3f35
.long 0x3f358000,0x3f353f80,0xbf35bf80,0x3f350000,0xbec4bf80,0x3f6d3f35,0xbf6d0000,0x3ec4bf35
.long 0xbf808000,0x3f808000,0x3f80,0xbf80,0xbec43f80,0x3f6dbf35,0x3f6d0000,0xbec4bf35
.long 0x3f358000,0x3f35bf80,0x3f35bf80,0xbf350000,0x3f6dbf80,0x3ec4bf35,0xbec40000,0xbf6d3f35
.long 0x0,0x0,0x3f80bf80,0x3f80bf80,0x3f6dbf80,0x3ec4bf35,0x3ec48000,0x3f6dbf35
.long 0x3f350000,0x3f35bf80,0xbf353f80,0x3f358000,0xbec43f80,0x3f6dbf35,0xbf6d8000,0x3ec43f35
.long 0xbf800000,0x3f800000,0x8000bf80,0x80003f80,0xbec4bf80,0x3f6d3f35,0x3f6d8000,0xbec43f35
.long 0x3f350000,0x3f353f80,0x3f353f80,0xbf358000,0x3f6d3f80,0x3ec43f35,0xbec48000,0xbf6dbf35
.size tab1, 10240
.p2align 8
.type tab2,@object
tab2:
.long 0x3f803f80,0x3f803f80,0x3f803f80,0x3f803f80,0x3f7f3f80,0x3f753f7b,0x3f623f6d,0x3f463f55
.long 0x3f7b3f80,0x3f553f6d,0x3f0e3f35,0x3e483ec4,0x3f753f80,0x3f223f55,0x3dc93ec4,0xbef1be48
.long 0x3f6d3f80,0x3ec43f35,0xbec40000,0xbf6dbf35,0x3f623f80,0x3dc93f0e,0xbf46bec4,0xbf75bf7b
.long 0x3f553f80,0xbe483ec4,0xbf7bbf35,0xbf0ebf6d,0x3f463f80,0xbef13e48,0xbf75bf6d,0x3dc9bf0e
.long 0x3f353f80,0xbf350000,0xbf35bf80,0x3f350000,0x3f223f80,0xbf62be48,0xbe95bf6d,0x3f7f3f0e
.long 0x3f0e3f80,0xbf7bbec4,0x3e48bf35,0x3f553f6d,0x3ef13f80,0xbf7fbf0e,0x3f22bec4,0x3e953f7b
.long 0x3ec43f80,0xbf6dbf35,0x3f6d0000,0xbec43f35,0x3e953f80,0xbf46bf55,0x3f7f3ec4,0xbf623e48
.long 0x3e483f80,0xbf0ebf6d,0x3f553f35,0xbf7bbec4,0x3dc93f80,0xbe95bf7b,0x3ef13f6d,0xbf22bf55
.long 0x3f803f80,0x3f803f80,0x3f803f80,0x3f803f80,0x3f223f35,0x3ef13f0e,0x3e953ec4,0x3dc93e48
.long 0xbe480000,0xbf0ebec4,0xbf55bf35,0xbf7bbf6d,0xbf62bf35,0xbf7fbf7b,0xbf46bf6d,0xbe95bf0e
.long 0xbf6dbf80,0xbec4bf35,0x3ec40000,0x3f6d3f35,0xbe95bf35,0x3f223e48,0x3f7f3f6d,0x3ef13f55
.long 0x3f0e0000,0x3f7b3f6d,0x3e483f35,0xbf55bec4,0x3f7f3f35,0x3e953f55,0xbf62bec4,0xbf22bf7b
.long 0x3f353f80,0xbf350000,0xbf35bf80,0x3f350000,0xbdc93f35,0xbf75bf55,0x3ef1bec4,0x3f463f7b
.long 0xbf550000,0xbe48bf6d,0x3f7b3f35,0xbf0e3ec4,0xbf75bf35,0x3f46be48,0x3dc93f6d,0xbf62bf55
.long 0xbec4bf80,0x3f6d3f35,0xbf6d0000,0x3ec4bf35,0x3ef1bf35,0x3dc93f7b,0xbf22bf6d,0x3f753f0e
.long 0x3f7b0000,0xbf553ec4,0x3f0ebf35,0xbe483f6d,0x3f463f35,0xbf62bf0e,0x3f753ec4,0xbf7fbe48
.long 0x3f803f80,0x3f803f80,0x3f803f80,0x3f803f80,0xbdc90000,0xbe95be48,0xbef1bec4,0xbf22bf0e
.long 0xbf7bbf80,0xbf55bf6d,0xbf0ebf35,0xbe48bec4,0x3e950000,0x3f463f0e,0x3f7f3f6d,0x3f623f7b
.long 0x3f6d3f80,0x3ec43f35,0xbec40000,0xbf6dbf35,0xbef10000,0xbf7fbf55,0xbf22bf6d,0x3e95be48
.long 0xbf55bf80,0x3e48bec4,0x3f7b3f35,0x3f0e3f6d,0x3f220000,0x3f623f7b,0xbe953ec4,0xbf7fbf55
.long 0x3f353f80,0xbf350000,0xbf35bf80,0x3f350000,0xbf460000,0xbef1bf7b,0x3f753ec4,0x3dc93f55
.long 0xbf0ebf80,0x3f7b3ec4,0xbe483f35,0xbf55bf6d,0x3f620000,0xbdc93f55,0xbf46bf6d,0x3f753e48
.long 0x3ec43f80,0xbf6dbf35,0x3f6d0000,0xbec43f35,0xbf750000,0x3f22bf0e,0xbdc93f6d,0xbef1bf7b
.long 0xbe48bf80,0x3f0e3f6d,0xbf55bf35,0x3f7b3ec4,0x3f7f0000,0xbf753e48,0x3f62bec4,0xbf463f0e
.long 0x3f803f80,0x3f803f80,0x3f803f80,0x3f803f80,0xbf46bf35,0xbf62bf55,0xbf75bf6d,0xbf7fbf7b
.long 0x3e480000,0x3f0e3ec4,0x3f553f35,0x3f7b3f6d,0x3ef13f35,0xbdc93e48,0xbf22bec4,0xbf75bf55
.long 0xbf6dbf80,0xbec4bf35,0x3ec40000,0x3f6d3f35,0x3f753f35,0x3f463f7b,0xbdc93ec4,0xbf62bf0e
.long 0xbf0e0000,0xbf7bbf6d,0xbe48bf35,0x3f553ec4,0xbdc9bf35,0x3f753f0e,0x3ef13f6d,0xbf46be48
.long 0x3f353f80,0xbf350000,0xbf35bf80,0x3f350000,0xbf7fbf35,0x3e95bf0e,0x3f623f6d,0xbf223e48
.long 0x3f550000,0x3e483f6d,0xbf7bbf35,0x3f0ebec4,0xbe953f35,0xbf22bf7b,0x3f7f3ec4,0xbef13f0e
.long 0xbec4bf80,0x3f6d3f35,0xbf6d0000,0x3ec4bf35,0x3f623f35,0xbf7fbe48,0x3f46bec4,0xbe953f55
.long 0xbf7b0000,0x3f55bec4,0xbf0e3f35,0x3e48bf6d,0x3f22bf35,0xbef13f55,0x3e95bf6d,0xbdc93f7b
.long 0x80008000,0x80008000,0x80008000,0x80008000,0xbdc98000,0xbe95be48,0xbef1bec4,0xbf22bf0e
.long 0xbe488000,0xbf0ebec4,0xbf55bf35,0xbf7bbf6d,0xbe958000,0xbf46bf0e,0xbf7fbf6d,0xbf62bf7b
.long 0xbec48000,0xbf6dbf35,0xbf6dbf80,0xbec4bf35,0xbef18000,0xbf7fbf55,0xbf22bf6d,0x3e95be48
.long 0xbf0e8000,0xbf7bbf6d,0xbe48bf35,0x3f553ec4,0xbf228000,0xbf62bf7b,0x3e95bec4,0x3f7f3f55
.long 0xbf358000,0xbf35bf80,0x3f358000,0x3f353f80,0xbf468000,0xbef1bf7b,0x3f753ec4,0x3dc93f55
.long 0xbf558000,0xbe48bf6d,0x3f7b3f35,0xbf0e3ec4,0xbf628000,0x3dc9bf55,0x3f463f6d,0xbf75be48
.long 0xbf6d8000,0x3ec4bf35,0x3ec43f80,0xbf6dbf35,0xbf758000,0x3f22bf0e,0xbdc93f6d,0xbef1bf7b
.long 0xbf7b8000,0x3f55bec4,0xbf0e3f35,0x3e48bf6d,0xbf7f8000,0x3f75be48,0xbf623ec4,0x3f46bf0e
.long 0x80008000,0x80008000,0x80008000,0x80008000,0xbf46bf35,0xbf62bf55,0xbf75bf6d,0xbf7fbf7b
.long 0xbf7bbf80,0xbf55bf6d,0xbf0ebf35,0xbe48bec4,0xbef1bf35,0x3dc9be48,0x3f223ec4,0x3f753f55
.long 0x3ec48000,0x3f6d3f35,0x3f6d3f80,0x3ec43f35,0x3f753f35,0x3f463f7b,0xbdc93ec4,0xbf62bf0e
.long 0x3f553f80,0xbe483ec4,0xbf7bbf35,0xbf0ebf6d,0x3dc93f35,0xbf75bf0e,0xbef1bf6d,0x3f463e48
.long 0xbf358000,0xbf35bf80,0x3f358000,0x3f353f80,0xbf7fbf35,0x3e95bf0e,0x3f623f6d,0xbf223e48
.long 0xbf0ebf80,0x3f7b3ec4,0xbe483f35,0xbf55bf6d,0x3e95bf35,0x3f223f7b,0xbf7fbec4,0x3ef1bf0e
.long 0x3f6d8000,0xbec43f35,0xbec4bf80,0x3f6d3f35,0x3f623f35,0xbf7fbe48,0x3f46bec4,0xbe953f55
.long 0x3e483f80,0xbf0ebf6d,0x3f553f35,0xbf7bbec4,0xbf223f35,0x3ef1bf55,0xbe953f6d,0x3dc9bf7b
.long 0x80008000,0x80008000,0x80008000,0x80008000,0xbf7fbf80,0xbf75bf7b,0xbf62bf6d,0xbf46bf55
.long 0x3e488000,0x3f0e3ec4,0x3f553f35,0x3f7b3f6d,0x3f753f80,0x3f223f55,0x3dc93ec4,0xbef1be48
.long 0xbec48000,0xbf6dbf35,0xbf6dbf80,0xbec4bf35,0xbf62bf80,0xbdc9bf0e,0x3f463ec4,0x3f753f7b
.long 0x3f0e8000,0x3f7b3f6d,0x3e483f35,0xbf55bec4,0x3f463f80,0xbef13e48,0xbf75bf6d,0x3dc9bf0e
.long 0xbf358000,0xbf35bf80,0x3f358000,0x3f353f80,0xbf22bf80,0x3f623e48,0x3e953f6d,0xbf7fbf0e
.long 0x3f558000,0x3e483f6d,0xbf7bbf35,0x3f0ebec4,0x3ef13f80,0xbf7fbf0e,0x3f22bec4,0x3e953f7b
.long 0xbf6d8000,0x3ec4bf35,0x3ec43f80,0xbf6dbf35,0xbe95bf80,0x3f463f55,0xbf7fbec4,0x3f62be48
.long 0x3f7b8000,0xbf553ec4,0x3f0ebf35,0xbe483f6d,0x3dc93f80,0xbe95bf7b,0x3ef13f6d,0xbf22bf55
.long 0x80008000,0x80008000,0x80008000,0x80008000,0xbf22bf35,0xbef1bf0e,0xbe95bec4,0xbdc9be48
.long 0x3f7b3f80,0x3f553f6d,0x3f0e3f35,0x3e483ec4,0xbf62bf35,0xbf7fbf7b,0xbf46bf6d,0xbe95bf0e
.long 0x3ec48000,0x3f6d3f35,0x3f6d3f80,0x3ec43f35,0x3e953f35,0xbf22be48,0xbf7fbf6d,0xbef1bf55
.long 0xbf55bf80,0x3e48bec4,0x3f7b3f35,0x3f0e3f6d,0x3f7f3f35,0x3e953f55,0xbf62bec4,0xbf22bf7b
.long 0xbf358000,0xbf35bf80,0x3f358000,0x3f353f80,0x3dc9bf35,0x3f753f55,0xbef13ec4,0xbf46bf7b
.long 0x3f0e3f80,0xbf7bbec4,0x3e48bf35,0x3f553f6d,0xbf75bf35,0x3f46be48,0x3dc93f6d,0xbf62bf55
.long 0x3f6d8000,0xbec43f35,0xbec4bf80,0x3f6d3f35,0xbef13f35,0xbdc9bf7b,0x3f223f6d,0xbf75bf0e
.long 0xbe48bf80,0x3f0e3f6d,0xbf55bf35,0x3f7b3ec4,0x3f463f35,0xbf62bf0e,0x3f753ec4,0xbf7fbe48
.long 0x3f803f80,0x3f803f80,0x3f803f80,0x3f803f80,0xbf7fbf80,0xbf75bf7b,0xbf62bf6d,0xbf46bf55
.long 0x3f7b3f80,0x3f553f6d,0x3f0e3f35,0x3e483ec4,0xbf75bf80,0xbf22bf55,0xbdc9bec4,0x3ef13e48
.long 0x3f6d3f80,0x3ec43f35,0xbec40000,0xbf6dbf35,0xbf62bf80,0xbdc9bf0e,0x3f463ec4,0x3f753f7b
.long 0x3f553f80,0xbe483ec4,0xbf7bbf35,0xbf0ebf6d,0xbf46bf80,0x3ef1be48,0x3f753f6d,0xbdc93f0e
.long 0x3f353f80,0xbf350000,0xbf35bf80,0x3f350000,0xbf22bf80,0x3f623e48,0x3e953f6d,0xbf7fbf0e
.long 0x3f0e3f80,0xbf7bbec4,0x3e48bf35,0x3f553f6d,0xbef1bf80,0x3f7f3f0e,0xbf223ec4,0xbe95bf7b
.long 0x3ec43f80,0xbf6dbf35,0x3f6d0000,0xbec43f35,0xbe95bf80,0x3f463f55,0xbf7fbec4,0x3f62be48
.long 0x3e483f80,0xbf0ebf6d,0x3f553f35,0xbf7bbec4,0xbdc9bf80,0x3e953f7b,0xbef1bf6d,0x3f223f55
.long 0x3f803f80,0x3f803f80,0x3f803f80,0x3f803f80,0xbf22bf35,0xbef1bf0e,0xbe95bec4,0xbdc9be48
.long 0xbe480000,0xbf0ebec4,0xbf55bf35,0xbf7bbf6d,0x3f623f35,0x3f7f3f7b,0x3f463f6d,0x3e953f0e
.long 0xbf6dbf80,0xbec4bf35,0x3ec40000,0x3f6d3f35,0x3e953f35,0xbf22be48,0xbf7fbf6d,0xbef1bf55
.long 0x3f0e0000,0x3f7b3f6d,0x3e483f35,0xbf55bec4,0xbf7fbf35,0xbe95bf55,0x3f623ec4,0x3f223f7b
.long 0x3f353f80,0xbf350000,0xbf35bf80,0x3f350000,0x3dc9bf35,0x3f753f55,0xbef13ec4,0xbf46bf7b
.long 0xbf550000,0xbe48bf6d,0x3f7b3f35,0xbf0e3ec4,0x3f753f35,0xbf463e48,0xbdc9bf6d,0x3f623f55
.long 0xbec4bf80,0x3f6d3f35,0xbf6d0000,0x3ec4bf35,0xbef13f35,0xbdc9bf7b,0x3f223f6d,0xbf75bf0e
.long 0x3f7b0000,0xbf553ec4,0x3f0ebf35,0xbe483f6d,0xbf46bf35,0x3f623f0e,0xbf75bec4,0x3f7f3e48
.long 0x3f803f80,0x3f803f80,0x3f803f80,0x3f803f80,0x3dc90000,0x3e953e48,0x3ef13ec4,0x3f223f0e
.long 0xbf7bbf80,0xbf55bf6d,0xbf0ebf35,0xbe48bec4,0xbe950000,0xbf46bf0e,0xbf7fbf6d,0xbf62bf7b
.long 0x3f6d3f80,0x3ec43f35,0xbec40000,0xbf6dbf35,0x3ef10000,0x3f7f3f55,0x3f223f6d,0xbe953e48
.long 0xbf55bf80,0x3e48bec4,0x3f7b3f35,0x3f0e3f6d,0xbf220000,0xbf62bf7b,0x3e95bec4,0x3f7f3f55
.long 0x3f353f80,0xbf350000,0xbf35bf80,0x3f350000,0x3f460000,0x3ef13f7b,0xbf75bec4,0xbdc9bf55
.long 0xbf0ebf80,0x3f7b3ec4,0xbe483f35,0xbf55bf6d,0xbf620000,0x3dc9bf55,0x3f463f6d,0xbf75be48
.long 0x3ec43f80,0xbf6dbf35,0x3f6d0000,0xbec43f35,0x3f750000,0xbf223f0e,0x3dc9bf6d,0x3ef13f7b
.long 0xbe48bf80,0x3f0e3f6d,0xbf55bf35,0x3f7b3ec4,0xbf7f0000,0x3f75be48,0xbf623ec4,0x3f46bf0e
.long 0x3f803f80,0x3f803f80,0x3f803f80,0x3f803f80,0x3f463f35,0x3f623f55,0x3f753f6d,0x3f7f3f7b
.long 0x3e480000,0x3f0e3ec4,0x3f553f35,0x3f7b3f6d,0xbef1bf35,0x3dc9be48,0x3f223ec4,0x3f753f55
.long 0xbf6dbf80,0xbec4bf35,0x3ec40000,0x3f6d3f35,0xbf75bf35,0xbf46bf7b,0x3dc9bec4,0x3f623f0e
.long 0xbf0e0000,0xbf7bbf6d,0xbe48bf35,0x3f553ec4,0x3dc93f35,0xbf75bf0e,0xbef1bf6d,0x3f463e48
.long 0x3f353f80,0xbf350000,0xbf35bf80,0x3f350000,0x3f7f3f35,0xbe953f0e,0xbf62bf6d,0x3f22be48
.long 0x3f550000,0x3e483f6d,0xbf7bbf35,0x3f0ebec4,0x3e95bf35,0x3f223f7b,0xbf7fbec4,0x3ef1bf0e
.long 0xbec4bf80,0x3f6d3f35,0xbf6d0000,0x3ec4bf35,0xbf62bf35,0x3f7f3e48,0xbf463ec4,0x3e95bf55
.long 0xbf7b0000,0x3f55bec4,0xbf0e3f35,0x3e48bf6d,0xbf223f35,0x3ef1bf55,0xbe953f6d,0x3dc9bf7b
.long 0x80008000,0x80008000,0x80008000,0x80008000,0x3dc98000,0x3e953e48,0x3ef13ec4,0x3f223f0e
.long 0xbe488000,0xbf0ebec4,0xbf55bf35,0xbf7bbf6d,0x3e958000,0x3f463f0e,0x3f7f3f6d,0x3f623f7b
.long 0xbec48000,0xbf6dbf35,0xbf6dbf80,0xbec4bf35,0x3ef18000,0x3f7f3f55,0x3f223f6d,0xbe953e48
.long 0xbf0e8000,0xbf7bbf6d,0xbe48bf35,0x3f553ec4,0x3f228000,0x3f623f7b,0xbe953ec4,0xbf7fbf55
.long 0xbf358000,0xbf35bf80,0x3f358000,0x3f353f80,0x3f468000,0x3ef13f7b,0xbf75bec4,0xbdc9bf55
.long 0xbf558000,0xbe48bf6d,0x3f7b3f35,0xbf0e3ec4,0x3f628000,0xbdc93f55,0xbf46bf6d,0x3f753e48
.long 0xbf6d8000,0x3ec4bf35,0x3ec43f80,0xbf6dbf35,0x3f758000,0xbf223f0e,0x3dc9bf6d,0x3ef13f7b
.long 0xbf7b8000,0x3f55bec4,0xbf0e3f35,0x3e48bf6d,0x3f7f8000,0xbf753e48,0x3f62bec4,0xbf463f0e
.long 0x80008000,0x80008000,0x80008000,0x80008000,0x3f463f35,0x3f623f55,0x3f753f6d,0x3f7f3f7b
.long 0xbf7bbf80,0xbf55bf6d,0xbf0ebf35,0xbe48bec4,0x3ef13f35,0xbdc93e48,0xbf22bec4,0xbf75bf55
.long 0x3ec48000,0x3f6d3f35,0x3f6d3f80,0x3ec43f35,0xbf75bf35,0xbf46bf7b,0x3dc9bec4,0x3f623f0e
.long 0x3f553f80,0xbe483ec4,0xbf7bbf35,0xbf0ebf6d,0xbdc9bf35,0x3f753f0e,0x3ef13f6d,0xbf46be48
.long 0xbf358000,0xbf35bf80,0x3f358000,0x3f353f80,0x3f7f3f35,0xbe953f0e,0xbf62bf6d,0x3f22be48
.long 0xbf0ebf80,0x3f7b3ec4,0xbe483f35,0xbf55bf6d,0xbe953f35,0xbf22bf7b,0x3f7f3ec4,0xbef13f0e
.long 0x3f6d8000,0xbec43f35,0xbec4bf80,0x3f6d3f35,0xbf62bf35,0x3f7f3e48,0xbf463ec4,0x3e95bf55
.long 0x3e483f80,0xbf0ebf6d,0x3f553f35,0xbf7bbec4,0x3f22bf35,0xbef13f55,0x3e95bf6d,0xbdc93f7b
.long 0x80008000,0x80008000,0x80008000,0x80008000,0x3f7f3f80,0x3f753f7b,0x3f623f6d,0x3f463f55
.long 0x3e488000,0x3f0e3ec4,0x3f553f35,0x3f7b3f6d,0xbf75bf80,0xbf22bf55,0xbdc9bec4,0x3ef13e48
.long 0xbec48000,0xbf6dbf35,0xbf6dbf80,0xbec4bf35,0x3f623f80,0x3dc93f0e,0xbf46bec4,0xbf75bf7b
.long 0x3f0e8000,0x3f7b3f6d,0x3e483f35,0xbf55bec4,0xbf46bf80,0x3ef1be48,0x3f753f6d,0xbdc93f0e
.long 0xbf358000,0xbf35bf80,0x3f358000,0x3f353f80,0x3f223f80,0xbf62be48,0xbe95bf6d,0x3f7f3f0e
.long 0x3f558000,0x3e483f6d,0xbf7bbf35,0x3f0ebec4,0xbef1bf80,0x3f7f3f0e,0xbf223ec4,0xbe95bf7b
.long 0xbf6d8000,0x3ec4bf35,0x3ec43f80,0xbf6dbf35,0x3e953f80,0xbf46bf55,0x3f7f3ec4,0xbf623e48
.long 0x3f7b8000,0xbf553ec4,0x3f0ebf35,0xbe483f6d,0xbdc9bf80,0x3e953f7b,0xbef1bf6d,0x3f223f55
.long 0x80008000,0x80008000,0x80008000,0x80008000,0x3f223f35,0x3ef13f0e,0x3e953ec4,0x3dc93e48
.long 0x3f7b3f80,0x3f553f6d,0x3f0e3f35,0x3e483ec4,0x3f623f35,0x3f7f3f7b,0x3f463f6d,0x3e953f0e
.long 0x3ec48000,0x3f6d3f35,0x3f6d3f80,0x3ec43f35,0xbe95bf35,0x3f223e48,0x3f7f3f6d,0x3ef13f55
.long 0xbf55bf80,0x3e48bec4,0x3f7b3f35,0x3f0e3f6d,0xbf7fbf35,0xbe95bf55,0x3f623ec4,0x3f223f7b
.long 0xbf358000,0xbf35bf80,0x3f358000,0x3f353f80,0xbdc93f35,0xbf75bf55,0x3ef1bec4,0x3f463f7b
.long 0x3f0e3f80,0xbf7bbec4,0x3e48bf35,0x3f553f6d,0x3f753f35,0xbf463e48,0xbdc9bf6d,0x3f623f55
.long 0x3f6d8000,0xbec43f35,0xbec4bf80,0x3f6d3f35,0x3ef1bf35,0x3dc93f7b,0xbf22bf6d,0x3f753f0e
.long 0xbe48bf80,0x3f0e3f6d,0xbf55bf35,0x3f7b3ec4,0xbf46bf35,0x3f623f0e,0xbf75bec4,0x3f7f3e48
.long 0x3f80,0xbf80,0x3f80,0xbf80,0xbdc93f80,0x3e95bf7b,0xbef13f6d,0x3f22bf55
.long 0xbe483f80,0x3f0ebf6d,0xbf553f35,0x3f7bbec4,0xbe953f80,0x3f46bf55,0xbf7f3ec4,0x3f623e48
.long 0xbec43f80,0x3f6dbf35,0xbf6d0000,0x3ec43f35,0xbef13f80,0x3f7fbf0e,0xbf22bec4,0xbe953f7b
.long 0xbf0e3f80,0x3f7bbec4,0xbe48bf35,0xbf553f6d,0xbf223f80,0x3f62be48,0x3e95bf6d,0xbf7f3f0e
.long 0xbf353f80,0x3f350000,0x3f35bf80,0xbf350000,0xbf463f80,0x3ef13e48,0x3f75bf6d,0xbdc9bf0e
.long 0xbf553f80,0x3e483ec4,0x3f7bbf35,0x3f0ebf6d,0xbf623f80,0xbdc93f0e,0x3f46bec4,0x3f75bf7b
.long 0xbf6d3f80,0xbec43f35,0x3ec40000,0x3f6dbf35,0xbf753f80,0xbf223f55,0xbdc93ec4,0x3ef1be48
.long 0xbf7b3f80,0xbf553f6d,0xbf0e3f35,0xbe483ec4,0xbf7f3f80,0xbf753f7b,0xbf623f6d,0xbf463f55
.long 0x3f80,0xbf80,0x3f80,0xbf80,0xbf463f35,0x3f62bf0e,0xbf753ec4,0x3f7fbe48
.long 0xbf7b0000,0x3f553ec4,0xbf0ebf35,0x3e483f6d,0xbef1bf35,0xbdc93f7b,0x3f22bf6d,0xbf753f0e
.long 0x3ec4bf80,0xbf6d3f35,0x3f6d0000,0xbec4bf35,0x3f75bf35,0xbf46be48,0xbdc93f6d,0x3f62bf55
.long 0x3f550000,0x3e48bf6d,0xbf7b3f35,0x3f0e3ec4,0x3dc93f35,0x3f75bf55,0xbef1bec4,0xbf463f7b
.long 0xbf353f80,0x3f350000,0x3f35bf80,0xbf350000,0xbf7f3f35,0xbe953f55,0x3f62bec4,0x3f22bf7b
.long 0xbf0e0000,0xbf7b3f6d,0xbe483f35,0x3f55bec4,0x3e95bf35,0xbf223e48,0xbf7f3f6d,0xbef13f55
.long 0x3f6dbf80,0x3ec4bf35,0xbec40000,0xbf6d3f35,0x3f62bf35,0x3f7fbf7b,0x3f46bf6d,0x3e95bf0e
.long 0x3e480000,0x3f0ebec4,0x3f55bf35,0x3f7bbf6d,0xbf223f35,0xbef13f0e,0xbe953ec4,0xbdc93e48
.long 0x3f80,0xbf80,0x3f80,0xbf80,0xbf7f0000,0x3f753e48,0xbf62bec4,0x3f463f0e
.long 0x3e48bf80,0xbf0e3f6d,0x3f55bf35,0xbf7b3ec4,0x3f750000,0xbf22bf0e,0x3dc93f6d,0x3ef1bf7b
.long 0xbec43f80,0x3f6dbf35,0xbf6d0000,0x3ec43f35,0xbf620000,0x3dc93f55,0x3f46bf6d,0xbf753e48
.long 0x3f0ebf80,0xbf7b3ec4,0x3e483f35,0x3f55bf6d,0x3f460000,0x3ef1bf7b,0xbf753ec4,0xbdc93f55
.long 0xbf353f80,0x3f350000,0x3f35bf80,0xbf350000,0xbf220000,0xbf623f7b,0x3e953ec4,0x3f7fbf55
.long 0x3f55bf80,0xbe48bec4,0xbf7b3f35,0xbf0e3f6d,0x3ef10000,0x3f7fbf55,0x3f22bf6d,0xbe95be48
.long 0xbf6d3f80,0xbec43f35,0x3ec40000,0x3f6dbf35,0xbe950000,0xbf463f0e,0xbf7f3f6d,0xbf623f7b
.long 0x3f7bbf80,0x3f55bf6d,0x3f0ebf35,0x3e48bec4,0x3dc90000,0x3e95be48,0x3ef1bec4,0x3f22bf0e
.long 0x3f80,0xbf80,0x3f80,0xbf80,0xbf22bf35,0x3ef13f55,0xbe95bf6d,0x3dc93f7b
.long 0x3f7b0000,0xbf55bec4,0x3f0e3f35,0xbe48bf6d,0xbf623f35,0x3f7fbe48,0xbf46bec4,0x3e953f55
.long 0x3ec4bf80,0xbf6d3f35,0x3f6d0000,0xbec4bf35,0x3e953f35,0x3f22bf7b,0xbf7f3ec4,0x3ef13f0e
.long 0xbf550000,0xbe483f6d,0x3f7bbf35,0xbf0ebec4,0x3f7fbf35,0xbe95bf0e,0xbf623f6d,0x3f223e48
.long 0xbf353f80,0x3f350000,0x3f35bf80,0xbf350000,0x3dc9bf35,0xbf753f0e,0xbef13f6d,0x3f46be48
.long 0x3f0e0000,0x3f7bbf6d,0x3e48bf35,0xbf553ec4,0xbf753f35,0xbf463f7b,0x3dc93ec4,0x3f62bf0e
.long 0x3f6dbf80,0x3ec4bf35,0xbec40000,0xbf6d3f35,0xbef13f35,0x3dc93e48,0x3f22bec4,0x3f75bf55
.long 0xbe480000,0xbf0e3ec4,0xbf553f35,0xbf7b3f6d,0x3f46bf35,0x3f62bf55,0x3f75bf6d,0x3f7fbf7b
.long 0xbf808000,0x3f808000,0xbf808000,0x3f808000,0xbf7f8000,0x3f753e48,0xbf62bec4,0x3f463f0e
.long 0xbf7b8000,0x3f553ec4,0xbf0ebf35,0x3e483f6d,0xbf758000,0x3f223f0e,0xbdc9bf6d,0xbef13f7b
.long 0xbf6d8000,0x3ec43f35,0x3ec4bf80,0xbf6d3f35,0xbf628000,0x3dc93f55,0x3f46bf6d,0xbf753e48
.long 0xbf558000,0xbe483f6d,0x3f7bbf35,0xbf0ebec4,0xbf468000,0xbef13f7b,0x3f75bec4,0x3dc9bf55
.long 0xbf358000,0xbf353f80,0x3f358000,0x3f35bf80,0xbf228000,0xbf623f7b,0x3e953ec4,0x3f7fbf55
.long 0xbf0e8000,0xbf7b3f6d,0xbe483f35,0x3f55bec4,0xbef18000,0xbf7f3f55,0xbf223f6d,0x3e953e48
.long 0xbec48000,0xbf6d3f35,0xbf6d3f80,0xbec43f35,0xbe958000,0xbf463f0e,0xbf7f3f6d,0xbf623f7b
.long 0xbe488000,0xbf0e3ec4,0xbf553f35,0xbf7b3f6d,0xbdc98000,0xbe953e48,0xbef13ec4,0xbf223f0e
.long 0xbf808000,0x3f808000,0xbf808000,0x3f808000,0xbf22bf35,0x3ef13f55,0xbe95bf6d,0x3dc93f7b
.long 0x3e48bf80,0xbf0e3f6d,0x3f55bf35,0xbf7b3ec4,0x3f62bf35,0xbf7f3e48,0x3f463ec4,0xbe95bf55
.long 0x3f6d8000,0xbec4bf35,0xbec43f80,0x3f6dbf35,0x3e953f35,0x3f22bf7b,0xbf7f3ec4,0x3ef13f0e
.long 0xbf0e3f80,0x3f7bbec4,0xbe48bf35,0xbf553f6d,0xbf7f3f35,0x3e953f0e,0x3f62bf6d,0xbf22be48
.long 0xbf358000,0xbf353f80,0x3f358000,0x3f35bf80,0x3dc9bf35,0xbf753f0e,0xbef13f6d,0x3f46be48
.long 0x3f55bf80,0xbe48bec4,0xbf7b3f35,0xbf0e3f6d,0x3f75bf35,0x3f46bf7b,0xbdc9bec4,0xbf623f0e
.long 0x3ec48000,0x3f6dbf35,0x3f6dbf80,0x3ec4bf35,0xbef13f35,0x3dc93e48,0x3f22bec4,0x3f75bf55
.long 0xbf7b3f80,0xbf553f6d,0xbf0e3f35,0xbe483ec4,0xbf463f35,0xbf623f55,0xbf753f6d,0xbf7f3f7b
.long 0xbf808000,0x3f808000,0xbf808000,0x3f808000,0x3dc9bf80,0xbe953f7b,0x3ef1bf6d,0xbf223f55
.long 0x3f7b8000,0xbf55bec4,0x3f0e3f35,0xbe48bf6d,0xbe953f80,0x3f46bf55,0xbf7f3ec4,0x3f623e48
.long 0xbf6d8000,0x3ec43f35,0x3ec4bf80,0xbf6d3f35,0x3ef1bf80,0xbf7f3f0e,0x3f223ec4,0x3e95bf7b
.long 0x3f558000,0x3e48bf6d,0xbf7b3f35,0x3f0e3ec4,0xbf223f80,0x3f62be48,0x3e95bf6d,0xbf7f3f0e
.long 0xbf358000,0xbf353f80,0x3f358000,0x3f35bf80,0x3f46bf80,0xbef1be48,0xbf753f6d,0x3dc93f0e
.long 0x3f0e8000,0x3f7bbf6d,0x3e48bf35,0xbf553ec4,0xbf623f80,0xbdc93f0e,0x3f46bec4,0x3f75bf7b
.long 0xbec48000,0xbf6d3f35,0xbf6d3f80,0xbec43f35,0x3f75bf80,0x3f22bf55,0x3dc9bec4,0xbef13e48
.long 0x3e488000,0x3f0ebec4,0x3f55bf35,0x3f7bbf6d,0xbf7f3f80,0xbf753f7b,0xbf623f6d,0xbf463f55
.long 0xbf808000,0x3f808000,0xbf808000,0x3f808000,0x3f46bf35,0xbf623f0e,0x3f75bec4,0xbf7f3e48
.long 0xbe483f80,0x3f0ebf6d,0xbf553f35,0x3f7bbec4,0xbef1bf35,0xbdc93f7b,0x3f22bf6d,0xbf753f0e
.long 0x3f6d8000,0xbec4bf35,0xbec43f80,0x3f6dbf35,0xbf753f35,0x3f463e48,0x3dc9bf6d,0xbf623f55
.long 0x3f0ebf80,0xbf7b3ec4,0x3e483f35,0x3f55bf6d,0x3dc93f35,0x3f75bf55,0xbef1bec4,0xbf463f7b
.long 0xbf358000,0xbf353f80,0x3f358000,0x3f35bf80,0x3f7fbf35,0x3e95bf55,0xbf623ec4,0xbf223f7b
.long 0xbf553f80,0x3e483ec4,0x3f7bbf35,0x3f0ebf6d,0x3e95bf35,0xbf223e48,0xbf7f3f6d,0xbef13f55
.long 0x3ec48000,0x3f6dbf35,0x3f6dbf80,0x3ec4bf35,0xbf623f35,0xbf7f3f7b,0xbf463f6d,0xbe953f0e
.long 0x3f7bbf80,0x3f55bf6d,0x3f0ebf35,0x3e48bec4,0xbf223f35,0xbef13f0e,0xbe953ec4,0xbdc93e48
.long 0x3f80,0xbf80,0x3f80,0xbf80,0x3dc9bf80,0xbe953f7b,0x3ef1bf6d,0xbf223f55
.long 0xbe483f80,0x3f0ebf6d,0xbf553f35,0x3f7bbec4,0x3e95bf80,0xbf463f55,0x3f7fbec4,0xbf62be48
.long 0xbec43f80,0x3f6dbf35,0xbf6d0000,0x3ec43f35,0x3ef1bf80,0xbf7f3f0e,0x3f223ec4,0x3e95bf7b
.long 0xbf0e3f80,0x3f7bbec4,0xbe48bf35,0xbf553f6d,0x3f22bf80,0xbf623e48,0xbe953f6d,0x3f7fbf0e
.long 0xbf353f80,0x3f350000,0x3f35bf80,0xbf350000,0x3f46bf80,0xbef1be48,0xbf753f6d,0x3dc93f0e
.long 0xbf553f80,0x3e483ec4,0x3f7bbf35,0x3f0ebf6d,0x3f62bf80,0x3dc9bf0e,0xbf463ec4,0xbf753f7b
.long 0xbf6d3f80,0xbec43f35,0x3ec40000,0x3f6dbf35,0x3f75bf80,0x3f22bf55,0x3dc9bec4,0xbef13e48
.long 0xbf7b3f80,0xbf553f6d,0xbf0e3f35,0xbe483ec4,0x3f7fbf80,0x3f75bf7b,0x3f62bf6d,0x3f46bf55
.long 0x3f80,0xbf80,0x3f80,0xbf80,0x3f46bf35,0xbf623f0e,0x3f75bec4,0xbf7f3e48
.long 0xbf7b0000,0x3f553ec4,0xbf0ebf35,0x3e483f6d,0x3ef13f35,0x3dc9bf7b,0xbf223f6d,0x3f75bf0e
.long 0x3ec4bf80,0xbf6d3f35,0x3f6d0000,0xbec4bf35,0xbf753f35,0x3f463e48,0x3dc9bf6d,0xbf623f55
.long 0x3f550000,0x3e48bf6d,0xbf7b3f35,0x3f0e3ec4,0xbdc9bf35,0xbf753f55,0x3ef13ec4,0x3f46bf7b
.long 0xbf353f80,0x3f350000,0x3f35bf80,0xbf350000,0x3f7fbf35,0x3e95bf55,0xbf623ec4,0xbf223f7b
.long 0xbf0e0000,0xbf7b3f6d,0xbe483f35,0x3f55bec4,0xbe953f35,0x3f22be48,0x3f7fbf6d,0x3ef1bf55
.long 0x3f6dbf80,0x3ec4bf35,0xbec40000,0xbf6d3f35,0xbf623f35,0xbf7f3f7b,0xbf463f6d,0xbe953f0e
.long 0x3e480000,0x3f0ebec4,0x3f55bf35,0x3f7bbf6d,0x3f22bf35,0x3ef1bf0e,0x3e95bec4,0x3dc9be48
.long 0x3f80,0xbf80,0x3f80,0xbf80,0x3f7f0000,0xbf75be48,0x3f623ec4,0xbf46bf0e
.long 0x3e48bf80,0xbf0e3f6d,0x3f55bf35,0xbf7b3ec4,0xbf750000,0x3f223f0e,0xbdc9bf6d,0xbef13f7b
.long 0xbec43f80,0x3f6dbf35,0xbf6d0000,0x3ec43f35,0x3f620000,0xbdc9bf55,0xbf463f6d,0x3f75be48
.long 0x3f0ebf80,0xbf7b3ec4,0x3e483f35,0x3f55bf6d,0xbf460000,0xbef13f7b,0x3f75bec4,0x3dc9bf55
.long 0xbf353f80,0x3f350000,0x3f35bf80,0xbf350000,0x3f220000,0x3f62bf7b,0xbe95bec4,0xbf7f3f55
.long 0x3f55bf80,0xbe48bec4,0xbf7b3f35,0xbf0e3f6d,0xbef10000,0xbf7f3f55,0xbf223f6d,0x3e953e48
.long 0xbf6d3f80,0xbec43f35,0x3ec40000,0x3f6dbf35,0x3e950000,0x3f46bf0e,0x3f7fbf6d,0x3f62bf7b
.long 0x3f7bbf80,0x3f55bf6d,0x3f0ebf35,0x3e48bec4,0xbdc90000,0xbe953e48,0xbef13ec4,0xbf223f0e
.long 0x3f80,0xbf80,0x3f80,0xbf80,0x3f223f35,0xbef1bf55,0x3e953f6d,0xbdc9bf7b
.long 0x3f7b0000,0xbf55bec4,0x3f0e3f35,0xbe48bf6d,0x3f62bf35,0xbf7f3e48,0x3f463ec4,0xbe95bf55
.long 0x3ec4bf80,0xbf6d3f35,0x3f6d0000,0xbec4bf35,0xbe95bf35,0xbf223f7b,0x3f7fbec4,0xbef1bf0e
.long 0xbf550000,0xbe483f6d,0x3f7bbf35,0xbf0ebec4,0xbf7f3f35,0x3e953f0e,0x3f62bf6d,0xbf22be48
.long 0xbf353f80,0x3f350000,0x3f35bf80,0xbf350000,0xbdc93f35,0x3f75bf0e,0x3ef1bf6d,0xbf463e48
.long 0x3f0e0000,0x3f7bbf6d,0x3e48bf35,0xbf553ec4,0x3f75bf35,0x3f46bf7b,0xbdc9bec4,0xbf623f0e
.long 0x3f6dbf80,0x3ec4bf35,0xbec40000,0xbf6d3f35,0x3ef1bf35,0xbdc9be48,0xbf223ec4,0xbf753f55
.long 0xbe480000,0xbf0e3ec4,0xbf553f35,0xbf7b3f6d,0xbf463f35,0xbf623f55,0xbf753f6d,0xbf7f3f7b
.long 0xbf808000,0x3f808000,0xbf808000,0x3f808000,0x3f7f8000,0xbf75be48,0x3f623ec4,0xbf46bf0e
.long 0xbf7b8000,0x3f553ec4,0xbf0ebf35,0x3e483f6d,0x3f758000,0xbf22bf0e,0x3dc93f6d,0x3ef1bf7b
.long 0xbf6d8000,0x3ec43f35,0x3ec4bf80,0xbf6d3f35,0x3f628000,0xbdc9bf55,0xbf463f6d,0x3f75be48
.long 0xbf558000,0xbe483f6d,0x3f7bbf35,0xbf0ebec4,0x3f468000,0x3ef1bf7b,0xbf753ec4,0xbdc93f55
.long 0xbf358000,0xbf353f80,0x3f358000,0x3f35bf80,0x3f228000,0x3f62bf7b,0xbe95bec4,0xbf7f3f55
.long 0xbf0e8000,0xbf7b3f6d,0xbe483f35,0x3f55bec4,0x3ef18000,0x3f7fbf55,0x3f22bf6d,0xbe95be48
.long 0xbec48000,0xbf6d3f35,0xbf6d3f80,0xbec43f35,0x3e958000,0x3f46bf0e,0x3f7fbf6d,0x3f62bf7b
.long 0xbe488000,0xbf0e3ec4,0xbf553f35,0xbf7b3f6d,0x3dc98000,0x3e95be48,0x3ef1bec4,0x3f22bf0e
.long 0xbf808000,0x3f808000,0xbf808000,0x3f808000,0x3f223f35,0xbef1bf55,0x3e953f6d,0xbdc9bf7b
.long 0x3e48bf80,0xbf0e3f6d,0x3f55bf35,0xbf7b3ec4,0xbf623f35,0x3f7fbe48,0xbf46bec4,0x3e953f55
.long 0x3f6d8000,0xbec4bf35,0xbec43f80,0x3f6dbf35,0xbe95bf35,0xbf223f7b,0x3f7fbec4,0xbef1bf0e
.long 0xbf0e3f80,0x3f7bbec4,0xbe48bf35,0xbf553f6d,0x3f7fbf35,0xbe95bf0e,0xbf623f6d,0x3f223e48
.long 0xbf358000,0xbf353f80,0x3f358000,0x3f35bf80,0xbdc93f35,0x3f75bf0e,0x3ef1bf6d,0xbf463e48
.long 0x3f55bf80,0xbe48bec4,0xbf7b3f35,0xbf0e3f6d,0xbf753f35,0xbf463f7b,0x3dc93ec4,0x3f62bf0e
.long 0x3ec48000,0x3f6dbf35,0x3f6dbf80,0x3ec4bf35,0x3ef1bf35,0xbdc9be48,0xbf223ec4,0xbf753f55
.long 0xbf7b3f80,0xbf553f6d,0xbf0e3f35,0xbe483ec4,0x3f46bf35,0x3f62bf55,0x3f75bf6d,0x3f7fbf7b
.long 0xbf808000,0x3f808000,0xbf808000,0x3f808000,0xbdc93f80,0x3e95bf7b,0xbef13f6d,0x3f22bf55
.long 0x3f7b8000,0xbf55bec4,0x3f0e3f35,0xbe48bf6d,0x3e95bf80,0xbf463f55,0x3f7fbec4,0xbf62be48
.long 0xbf6d8000,0x3ec43f35,0x3ec4bf80,0xbf6d3f35,0xbef13f80,0x3f7fbf0e,0xbf22bec4,0xbe953f7b
.long 0x3f558000,0x3e48bf6d,0xbf7b3f35,0x3f0e3ec4,0x3f22bf80,0xbf623e48,0xbe953f6d,0x3f7fbf0e
.long 0xbf358000,0xbf353f80,0x3f358000,0x3f35bf80,0xbf463f80,0x3ef13e48,0x3f75bf6d,0xbdc9bf0e
.long 0x3f0e8000,0x3f7bbf6d,0x3e48bf35,0xbf553ec4,0x3f62bf80,0x3dc9bf0e,0xbf463ec4,0xbf753f7b
.long 0xbec48000,0xbf6d3f35,0xbf6d3f80,0xbec43f35,0xbf753f80,0xbf223f55,0xbdc93ec4,0x3ef1be48
.long 0x3e488000,0x3f0ebec4,0x3f55bf35,0x3f7bbf6d,0x3f7fbf80,0x3f75bf7b,0x3f62bf6d,0x3f46bf55
.long 0xbf808000,0x3f808000,0xbf808000,0x3f808000,0xbf463f35,0x3f62bf0e,0xbf753ec4,0x3f7fbe48
.long 0xbe483f80,0x3f0ebf6d,0xbf553f35,0x3f7bbec4,0x3ef13f35,0x3dc9bf7b,0xbf223f6d,0x3f75bf0e
.long 0x3f6d8000,0xbec4bf35,0xbec43f80,0x3f6dbf35,0x3f75bf35,0xbf46be48,0xbdc93f6d,0x3f62bf55
.long 0x3f0ebf80,0xbf7b3ec4,0x3e483f35,0x3f55bf6d,0xbdc9bf35,0xbf753f55,0x3ef13ec4,0x3f46bf7b
.long 0xbf358000,0xbf353f80,0x3f358000,0x3f35bf80,0xbf7f3f35,0xbe953f55,0x3f62bec4,0x3f22bf7b
.long 0xbf553f80,0x3e483ec4,0x3f7bbf35,0x3f0ebf6d,0xbe953f35,0x3f22be48,0x3f7fbf6d,0x3ef1bf55
.long 0x3ec48000,0x3f6dbf35,0x3f6dbf80,0x3ec4bf35,0x3f62bf35,0x3f7fbf7b,0x3f46bf6d,0x3e95bf0e
.long 0x3f7bbf80,0x3f55bf6d,0x3f0ebf35,0x3e48bec4,0x3f22bf35,0x3ef1bf0e,0x3e95bec4,0x3dc9be48
.long 0xbf803f80,0xbf803f80,0xbf803f80,0xbf803f80,0xbf7f3f80,0xbf753f7b,0xbf623f6d,0xbf463f55
.long 0xbf7b3f80,0xbf553f6d,0xbf0e3f35,0xbe483ec4,0xbf753f80,0xbf223f55,0xbdc93ec4,0x3ef1be48
.long 0xbf6d3f80,0xbec43f35,0x3ec40000,0x3f6dbf35,0xbf623f80,0xbdc93f0e,0x3f46bec4,0x3f75bf7b
.long 0xbf553f80,0x3e483ec4,0x3f7bbf35,0x3f0ebf6d,0xbf463f80,0x3ef13e48,0x3f75bf6d,0xbdc9bf0e
.long 0xbf353f80,0x3f350000,0x3f35bf80,0xbf350000,0xbf223f80,0x3f62be48,0x3e95bf6d,0xbf7f3f0e
.long 0xbf0e3f80,0x3f7bbec4,0xbe48bf35,0xbf553f6d,0xbef13f80,0x3f7fbf0e,0xbf22bec4,0xbe953f7b
.long 0xbec43f80,0x3f6dbf35,0xbf6d0000,0x3ec43f35,0xbe953f80,0x3f46bf55,0xbf7f3ec4,0x3f623e48
.long 0xbe483f80,0x3f0ebf6d,0xbf553f35,0x3f7bbec4,0xbdc93f80,0x3e95bf7b,0xbef13f6d,0x3f22bf55
.long 0xbf803f80,0xbf803f80,0xbf803f80,0xbf803f80,0xbf223f35,0xbef13f0e,0xbe953ec4,0xbdc93e48
.long 0x3e480000,0x3f0ebec4,0x3f55bf35,0x3f7bbf6d,0x3f62bf35,0x3f7fbf7b,0x3f46bf6d,0x3e95bf0e
.long 0x3f6dbf80,0x3ec4bf35,0xbec40000,0xbf6d3f35,0x3e95bf35,0xbf223e48,0xbf7f3f6d,0xbef13f55
.long 0xbf0e0000,0xbf7b3f6d,0xbe483f35,0x3f55bec4,0xbf7f3f35,0xbe953f55,0x3f62bec4,0x3f22bf7b
.long 0xbf353f80,0x3f350000,0x3f35bf80,0xbf350000,0x3dc93f35,0x3f75bf55,0xbef1bec4,0xbf463f7b
.long 0x3f550000,0x3e48bf6d,0xbf7b3f35,0x3f0e3ec4,0x3f75bf35,0xbf46be48,0xbdc93f6d,0x3f62bf55
.long 0x3ec4bf80,0xbf6d3f35,0x3f6d0000,0xbec4bf35,0xbef1bf35,0xbdc93f7b,0x3f22bf6d,0xbf753f0e
.long 0xbf7b0000,0x3f553ec4,0xbf0ebf35,0x3e483f6d,0xbf463f35,0x3f62bf0e,0xbf753ec4,0x3f7fbe48
.long 0xbf803f80,0xbf803f80,0xbf803f80,0xbf803f80,0x3dc90000,0x3e95be48,0x3ef1bec4,0x3f22bf0e
.long 0x3f7bbf80,0x3f55bf6d,0x3f0ebf35,0x3e48bec4,0xbe950000,0xbf463f0e,0xbf7f3f6d,0xbf623f7b
.long 0xbf6d3f80,0xbec43f35,0x3ec40000,0x3f6dbf35,0x3ef10000,0x3f7fbf55,0x3f22bf6d,0xbe95be48
.long 0x3f55bf80,0xbe48bec4,0xbf7b3f35,0xbf0e3f6d,0xbf220000,0xbf623f7b,0x3e953ec4,0x3f7fbf55
.long 0xbf353f80,0x3f350000,0x3f35bf80,0xbf350000,0x3f460000,0x3ef1bf7b,0xbf753ec4,0xbdc93f55
.long 0x3f0ebf80,0xbf7b3ec4,0x3e483f35,0x3f55bf6d,0xbf620000,0x3dc93f55,0x3f46bf6d,0xbf753e48
.long 0xbec43f80,0x3f6dbf35,0xbf6d0000,0x3ec43f35,0x3f750000,0xbf22bf0e,0x3dc93f6d,0x3ef1bf7b
.long 0x3e48bf80,0xbf0e3f6d,0x3f55bf35,0xbf7b3ec4,0xbf7f0000,0x3f753e48,0xbf62bec4,0x3f463f0e
.long 0xbf803f80,0xbf803f80,0xbf803f80,0xbf803f80,0x3f46bf35,0x3f62bf55,0x3f75bf6d,0x3f7fbf7b
.long 0xbe480000,0xbf0e3ec4,0xbf553f35,0xbf7b3f6d,0xbef13f35,0x3dc93e48,0x3f22bec4,0x3f75bf55
.long 0x3f6dbf80,0x3ec4bf35,0xbec40000,0xbf6d3f35,0xbf753f35,0xbf463f7b,0x3dc93ec4,0x3f62bf0e
.long 0x3f0e0000,0x3f7bbf6d,0x3e48bf35,0xbf553ec4,0x3dc9bf35,0xbf753f0e,0xbef13f6d,0x3f46be48
.long 0xbf353f80,0x3f350000,0x3f35bf80,0xbf350000,0x3f7fbf35,0xbe95bf0e,0xbf623f6d,0x3f223e48
.long 0xbf550000,0xbe483f6d,0x3f7bbf35,0xbf0ebec4,0x3e953f35,0x3f22bf7b,0xbf7f3ec4,0x3ef13f0e
.long 0x3ec4bf80,0xbf6d3f35,0x3f6d0000,0xbec4bf35,0xbf623f35,0x3f7fbe48,0xbf46bec4,0x3e953f55
.long 0x3f7b0000,0xbf55bec4,0x3f0e3f35,0xbe48bf6d,0xbf22bf35,0x3ef13f55,0xbe95bf6d,0x3dc93f7b
.long 0x80008000,0x80008000,0x80008000,0x80008000,0x3dc98000,0x3e95be48,0x3ef1bec4,0x3f22bf0e
.long 0x3e488000,0x3f0ebec4,0x3f55bf35,0x3f7bbf6d,0x3e958000,0x3f46bf0e,0x3f7fbf6d,0x3f62bf7b
.long 0x3ec48000,0x3f6dbf35,0x3f6dbf80,0x3ec4bf35,0x3ef18000,0x3f7fbf55,0x3f22bf6d,0xbe95be48
.long 0x3f0e8000,0x3f7bbf6d,0x3e48bf35,0xbf553ec4,0x3f228000,0x3f62bf7b,0xbe95bec4,0xbf7f3f55
.long 0x3f358000,0x3f35bf80,0xbf358000,0xbf353f80,0x3f468000,0x3ef1bf7b,0xbf753ec4,0xbdc93f55
.long 0x3f558000,0x3e48bf6d,0xbf7b3f35,0x3f0e3ec4,0x3f628000,0xbdc9bf55,0xbf463f6d,0x3f75be48
.long 0x3f6d8000,0xbec4bf35,0xbec43f80,0x3f6dbf35,0x3f758000,0xbf22bf0e,0x3dc93f6d,0x3ef1bf7b
.long 0x3f7b8000,0xbf55bec4,0x3f0e3f35,0xbe48bf6d,0x3f7f8000,0xbf75be48,0x3f623ec4,0xbf46bf0e
.long 0x80008000,0x80008000,0x80008000,0x80008000,0x3f46bf35,0x3f62bf55,0x3f75bf6d,0x3f7fbf7b
.long 0x3f7bbf80,0x3f55bf6d,0x3f0ebf35,0x3e48bec4,0x3ef1bf35,0xbdc9be48,0xbf223ec4,0xbf753f55
.long 0xbec48000,0xbf6d3f35,0xbf6d3f80,0xbec43f35,0xbf753f35,0xbf463f7b,0x3dc93ec4,0x3f62bf0e
.long 0xbf553f80,0x3e483ec4,0x3f7bbf35,0x3f0ebf6d,0xbdc93f35,0x3f75bf0e,0x3ef1bf6d,0xbf463e48
.long 0x3f358000,0x3f35bf80,0xbf358000,0xbf353f80,0x3f7fbf35,0xbe95bf0e,0xbf623f6d,0x3f223e48
.long 0x3f0ebf80,0xbf7b3ec4,0x3e483f35,0x3f55bf6d,0xbe95bf35,0xbf223f7b,0x3f7fbec4,0xbef1bf0e
.long 0xbf6d8000,0x3ec43f35,0x3ec4bf80,0xbf6d3f35,0xbf623f35,0x3f7fbe48,0xbf46bec4,0x3e953f55
.long 0xbe483f80,0x3f0ebf6d,0xbf553f35,0x3f7bbec4,0x3f223f35,0xbef1bf55,0x3e953f6d,0xbdc9bf7b
.long 0x80008000,0x80008000,0x80008000,0x80008000,0x3f7fbf80,0x3f75bf7b,0x3f62bf6d,0x3f46bf55
.long 0xbe488000,0xbf0e3ec4,0xbf553f35,0xbf7b3f6d,0xbf753f80,0xbf223f55,0xbdc93ec4,0x3ef1be48
.long 0x3ec48000,0x3f6dbf35,0x3f6dbf80,0x3ec4bf35,0x3f62bf80,0x3dc9bf0e,0xbf463ec4,0xbf753f7b
.long 0xbf0e8000,0xbf7b3f6d,0xbe483f35,0x3f55bec4,0xbf463f80,0x3ef13e48,0x3f75bf6d,0xbdc9bf0e
.long 0x3f358000,0x3f35bf80,0xbf358000,0xbf353f80,0x3f22bf80,0xbf623e48,0xbe953f6d,0x3f7fbf0e
.long 0xbf558000,0xbe483f6d,0x3f7bbf35,0xbf0ebec4,0xbef13f80,0x3f7fbf0e,0xbf22bec4,0xbe953f7b
.long 0x3f6d8000,0xbec4bf35,0xbec43f80,0x3f6dbf35,0x3e95bf80,0xbf463f55,0x3f7fbec4,0xbf62be48
.long 0xbf7b8000,0x3f553ec4,0xbf0ebf35,0x3e483f6d,0xbdc93f80,0x3e95bf7b,0xbef13f6d,0x3f22bf55
.long 0x80008000,0x80008000,0x80008000,0x80008000,0x3f22bf35,0x3ef1bf0e,0x3e95bec4,0x3dc9be48
.long 0xbf7b3f80,0xbf553f6d,0xbf0e3f35,0xbe483ec4,0x3f62bf35,0x3f7fbf7b,0x3f46bf6d,0x3e95bf0e
.long 0xbec48000,0xbf6d3f35,0xbf6d3f80,0xbec43f35,0xbe953f35,0x3f22be48,0x3f7fbf6d,0x3ef1bf55
.long 0x3f55bf80,0xbe48bec4,0xbf7b3f35,0xbf0e3f6d,0xbf7f3f35,0xbe953f55,0x3f62bec4,0x3f22bf7b
.long 0x3f358000,0x3f35bf80,0xbf358000,0xbf353f80,0xbdc9bf35,0xbf753f55,0x3ef13ec4,0x3f46bf7b
.long 0xbf0e3f80,0x3f7bbec4,0xbe48bf35,0xbf553f6d,0x3f75bf35,0xbf46be48,0xbdc93f6d,0x3f62bf55
.long 0xbf6d8000,0x3ec43f35,0x3ec4bf80,0xbf6d3f35,0x3ef13f35,0x3dc9bf7b,0xbf223f6d,0x3f75bf0e
.long 0x3e48bf80,0xbf0e3f6d,0x3f55bf35,0xbf7b3ec4,0xbf463f35,0x3f62bf0e,0xbf753ec4,0x3f7fbe48
.long 0xbf803f80,0xbf803f80,0xbf803f80,0xbf803f80,0x3f7fbf80,0x3f75bf7b,0x3f62bf6d,0x3f46bf55
.long 0xbf7b3f80,0xbf553f6d,0xbf0e3f35,0xbe483ec4,0x3f75bf80,0x3f22bf55,0x3dc9bec4,0xbef13e48
.long 0xbf6d3f80,0xbec43f35,0x3ec40000,0x3f6dbf35,0x3f62bf80,0x3dc9bf0e,0xbf463ec4,0xbf753f7b
.long 0xbf553f80,0x3e483ec4,0x3f7bbf35,0x3f0ebf6d,0x3f46bf80,0xbef1be48,0xbf753f6d,0x3dc93f0e
.long 0xbf353f80,0x3f350000,0x3f35bf80,0xbf350000,0x3f22bf80,0xbf623e48,0xbe953f6d,0x3f7fbf0e
.long 0xbf0e3f80,0x3f7bbec4,0xbe48bf35,0xbf553f6d,0x3ef1bf80,0xbf7f3f0e,0x3f223ec4,0x3e95bf7b
.long 0xbec43f80,0x3f6dbf35,0xbf6d0000,0x3ec43f35,0x3e95bf80,0xbf463f55,0x3f7fbec4,0xbf62be48
.long 0xbe483f80,0x3f0ebf6d,0xbf553f35,0x3f7bbec4,0x3dc9bf80,0xbe953f7b,0x3ef1bf6d,0xbf223f55
.long 0xbf803f80,0xbf803f80,0xbf803f80,0xbf803f80,0x3f22bf35,0x3ef1bf0e,0x3e95bec4,0x3dc9be48
.long 0x3e480000,0x3f0ebec4,0x3f55bf35,0x3f7bbf6d,0xbf623f35,0xbf7f3f7b,0xbf463f6d,0xbe953f0e
.long 0x3f6dbf80,0x3ec4bf35,0xbec40000,0xbf6d3f35,0xbe953f35,0x3f22be48,0x3f7fbf6d,0x3ef1bf55
.long 0xbf0e0000,0xbf7b3f6d,0xbe483f35,0x3f55bec4,0x3f7fbf35,0x3e95bf55,0xbf623ec4,0xbf223f7b
.long 0xbf353f80,0x3f350000,0x3f35bf80,0xbf350000,0xbdc9bf35,0xbf753f55,0x3ef13ec4,0x3f46bf7b
.long 0x3f550000,0x3e48bf6d,0xbf7b3f35,0x3f0e3ec4,0xbf753f35,0x3f463e48,0x3dc9bf6d,0xbf623f55
.long 0x3ec4bf80,0xbf6d3f35,0x3f6d0000,0xbec4bf35,0x3ef13f35,0x3dc9bf7b,0xbf223f6d,0x3f75bf0e
.long 0xbf7b0000,0x3f553ec4,0xbf0ebf35,0x3e483f6d,0x3f46bf35,0xbf623f0e,0x3f75bec4,0xbf7f3e48
.long 0xbf803f80,0xbf803f80,0xbf803f80,0xbf803f80,0xbdc90000,0xbe953e48,0xbef13ec4,0xbf223f0e
.long 0x3f7bbf80,0x3f55bf6d,0x3f0ebf35,0x3e48bec4,0x3e950000,0x3f46bf0e,0x3f7fbf6d,0x3f62bf7b
.long 0xbf6d3f80,0xbec43f35,0x3ec40000,0x3f6dbf35,0xbef10000,0xbf7f3f55,0xbf223f6d,0x3e953e48
.long 0x3f55bf80,0xbe48bec4,0xbf7b3f35,0xbf0e3f6d,0x3f220000,0x3f62bf7b,0xbe95bec4,0xbf7f3f55
.long 0xbf353f80,0x3f350000,0x3f35bf80,0xbf350000,0xbf460000,0xbef13f7b,0x3f75bec4,0x3dc9bf55
.long 0x3f0ebf80,0xbf7b3ec4,0x3e483f35,0x3f55bf6d,0x3f620000,0xbdc9bf55,0xbf463f6d,0x3f75be48
.long 0xbec43f80,0x3f6dbf35,0xbf6d0000,0x3ec43f35,0xbf750000,0x3f223f0e,0xbdc9bf6d,0xbef13f7b
.long 0x3e48bf80,0xbf0e3f6d,0x3f55bf35,0xbf7b3ec4,0x3f7f0000,0xbf75be48,0x3f623ec4,0xbf46bf0e
.long 0xbf803f80,0xbf803f80,0xbf803f80,0xbf803f80,0xbf463f35,0xbf623f55,0xbf753f6d,0xbf7f3f7b
.long 0xbe480000,0xbf0e3ec4,0xbf553f35,0xbf7b3f6d,0x3ef1bf35,0xbdc9be48,0xbf223ec4,0xbf753f55
.long 0x3f6dbf80,0x3ec4bf35,0xbec40000,0xbf6d3f35,0x3f75bf35,0x3f46bf7b,0xbdc9bec4,0xbf623f0e
.long 0x3f0e0000,0x3f7bbf6d,0x3e48bf35,0xbf553ec4,0xbdc93f35,0x3f75bf0e,0x3ef1bf6d,0xbf463e48
.long 0xbf353f80,0x3f350000,0x3f35bf80,0xbf350000,0xbf7f3f35,0x3e953f0e,0x3f62bf6d,0xbf22be48
.long 0xbf550000,0xbe483f6d,0x3f7bbf35,0xbf0ebec4,0xbe95bf35,0xbf223f7b,0x3f7fbec4,0xbef1bf0e
.long 0x3ec4bf80,0xbf6d3f35,0x3f6d0000,0xbec4bf35,0x3f62bf35,0xbf7f3e48,0x3f463ec4,0xbe95bf55
.long 0x3f7b0000,0xbf55bec4,0x3f0e3f35,0xbe48bf6d,0x3f223f35,0xbef1bf55,0x3e953f6d,0xbdc9bf7b
.long 0x80008000,0x80008000,0x80008000,0x80008000,0xbdc98000,0xbe953e48,0xbef13ec4,0xbf223f0e
.long 0x3e488000,0x3f0ebec4,0x3f55bf35,0x3f7bbf6d,0xbe958000,0xbf463f0e,0xbf7f3f6d,0xbf623f7b
.long 0x3ec48000,0x3f6dbf35,0x3f6dbf80,0x3ec4bf35,0xbef18000,0xbf7f3f55,0xbf223f6d,0x3e953e48
.long 0x3f0e8000,0x3f7bbf6d,0x3e48bf35,0xbf553ec4,0xbf228000,0xbf623f7b,0x3e953ec4,0x3f7fbf55
.long 0x3f358000,0x3f35bf80,0xbf358000,0xbf353f80,0xbf468000,0xbef13f7b,0x3f75bec4,0x3dc9bf55
.long 0x3f558000,0x3e48bf6d,0xbf7b3f35,0x3f0e3ec4,0xbf628000,0x3dc93f55,0x3f46bf6d,0xbf753e48
.long 0x3f6d8000,0xbec4bf35,0xbec43f80,0x3f6dbf35,0xbf758000,0x3f223f0e,0xbdc9bf6d,0xbef13f7b
.long 0x3f7b8000,0xbf55bec4,0x3f0e3f35,0xbe48bf6d,0xbf7f8000,0x3f753e48,0xbf62bec4,0x3f463f0e
.long 0x80008000,0x80008000,0x80008000,0x80008000,0xbf463f35,0xbf623f55,0xbf753f6d,0xbf7f3f7b
.long 0x3f7bbf80,0x3f55bf6d,0x3f0ebf35,0x3e48bec4,0xbef13f35,0x3dc93e48,0x3f22bec4,0x3f75bf55
.long 0xbec48000,0xbf6d3f35,0xbf6d3f80,0xbec43f35,0x3f75bf35,0x3f46bf7b,0xbdc9bec4,0xbf623f0e
.long 0xbf553f80,0x3e483ec4,0x3f7bbf35,0x3f0ebf6d,0x3dc9bf35,0xbf753f0e,0xbef13f6d,0x3f46be48
.long 0x3f358000,0x3f35bf80,0xbf358000,0xbf353f80,0xbf7f3f35,0x3e953f0e,0x3f62bf6d,0xbf22be48
.long 0x3f0ebf80,0xbf7b3ec4,0x3e483f35,0x3f55bf6d,0x3e953f35,0x3f22bf7b,0xbf7f3ec4,0x3ef13f0e
.long 0xbf6d8000,0x3ec43f35,0x3ec4bf80,0xbf6d3f35,0x3f62bf35,0xbf7f3e48,0x3f463ec4,0xbe95bf55
.long 0xbe483f80,0x3f0ebf6d,0xbf553f35,0x3f7bbec4,0xbf22bf35,0x3ef13f55,0xbe95bf6d,0x3dc93f7b
.long 0x80008000,0x80008000,0x80008000,0x80008000,0xbf7f3f80,0xbf753f7b,0xbf623f6d,0xbf463f55
.long 0xbe488000,0xbf0e3ec4,0xbf553f35,0xbf7b3f6d,0x3f75bf80,0x3f22bf55,0x3dc9bec4,0xbef13e48
.long 0x3ec48000,0x3f6dbf35,0x3f6dbf80,0x3ec4bf35,0xbf623f80,0xbdc93f0e,0x3f46bec4,0x3f75bf7b
.long 0xbf0e8000,0xbf7b3f6d,0xbe483f35,0x3f55bec4,0x3f46bf80,0xbef1be48,0xbf753f6d,0x3dc93f0e
.long 0x3f358000,0x3f35bf80,0xbf358000,0xbf353f80,0xbf223f80,0x3f62be48,0x3e95bf6d,0xbf7f3f0e
.long 0xbf558000,0xbe483f6d,0x3f7bbf35,0xbf0ebec4,0x3ef1bf80,0xbf7f3f0e,0x3f223ec4,0x3e95bf7b
.long 0x3f6d8000,0xbec4bf35,0xbec43f80,0x3f6dbf35,0xbe953f80,0x3f46bf55,0xbf7f3ec4,0x3f623e48
.long 0xbf7b8000,0x3f553ec4,0xbf0ebf35,0x3e483f6d,0x3dc9bf80,0xbe953f7b,0x3ef1bf6d,0xbf223f55
.long 0x80008000,0x80008000,0x80008000,0x80008000,0xbf223f35,0xbef13f0e,0xbe953ec4,0xbdc93e48
.long 0xbf7b3f80,0xbf553f6d,0xbf0e3f35,0xbe483ec4,0xbf623f35,0xbf7f3f7b,0xbf463f6d,0xbe953f0e
.long 0xbec48000,0xbf6d3f35,0xbf6d3f80,0xbec43f35,0x3e95bf35,0xbf223e48,0xbf7f3f6d,0xbef13f55
.long 0x3f55bf80,0xbe48bec4,0xbf7b3f35,0xbf0e3f6d,0x3f7fbf35,0x3e95bf55,0xbf623ec4,0xbf223f7b
.long 0x3f358000,0x3f35bf80,0xbf358000,0xbf353f80,0x3dc93f35,0x3f75bf55,0xbef1bec4,0xbf463f7b
.long 0xbf0e3f80,0x3f7bbec4,0xbe48bf35,0xbf553f6d,0xbf753f35,0x3f463e48,0x3dc9bf6d,0xbf623f55
.long 0xbf6d8000,0x3ec43f35,0x3ec4bf80,0xbf6d3f35,0xbef1bf35,0xbdc93f7b,0x3f22bf6d,0xbf753f0e
.long 0x3e48bf80,0xbf0e3f6d,0x3f55bf35,0xbf7b3ec4,0x3f46bf35,0xbf623f0e,0x3f75bec4,0xbf7f3e48
.long 0x3f80,0xbf80,0x3f80,0xbf80,0x3dc93f80,0xbe95bf7b,0x3ef13f6d,0xbf22bf55
.long 0x3e483f80,0xbf0ebf6d,0x3f553f35,0xbf7bbec4,0x3e953f80,0xbf46bf55,0x3f7f3ec4,0xbf623e48
.long 0x3ec43f80,0xbf6dbf35,0x3f6d0000,0xbec43f35,0x3ef13f80,0xbf7fbf0e,0x3f22bec4,0x3e953f7b
.long 0x3f0e3f80,0xbf7bbec4,0x3e48bf35,0x3f553f6d,0x3f223f80,0xbf62be48,0xbe95bf6d,0x3f7f3f0e
.long 0x3f353f80,0xbf350000,0xbf35bf80,0x3f350000,0x3f463f80,0xbef13e48,0xbf75bf6d,0x3dc9bf0e
.long 0x3f553f80,0xbe483ec4,0xbf7bbf35,0xbf0ebf6d,0x3f623f80,0x3dc93f0e,0xbf46bec4,0xbf75bf7b
.long 0x3f6d3f80,0x3ec43f35,0xbec40000,0xbf6dbf35,0x3f753f80,0x3f223f55,0x3dc93ec4,0xbef1be48
.long 0x3f7b3f80,0x3f553f6d,0x3f0e3f35,0x3e483ec4,0x3f7f3f80,0x3f753f7b,0x3f623f6d,0x3f463f55
.long 0x3f80,0xbf80,0x3f80,0xbf80,0x3f463f35,0xbf62bf0e,0x3f753ec4,0xbf7fbe48
.long 0x3f7b0000,0xbf553ec4,0x3f0ebf35,0xbe483f6d,0x3ef1bf35,0x3dc93f7b,0xbf22bf6d,0x3f753f0e
.long 0xbec4bf80,0x3f6d3f35,0xbf6d0000,0x3ec4bf35,0xbf75bf35,0x3f46be48,0x3dc93f6d,0xbf62bf55
.long 0xbf550000,0xbe48bf6d,0x3f7b3f35,0xbf0e3ec4,0xbdc93f35,0xbf75bf55,0x3ef1bec4,0x3f463f7b
.long 0x3f353f80,0xbf350000,0xbf35bf80,0x3f350000,0x3f7f3f35,0x3e953f55,0xbf62bec4,0xbf22bf7b
.long 0x3f0e0000,0x3f7b3f6d,0x3e483f35,0xbf55bec4,0xbe95bf35,0x3f223e48,0x3f7f3f6d,0x3ef13f55
.long 0xbf6dbf80,0xbec4bf35,0x3ec40000,0x3f6d3f35,0xbf62bf35,0xbf7fbf7b,0xbf46bf6d,0xbe95bf0e
.long 0xbe480000,0xbf0ebec4,0xbf55bf35,0xbf7bbf6d,0x3f223f35,0x3ef13f0e,0x3e953ec4,0x3dc93e48
.long 0x3f80,0xbf80,0x3f80,0xbf80,0x3f7f0000,0xbf753e48,0x3f62bec4,0xbf463f0e
.long 0xbe48bf80,0x3f0e3f6d,0xbf55bf35,0x3f7b3ec4,0xbf750000,0x3f22bf0e,0xbdc93f6d,0xbef1bf7b
.long 0x3ec43f80,0xbf6dbf35,0x3f6d0000,0xbec43f35,0x3f620000,0xbdc93f55,0xbf46bf6d,0x3f753e48
.long 0xbf0ebf80,0x3f7b3ec4,0xbe483f35,0xbf55bf6d,0xbf460000,0xbef1bf7b,0x3f753ec4,0x3dc93f55
.long 0x3f353f80,0xbf350000,0xbf35bf80,0x3f350000,0x3f220000,0x3f623f7b,0xbe953ec4,0xbf7fbf55
.long 0xbf55bf80,0x3e48bec4,0x3f7b3f35,0x3f0e3f6d,0xbef10000,0xbf7fbf55,0xbf22bf6d,0x3e95be48
.long 0x3f6d3f80,0x3ec43f35,0xbec40000,0xbf6dbf35,0x3e950000,0x3f463f0e,0x3f7f3f6d,0x3f623f7b
.long 0xbf7bbf80,0xbf55bf6d,0xbf0ebf35,0xbe48bec4,0xbdc90000,0xbe95be48,0xbef1bec4,0xbf22bf0e
.long 0x3f80,0xbf80,0x3f80,0xbf80,0x3f22bf35,0xbef13f55,0x3e95bf6d,0xbdc93f7b
.long 0xbf7b0000,0x3f55bec4,0xbf0e3f35,0x3e48bf6d,0x3f623f35,0xbf7fbe48,0x3f46bec4,0xbe953f55
.long 0xbec4bf80,0x3f6d3f35,0xbf6d0000,0x3ec4bf35,0xbe953f35,0xbf22bf7b,0x3f7f3ec4,0xbef13f0e
.long 0x3f550000,0x3e483f6d,0xbf7bbf35,0x3f0ebec4,0xbf7fbf35,0x3e95bf0e,0x3f623f6d,0xbf223e48
.long 0x3f353f80,0xbf350000,0xbf35bf80,0x3f350000,0xbdc9bf35,0x3f753f0e,0x3ef13f6d,0xbf46be48
.long 0xbf0e0000,0xbf7bbf6d,0xbe48bf35,0x3f553ec4,0x3f753f35,0x3f463f7b,0xbdc93ec4,0xbf62bf0e
.long 0xbf6dbf80,0xbec4bf35,0x3ec40000,0x3f6d3f35,0x3ef13f35,0xbdc93e48,0xbf22bec4,0xbf75bf55
.long 0x3e480000,0x3f0e3ec4,0x3f553f35,0x3f7b3f6d,0xbf46bf35,0xbf62bf55,0xbf75bf6d,0xbf7fbf7b
.long 0x3f808000,0xbf808000,0x3f808000,0xbf808000,0x3f7f8000,0xbf753e48,0x3f62bec4,0xbf463f0e
.long 0x3f7b8000,0xbf553ec4,0x3f0ebf35,0xbe483f6d,0x3f758000,0xbf223f0e,0x3dc9bf6d,0x3ef13f7b
.long 0x3f6d8000,0xbec43f35,0xbec4bf80,0x3f6d3f35,0x3f628000,0xbdc93f55,0xbf46bf6d,0x3f753e48
.long 0x3f558000,0x3e483f6d,0xbf7bbf35,0x3f0ebec4,0x3f468000,0x3ef13f7b,0xbf75bec4,0xbdc9bf55
.long 0x3f358000,0x3f353f80,0xbf358000,0xbf35bf80,0x3f228000,0x3f623f7b,0xbe953ec4,0xbf7fbf55
.long 0x3f0e8000,0x3f7b3f6d,0x3e483f35,0xbf55bec4,0x3ef18000,0x3f7f3f55,0x3f223f6d,0xbe953e48
.long 0x3ec48000,0x3f6d3f35,0x3f6d3f80,0x3ec43f35,0x3e958000,0x3f463f0e,0x3f7f3f6d,0x3f623f7b
.long 0x3e488000,0x3f0e3ec4,0x3f553f35,0x3f7b3f6d,0x3dc98000,0x3e953e48,0x3ef13ec4,0x3f223f0e
.long 0x3f808000,0xbf808000,0x3f808000,0xbf808000,0x3f22bf35,0xbef13f55,0x3e95bf6d,0xbdc93f7b
.long 0xbe48bf80,0x3f0e3f6d,0xbf55bf35,0x3f7b3ec4,0xbf62bf35,0x3f7f3e48,0xbf463ec4,0x3e95bf55
.long 0xbf6d8000,0x3ec4bf35,0x3ec43f80,0xbf6dbf35,0xbe953f35,0xbf22bf7b,0x3f7f3ec4,0xbef13f0e
.long 0x3f0e3f80,0xbf7bbec4,0x3e48bf35,0x3f553f6d,0x3f7f3f35,0xbe953f0e,0xbf62bf6d,0x3f22be48
.long 0x3f358000,0x3f353f80,0xbf358000,0xbf35bf80,0xbdc9bf35,0x3f753f0e,0x3ef13f6d,0xbf46be48
.long 0xbf55bf80,0x3e48bec4,0x3f7b3f35,0x3f0e3f6d,0xbf75bf35,0xbf46bf7b,0x3dc9bec4,0x3f623f0e
.long 0xbec48000,0xbf6dbf35,0xbf6dbf80,0xbec4bf35,0x3ef13f35,0xbdc93e48,0xbf22bec4,0xbf75bf55
.long 0x3f7b3f80,0x3f553f6d,0x3f0e3f35,0x3e483ec4,0x3f463f35,0x3f623f55,0x3f753f6d,0x3f7f3f7b
.long 0x3f808000,0xbf808000,0x3f808000,0xbf808000,0xbdc9bf80,0x3e953f7b,0xbef1bf6d,0x3f223f55
.long 0xbf7b8000,0x3f55bec4,0xbf0e3f35,0x3e48bf6d,0x3e953f80,0xbf46bf55,0x3f7f3ec4,0xbf623e48
.long 0x3f6d8000,0xbec43f35,0xbec4bf80,0x3f6d3f35,0xbef1bf80,0x3f7f3f0e,0xbf223ec4,0xbe95bf7b
.long 0xbf558000,0xbe48bf6d,0x3f7b3f35,0xbf0e3ec4,0x3f223f80,0xbf62be48,0xbe95bf6d,0x3f7f3f0e
.long 0x3f358000,0x3f353f80,0xbf358000,0xbf35bf80,0xbf46bf80,0x3ef1be48,0x3f753f6d,0xbdc93f0e
.long 0xbf0e8000,0xbf7bbf6d,0xbe48bf35,0x3f553ec4,0x3f623f80,0x3dc93f0e,0xbf46bec4,0xbf75bf7b
.long 0x3ec48000,0x3f6d3f35,0x3f6d3f80,0x3ec43f35,0xbf75bf80,0xbf22bf55,0xbdc9bec4,0x3ef13e48
.long 0xbe488000,0xbf0ebec4,0xbf55bf35,0xbf7bbf6d,0x3f7f3f80,0x3f753f7b,0x3f623f6d,0x3f463f55
.long 0x3f808000,0xbf808000,0x3f808000,0xbf808000,0xbf46bf35,0x3f623f0e,0xbf75bec4,0x3f7f3e48
.long 0x3e483f80,0xbf0ebf6d,0x3f553f35,0xbf7bbec4,0x3ef1bf35,0x3dc93f7b,0xbf22bf6d,0x3f753f0e
.long 0xbf6d8000,0x3ec4bf35,0x3ec43f80,0xbf6dbf35,0x3f753f35,0xbf463e48,0xbdc9bf6d,0x3f623f55
.long 0xbf0ebf80,0x3f7b3ec4,0xbe483f35,0xbf55bf6d,0xbdc93f35,0xbf75bf55,0x3ef1bec4,0x3f463f7b
.long 0x3f358000,0x3f353f80,0xbf358000,0xbf35bf80,0xbf7fbf35,0xbe95bf55,0x3f623ec4,0x3f223f7b
.long 0x3f553f80,0xbe483ec4,0xbf7bbf35,0xbf0ebf6d,0xbe95bf35,0x3f223e48,0x3f7f3f6d,0x3ef13f55
.long 0xbec48000,0xbf6dbf35,0xbf6dbf80,0xbec4bf35,0x3f623f35,0x3f7f3f7b,0x3f463f6d,0x3e953f0e
.long 0xbf7bbf80,0xbf55bf6d,0xbf0ebf35,0xbe48bec4,0x3f223f35,0x3ef13f0e,0x3e953ec4,0x3dc93e48
.long 0x3f80,0xbf80,0x3f80,0xbf80,0xbdc9bf80,0x3e953f7b,0xbef1bf6d,0x3f223f55
.long 0x3e483f80,0xbf0ebf6d,0x3f553f35,0xbf7bbec4,0xbe95bf80,0x3f463f55,0xbf7fbec4,0x3f62be48
.long 0x3ec43f80,0xbf6dbf35,0x3f6d0000,0xbec43f35,0xbef1bf80,0x3f7f3f0e,0xbf223ec4,0xbe95bf7b
.long 0x3f0e3f80,0xbf7bbec4,0x3e48bf35,0x3f553f6d,0xbf22bf80,0x3f623e48,0x3e953f6d,0xbf7fbf0e
.long 0x3f353f80,0xbf350000,0xbf35bf80,0x3f350000,0xbf46bf80,0x3ef1be48,0x3f753f6d,0xbdc93f0e
.long 0x3f553f80,0xbe483ec4,0xbf7bbf35,0xbf0ebf6d,0xbf62bf80,0xbdc9bf0e,0x3f463ec4,0x3f753f7b
.long 0x3f6d3f80,0x3ec43f35,0xbec40000,0xbf6dbf35,0xbf75bf80,0xbf22bf55,0xbdc9bec4,0x3ef13e48
.long 0x3f7b3f80,0x3f553f6d,0x3f0e3f35,0x3e483ec4,0xbf7fbf80,0xbf75bf7b,0xbf62bf6d,0xbf46bf55
.long 0x3f80,0xbf80,0x3f80,0xbf80,0xbf46bf35,0x3f623f0e,0xbf75bec4,0x3f7f3e48
.long 0x3f7b0000,0xbf553ec4,0x3f0ebf35,0xbe483f6d,0xbef13f35,0xbdc9bf7b,0x3f223f6d,0xbf75bf0e
.long 0xbec4bf80,0x3f6d3f35,0xbf6d0000,0x3ec4bf35,0x3f753f35,0xbf463e48,0xbdc9bf6d,0x3f623f55
.long 0xbf550000,0xbe48bf6d,0x3f7b3f35,0xbf0e3ec4,0x3dc9bf35,0x3f753f55,0xbef13ec4,0xbf46bf7b
.long 0x3f353f80,0xbf350000,0xbf35bf80,0x3f350000,0xbf7fbf35,0xbe95bf55,0x3f623ec4,0x3f223f7b
.long 0x3f0e0000,0x3f7b3f6d,0x3e483f35,0xbf55bec4,0x3e953f35,0xbf22be48,0xbf7fbf6d,0xbef1bf55
.long 0xbf6dbf80,0xbec4bf35,0x3ec40000,0x3f6d3f35,0x3f623f35,0x3f7f3f7b,0x3f463f6d,0x3e953f0e
.long 0xbe480000,0xbf0ebec4,0xbf55bf35,0xbf7bbf6d,0xbf22bf35,0xbef1bf0e,0xbe95bec4,0xbdc9be48
.long 0x3f80,0xbf80,0x3f80,0xbf80,0xbf7f0000,0x3f75be48,0xbf623ec4,0x3f46bf0e
.long 0xbe48bf80,0x3f0e3f6d,0xbf55bf35,0x3f7b3ec4,0x3f750000,0xbf223f0e,0x3dc9bf6d,0x3ef13f7b
.long 0x3ec43f80,0xbf6dbf35,0x3f6d0000,0xbec43f35,0xbf620000,0x3dc9bf55,0x3f463f6d,0xbf75be48
.long 0xbf0ebf80,0x3f7b3ec4,0xbe483f35,0xbf55bf6d,0x3f460000,0x3ef13f7b,0xbf75bec4,0xbdc9bf55
.long 0x3f353f80,0xbf350000,0xbf35bf80,0x3f350000,0xbf220000,0xbf62bf7b,0x3e95bec4,0x3f7f3f55
.long 0xbf55bf80,0x3e48bec4,0x3f7b3f35,0x3f0e3f6d,0x3ef10000,0x3f7f3f55,0x3f223f6d,0xbe953e48
.long 0x3f6d3f80,0x3ec43f35,0xbec40000,0xbf6dbf35,0xbe950000,0xbf46bf0e,0xbf7fbf6d,0xbf62bf7b
.long 0xbf7bbf80,0xbf55bf6d,0xbf0ebf35,0xbe48bec4,0x3dc90000,0x3e953e48,0x3ef13ec4,0x3f223f0e
.long 0x3f80,0xbf80,0x3f80,0xbf80,0xbf223f35,0x3ef1bf55,0xbe953f6d,0x3dc9bf7b
.long 0xbf7b0000,0x3f55bec4,0xbf0e3f35,0x3e48bf6d,0xbf62bf35,0x3f7f3e48,0xbf463ec4,0x3e95bf55
.long 0xbec4bf80,0x3f6d3f35,0xbf6d0000,0x3ec4bf35,0x3e95bf35,0x3f223f7b,0xbf7fbec4,0x3ef1bf0e
.long 0x3f550000,0x3e483f6d,0xbf7bbf35,0x3f0ebec4,0x3f7f3f35,0xbe953f0e,0xbf62bf6d,0x3f22be48
.long 0x3f353f80,0xbf350000,0xbf35bf80,0x3f350000,0x3dc93f35,0xbf75bf0e,0xbef1bf6d,0x3f463e48
.long 0xbf0e0000,0xbf7bbf6d,0xbe48bf35,0x3f553ec4,0xbf75bf35,0xbf46bf7b,0x3dc9bec4,0x3f623f0e
.long 0xbf6dbf80,0xbec4bf35,0x3ec40000,0x3f6d3f35,0xbef1bf35,0x3dc9be48,0x3f223ec4,0x3f753f55
.long 0x3e480000,0x3f0e3ec4,0x3f553f35,0x3f7b3f6d,0x3f463f35,0x3f623f55,0x3f753f6d,0x3f7f3f7b
.long 0x3f808000,0xbf808000,0x3f808000,0xbf808000,0xbf7f8000,0x3f75be48,0xbf623ec4,0x3f46bf0e
.long 0x3f7b8000,0xbf553ec4,0x3f0ebf35,0xbe483f6d,0xbf758000,0x3f22bf0e,0xbdc93f6d,0xbef1bf7b
.long 0x3f6d8000,0xbec43f35,0xbec4bf80,0x3f6d3f35,0xbf628000,0x3dc9bf55,0x3f463f6d,0xbf75be48
.long 0x3f558000,0x3e483f6d,0xbf7bbf35,0x3f0ebec4,0xbf468000,0xbef1bf7b,0x3f753ec4,0x3dc93f55
.long 0x3f358000,0x3f353f80,0xbf358000,0xbf35bf80,0xbf228000,0xbf62bf7b,0x3e95bec4,0x3f7f3f55
.long 0x3f0e8000,0x3f7b3f6d,0x3e483f35,0xbf55bec4,0xbef18000,0xbf7fbf55,0xbf22bf6d,0x3e95be48
.long 0x3ec48000,0x3f6d3f35,0x3f6d3f80,0x3ec43f35,0xbe958000,0xbf46bf0e,0xbf7fbf6d,0xbf62bf7b
.long 0x3e488000,0x3f0e3ec4,0x3f553f35,0x3f7b3f6d,0xbdc98000,0xbe95be48,0xbef1bec4,0xbf22bf0e
.long 0x3f808000,0xbf808000,0x3f808000,0xbf808000,0xbf223f35,0x3ef1bf55,0xbe953f6d,0x3dc9bf7b
.long 0xbe48bf80,0x3f0e3f6d,0xbf55bf35,0x3f7b3ec4,0x3f623f35,0xbf7fbe48,0x3f46bec4,0xbe953f55
.long 0xbf6d8000,0x3ec4bf35,0x3ec43f80,0xbf6dbf35,0x3e95bf35,0x3f223f7b,0xbf7fbec4,0x3ef1bf0e
.long 0x3f0e3f80,0xbf7bbec4,0x3e48bf35,0x3f553f6d,0xbf7fbf35,0x3e95bf0e,0x3f623f6d,0xbf223e48
.long 0x3f358000,0x3f353f80,0xbf358000,0xbf35bf80,0x3dc93f35,0xbf75bf0e,0xbef1bf6d,0x3f463e48
.long 0xbf55bf80,0x3e48bec4,0x3f7b3f35,0x3f0e3f6d,0x3f753f35,0x3f463f7b,0xbdc93ec4,0xbf62bf0e
.long 0xbec48000,0xbf6dbf35,0xbf6dbf80,0xbec4bf35,0xbef1bf35,0x3dc9be48,0x3f223ec4,0x3f753f55
.long 0x3f7b3f80,0x3f553f6d,0x3f0e3f35,0x3e483ec4,0xbf46bf35,0xbf62bf55,0xbf75bf6d,0xbf7fbf7b
.long 0x3f808000,0xbf808000,0x3f808000,0xbf808000,0x3dc93f80,0xbe95bf7b,0x3ef13f6d,0xbf22bf55
.long 0xbf7b8000,0x3f55bec4,0xbf0e3f35,0x3e48bf6d,0xbe95bf80,0x3f463f55,0xbf7fbec4,0x3f62be48
.long 0x3f6d8000,0xbec43f35,0xbec4bf80,0x3f6d3f35,0x3ef13f80,0xbf7fbf0e,0x3f22bec4,0x3e953f7b
.long 0xbf558000,0xbe48bf6d,0x3f7b3f35,0xbf0e3ec4,0xbf22bf80,0x3f623e48,0x3e953f6d,0xbf7fbf0e
.long 0x3f358000,0x3f353f80,0xbf358000,0xbf35bf80,0x3f463f80,0xbef13e48,0xbf75bf6d,0x3dc9bf0e
.long 0xbf0e8000,0xbf7bbf6d,0xbe48bf35,0x3f553ec4,0xbf62bf80,0xbdc9bf0e,0x3f463ec4,0x3f753f7b
.long 0x3ec48000,0x3f6d3f35,0x3f6d3f80,0x3ec43f35,0x3f753f80,0x3f223f55,0x3dc93ec4,0xbef1be48
.long 0xbe488000,0xbf0ebec4,0xbf55bf35,0xbf7bbf6d,0xbf7fbf80,0xbf75bf7b,0xbf62bf6d,0xbf46bf55
.long 0x3f808000,0xbf808000,0x3f808000,0xbf808000,0x3f463f35,0xbf62bf0e,0x3f753ec4,0xbf7fbe48
.long 0x3e483f80,0xbf0ebf6d,0x3f553f35,0xbf7bbec4,0xbef13f35,0xbdc9bf7b,0x3f223f6d,0xbf75bf0e
.long 0xbf6d8000,0x3ec4bf35,0x3ec43f80,0xbf6dbf35,0xbf75bf35,0x3f46be48,0x3dc93f6d,0xbf62bf55
.long 0xbf0ebf80,0x3f7b3ec4,0xbe483f35,0xbf55bf6d,0x3dc9bf35,0x3f753f55,0xbef13ec4,0xbf46bf7b
.long 0x3f358000,0x3f353f80,0xbf358000,0xbf35bf80,0x3f7f3f35,0x3e953f55,0xbf62bec4,0xbf22bf7b
.long 0x3f553f80,0xbe483ec4,0xbf7bbf35,0xbf0ebf6d,0x3e953f35,0xbf22be48,0xbf7fbf6d,0xbef1bf55
.long 0xbec48000,0xbf6dbf35,0xbf6dbf80,0xbec4bf35,0xbf62bf35,0xbf7fbf7b,0xbf46bf6d,0xbe95bf0e
.long 0xbf7bbf80,0xbf55bf6d,0xbf0ebf35,0xbe48bec4,0xbf22bf35,0xbef1bf0e,0xbe95bec4,0xbdc9be48
.long 0x3f803f80,0x3f803f80,0x3f803f80,0x3f803f80,0x3f7b3f80,0x3f553f6d,0xbf7bbf80,0xbf55bf6d
.long 0x3f6d3f80,0x3ec43f35,0x3f6d3f80,0x3ec43f35,0x3f553f80,0xbe483ec4,0xbf55bf80,0x3e48bec4
.long 0x3f353f80,0xbf350000,0x3f353f80,0xbf350000,0x3f0e3f80,0xbf7bbec4,0xbf0ebf80,0x3f7b3ec4
.long 0x3ec43f80,0xbf6dbf35,0x3ec43f80,0xbf6dbf35,0x3e483f80,0xbf0ebf6d,0xbe48bf80,0x3f0e3f6d
.long 0x3f80,0xbf80,0x3f80,0xbf80,0xbe483f80,0x3f0ebf6d,0x3e48bf80,0xbf0e3f6d
.long 0xbec43f80,0x3f6dbf35,0xbec43f80,0x3f6dbf35,0xbf0e3f80,0x3f7bbec4,0x3f0ebf80,0xbf7b3ec4
.long 0xbf353f80,0x3f350000,0xbf353f80,0x3f350000,0xbf553f80,0x3e483ec4,0x3f55bf80,0xbe48bec4
.long 0xbf6d3f80,0xbec43f35,0xbf6d3f80,0xbec43f35,0xbf7b3f80,0xbf553f6d,0x3f7bbf80,0x3f55bf6d
.long 0x3f803f80,0x3f803f80,0x3f803f80,0x3f803f80,0x3f0e3f35,0x3e483ec4,0xbf0ebf35,0xbe48bec4
.long 0xbec40000,0xbf6dbf35,0xbec40000,0xbf6dbf35,0xbf7bbf35,0xbf0ebf6d,0x3f7b3f35,0x3f0e3f6d
.long 0xbf35bf80,0x3f350000,0xbf35bf80,0x3f350000,0x3e48bf35,0x3f553f6d,0xbe483f35,0xbf55bf6d
.long 0x3f6d0000,0xbec43f35,0x3f6d0000,0xbec43f35,0x3f553f35,0xbf7bbec4,0xbf55bf35,0x3f7b3ec4
.long 0x3f80,0xbf80,0x3f80,0xbf80,0xbf553f35,0x3f7bbec4,0x3f55bf35,0xbf7b3ec4
.long 0xbf6d0000,0x3ec43f35,0xbf6d0000,0x3ec43f35,0xbe48bf35,0xbf553f6d,0x3e483f35,0x3f55bf6d
.long 0x3f35bf80,0xbf350000,0x3f35bf80,0xbf350000,0x3f7bbf35,0x3f0ebf6d,0xbf7b3f35,0xbf0e3f6d
.long 0x3ec40000,0x3f6dbf35,0x3ec40000,0x3f6dbf35,0xbf0e3f35,0xbe483ec4,0x3f0ebf35,0x3e48bec4
.long 0x3f803f80,0x3f803f80,0x3f803f80,0x3f803f80,0xbe480000,0xbf0ebec4,0x3e480000,0x3f0e3ec4
.long 0xbf6dbf80,0xbec4bf35,0xbf6dbf80,0xbec4bf35,0x3f0e0000,0x3f7b3f6d,0xbf0e0000,0xbf7bbf6d
.long 0x3f353f80,0xbf350000,0x3f353f80,0xbf350000,0xbf550000,0xbe48bf6d,0x3f550000,0x3e483f6d
.long 0xbec4bf80,0x3f6d3f35,0xbec4bf80,0x3f6d3f35,0x3f7b0000,0xbf553ec4,0xbf7b0000,0x3f55bec4
.long 0x3f80,0xbf80,0x3f80,0xbf80,0xbf7b0000,0x3f553ec4,0x3f7b0000,0xbf55bec4
.long 0x3ec4bf80,0xbf6d3f35,0x3ec4bf80,0xbf6d3f35,0x3f550000,0x3e48bf6d,0xbf550000,0xbe483f6d
.long 0xbf353f80,0x3f350000,0xbf353f80,0x3f350000,0xbf0e0000,0xbf7b3f6d,0x3f0e0000,0x3f7bbf6d
.long 0x3f6dbf80,0x3ec4bf35,0x3f6dbf80,0x3ec4bf35,0x3e480000,0x3f0ebec4,0xbe480000,0xbf0e3ec4
.long 0x3f803f80,0x3f803f80,0x3f803f80,0x3f803f80,0xbf55bf35,0xbf7bbf6d,0x3f553f35,0x3f7b3f6d
.long 0x3ec40000,0x3f6d3f35,0x3ec40000,0x3f6d3f35,0x3e483f35,0xbf55bec4,0xbe48bf35,0x3f553ec4
.long 0xbf35bf80,0x3f350000,0xbf35bf80,0x3f350000,0x3f7b3f35,0xbf0e3ec4,0xbf7bbf35,0x3f0ebec4
.long 0xbf6d0000,0x3ec4bf35,0xbf6d0000,0x3ec4bf35,0x3f0ebf35,0xbe483f6d,0xbf0e3f35,0x3e48bf6d
.long 0x3f80,0xbf80,0x3f80,0xbf80,0xbf0ebf35,0x3e483f6d,0x3f0e3f35,0xbe48bf6d
.long 0x3f6d0000,0xbec4bf35,0x3f6d0000,0xbec4bf35,0xbf7b3f35,0x3f0e3ec4,0x3f7bbf35,0xbf0ebec4
.long 0x3f35bf80,0xbf350000,0x3f35bf80,0xbf350000,0xbe483f35,0x3f55bec4,0x3e48bf35,0xbf553ec4
.long 0xbec40000,0xbf6d3f35,0xbec40000,0xbf6d3f35,0x3f55bf35,0x3f7bbf6d,0xbf553f35,0xbf7b3f6d
.long 0x80008000,0x80008000,0x80008000,0x80008000,0xbe488000,0xbf0ebec4,0x3e488000,0x3f0e3ec4
.long 0xbec48000,0xbf6dbf35,0xbec48000,0xbf6dbf35,0xbf0e8000,0xbf7bbf6d,0x3f0e8000,0x3f7b3f6d
.long 0xbf358000,0xbf35bf80,0xbf358000,0xbf35bf80,0xbf558000,0xbe48bf6d,0x3f558000,0x3e483f6d
.long 0xbf6d8000,0x3ec4bf35,0xbf6d8000,0x3ec4bf35,0xbf7b8000,0x3f55bec4,0x3f7b8000,0xbf553ec4
.long 0xbf808000,0x3f808000,0xbf808000,0x3f808000,0xbf7b8000,0x3f553ec4,0x3f7b8000,0xbf55bec4
.long 0xbf6d8000,0x3ec43f35,0xbf6d8000,0x3ec43f35,0xbf558000,0xbe483f6d,0x3f558000,0x3e48bf6d
.long 0xbf358000,0xbf353f80,0xbf358000,0xbf353f80,0xbf0e8000,0xbf7b3f6d,0x3f0e8000,0x3f7bbf6d
.long 0xbec48000,0xbf6d3f35,0xbec48000,0xbf6d3f35,0xbe488000,0xbf0e3ec4,0x3e488000,0x3f0ebec4
.long 0x80008000,0x80008000,0x80008000,0x80008000,0xbf55bf35,0xbf7bbf6d,0x3f553f35,0x3f7b3f6d
.long 0xbf6dbf80,0xbec4bf35,0xbf6dbf80,0xbec4bf35,0xbe48bf35,0x3f553ec4,0x3e483f35,0xbf55bec4
.long 0x3f358000,0x3f353f80,0x3f358000,0x3f353f80,0x3f7b3f35,0xbf0e3ec4,0xbf7bbf35,0x3f0ebec4
.long 0x3ec43f80,0xbf6dbf35,0x3ec43f80,0xbf6dbf35,0xbf0e3f35,0x3e48bf6d,0x3f0ebf35,0xbe483f6d
.long 0xbf808000,0x3f808000,0xbf808000,0x3f808000,0xbf0ebf35,0x3e483f6d,0x3f0e3f35,0xbe48bf6d
.long 0x3ec4bf80,0xbf6d3f35,0x3ec4bf80,0xbf6d3f35,0x3f7bbf35,0xbf0ebec4,0xbf7b3f35,0x3f0e3ec4
.long 0x3f358000,0x3f35bf80,0x3f358000,0x3f35bf80,0xbe483f35,0x3f55bec4,0x3e48bf35,0xbf553ec4
.long 0xbf6d3f80,0xbec43f35,0xbf6d3f80,0xbec43f35,0xbf553f35,0xbf7b3f6d,0x3f55bf35,0x3f7bbf6d
.long 0x80008000,0x80008000,0x80008000,0x80008000,0xbf7bbf80,0xbf55bf6d,0x3f7b3f80,0x3f553f6d
.long 0x3ec48000,0x3f6d3f35,0x3ec48000,0x3f6d3f35,0x3f553f80,0xbe483ec4,0xbf55bf80,0x3e48bec4
.long 0xbf358000,0xbf35bf80,0xbf358000,0xbf35bf80,0xbf0ebf80,0x3f7b3ec4,0x3f0e3f80,0xbf7bbec4
.long 0x3f6d8000,0xbec43f35,0x3f6d8000,0xbec43f35,0x3e483f80,0xbf0ebf6d,0xbe48bf80,0x3f0e3f6d
.long 0xbf808000,0x3f808000,0xbf808000,0x3f808000,0x3e48bf80,0xbf0e3f6d,0xbe483f80,0x3f0ebf6d
.long 0x3f6d8000,0xbec4bf35,0x3f6d8000,0xbec4bf35,0xbf0e3f80,0x3f7bbec4,0x3f0ebf80,0xbf7b3ec4
.long 0xbf358000,0xbf353f80,0xbf358000,0xbf353f80,0x3f55bf80,0xbe48bec4,0xbf553f80,0x3e483ec4
.long 0x3ec48000,0x3f6dbf35,0x3ec48000,0x3f6dbf35,0xbf7b3f80,0xbf553f6d,0x3f7bbf80,0x3f55bf6d
.long 0x80008000,0x80008000,0x80008000,0x80008000,0xbf0ebf35,0xbe48bec4,0x3f0e3f35,0x3e483ec4
.long 0x3f6d3f80,0x3ec43f35,0x3f6d3f80,0x3ec43f35,0xbf7bbf35,0xbf0ebf6d,0x3f7b3f35,0x3f0e3f6d
.long 0x3f358000,0x3f353f80,0x3f358000,0x3f353f80,0xbe483f35,0xbf55bf6d,0x3e48bf35,0x3f553f6d
.long 0xbec4bf80,0x3f6d3f35,0xbec4bf80,0x3f6d3f35,0x3f553f35,0xbf7bbec4,0xbf55bf35,0x3f7b3ec4
.long 0xbf808000,0x3f808000,0xbf808000,0x3f808000,0x3f55bf35,0xbf7b3ec4,0xbf553f35,0x3f7bbec4
.long 0xbec43f80,0x3f6dbf35,0xbec43f80,0x3f6dbf35,0xbe48bf35,0xbf553f6d,0x3e483f35,0x3f55bf6d
.long 0x3f358000,0x3f35bf80,0x3f358000,0x3f35bf80,0xbf7b3f35,0xbf0e3f6d,0x3f7bbf35,0x3f0ebf6d
.long 0x3f6dbf80,0x3ec4bf35,0x3f6dbf80,0x3ec4bf35,0xbf0e3f35,0xbe483ec4,0x3f0ebf35,0x3e48bec4
.long 0xbf803f80,0xbf803f80,0xbf803f80,0xbf803f80,0xbf7b3f80,0xbf553f6d,0x3f7bbf80,0x3f55bf6d
.long 0xbf6d3f80,0xbec43f35,0xbf6d3f80,0xbec43f35,0xbf553f80,0x3e483ec4,0x3f55bf80,0xbe48bec4
.long 0xbf353f80,0x3f350000,0xbf353f80,0x3f350000,0xbf0e3f80,0x3f7bbec4,0x3f0ebf80,0xbf7b3ec4
.long 0xbec43f80,0x3f6dbf35,0xbec43f80,0x3f6dbf35,0xbe483f80,0x3f0ebf6d,0x3e48bf80,0xbf0e3f6d
.long 0x3f80,0xbf80,0x3f80,0xbf80,0x3e483f80,0xbf0ebf6d,0xbe48bf80,0x3f0e3f6d
.long 0x3ec43f80,0xbf6dbf35,0x3ec43f80,0xbf6dbf35,0x3f0e3f80,0xbf7bbec4,0xbf0ebf80,0x3f7b3ec4
.long 0x3f353f80,0xbf350000,0x3f353f80,0xbf350000,0x3f553f80,0xbe483ec4,0xbf55bf80,0x3e48bec4
.long 0x3f6d3f80,0x3ec43f35,0x3f6d3f80,0x3ec43f35,0x3f7b3f80,0x3f553f6d,0xbf7bbf80,0xbf55bf6d
.long 0xbf803f80,0xbf803f80,0xbf803f80,0xbf803f80,0xbf0e3f35,0xbe483ec4,0x3f0ebf35,0x3e48bec4
.long 0x3ec40000,0x3f6dbf35,0x3ec40000,0x3f6dbf35,0x3f7bbf35,0x3f0ebf6d,0xbf7b3f35,0xbf0e3f6d
.long 0x3f35bf80,0xbf350000,0x3f35bf80,0xbf350000,0xbe48bf35,0xbf553f6d,0x3e483f35,0x3f55bf6d
.long 0xbf6d0000,0x3ec43f35,0xbf6d0000,0x3ec43f35,0xbf553f35,0x3f7bbec4,0x3f55bf35,0xbf7b3ec4
.long 0x3f80,0xbf80,0x3f80,0xbf80,0x3f553f35,0xbf7bbec4,0xbf55bf35,0x3f7b3ec4
.long 0x3f6d0000,0xbec43f35,0x3f6d0000,0xbec43f35,0x3e48bf35,0x3f553f6d,0xbe483f35,0xbf55bf6d
.long 0xbf35bf80,0x3f350000,0xbf35bf80,0x3f350000,0xbf7bbf35,0xbf0ebf6d,0x3f7b3f35,0x3f0e3f6d
.long 0xbec40000,0xbf6dbf35,0xbec40000,0xbf6dbf35,0x3f0e3f35,0x3e483ec4,0xbf0ebf35,0xbe48bec4
.long 0xbf803f80,0xbf803f80,0xbf803f80,0xbf803f80,0x3e480000,0x3f0ebec4,0xbe480000,0xbf0e3ec4
.long 0x3f6dbf80,0x3ec4bf35,0x3f6dbf80,0x3ec4bf35,0xbf0e0000,0xbf7b3f6d,0x3f0e0000,0x3f7bbf6d
.long 0xbf353f80,0x3f350000,0xbf353f80,0x3f350000,0x3f550000,0x3e48bf6d,0xbf550000,0xbe483f6d
.long 0x3ec4bf80,0xbf6d3f35,0x3ec4bf80,0xbf6d3f35,0xbf7b0000,0x3f553ec4,0x3f7b0000,0xbf55bec4
.long 0x3f80,0xbf80,0x3f80,0xbf80,0x3f7b0000,0xbf553ec4,0xbf7b0000,0x3f55bec4
.long 0xbec4bf80,0x3f6d3f35,0xbec4bf80,0x3f6d3f35,0xbf550000,0xbe48bf6d,0x3f550000,0x3e483f6d
.long 0x3f353f80,0xbf350000,0x3f353f80,0xbf350000,0x3f0e0000,0x3f7b3f6d,0xbf0e0000,0xbf7bbf6d
.long 0xbf6dbf80,0xbec4bf35,0xbf6dbf80,0xbec4bf35,0xbe480000,0xbf0ebec4,0x3e480000,0x3f0e3ec4
.long 0xbf803f80,0xbf803f80,0xbf803f80,0xbf803f80,0x3f55bf35,0x3f7bbf6d,0xbf553f35,0xbf7b3f6d
.long 0xbec40000,0xbf6d3f35,0xbec40000,0xbf6d3f35,0xbe483f35,0x3f55bec4,0x3e48bf35,0xbf553ec4
.long 0x3f35bf80,0xbf350000,0x3f35bf80,0xbf350000,0xbf7b3f35,0x3f0e3ec4,0x3f7bbf35,0xbf0ebec4
.long 0x3f6d0000,0xbec4bf35,0x3f6d0000,0xbec4bf35,0xbf0ebf35,0x3e483f6d,0x3f0e3f35,0xbe48bf6d
.long 0x3f80,0xbf80,0x3f80,0xbf80,0x3f0ebf35,0xbe483f6d,0xbf0e3f35,0x3e48bf6d
.long 0xbf6d0000,0x3ec4bf35,0xbf6d0000,0x3ec4bf35,0x3f7b3f35,0xbf0e3ec4,0xbf7bbf35,0x3f0ebec4
.long 0xbf35bf80,0x3f350000,0xbf35bf80,0x3f350000,0x3e483f35,0xbf55bec4,0xbe48bf35,0x3f553ec4
.long 0x3ec40000,0x3f6d3f35,0x3ec40000,0x3f6d3f35,0xbf55bf35,0xbf7bbf6d,0x3f553f35,0x3f7b3f6d
.long 0x80008000,0x80008000,0x80008000,0x80008000,0x3e488000,0x3f0ebec4,0xbe488000,0xbf0e3ec4
.long 0x3ec48000,0x3f6dbf35,0x3ec48000,0x3f6dbf35,0x3f0e8000,0x3f7bbf6d,0xbf0e8000,0xbf7b3f6d
.long 0x3f358000,0x3f35bf80,0x3f358000,0x3f35bf80,0x3f558000,0x3e48bf6d,0xbf558000,0xbe483f6d
.long 0x3f6d8000,0xbec4bf35,0x3f6d8000,0xbec4bf35,0x3f7b8000,0xbf55bec4,0xbf7b8000,0x3f553ec4
.long 0x3f808000,0xbf808000,0x3f808000,0xbf808000,0x3f7b8000,0xbf553ec4,0xbf7b8000,0x3f55bec4
.long 0x3f6d8000,0xbec43f35,0x3f6d8000,0xbec43f35,0x3f558000,0x3e483f6d,0xbf558000,0xbe48bf6d
.long 0x3f358000,0x3f353f80,0x3f358000,0x3f353f80,0x3f0e8000,0x3f7b3f6d,0xbf0e8000,0xbf7bbf6d
.long 0x3ec48000,0x3f6d3f35,0x3ec48000,0x3f6d3f35,0x3e488000,0x3f0e3ec4,0xbe488000,0xbf0ebec4
.long 0x80008000,0x80008000,0x80008000,0x80008000,0x3f55bf35,0x3f7bbf6d,0xbf553f35,0xbf7b3f6d
.long 0x3f6dbf80,0x3ec4bf35,0x3f6dbf80,0x3ec4bf35,0x3e48bf35,0xbf553ec4,0xbe483f35,0x3f55bec4
.long 0xbf358000,0xbf353f80,0xbf358000,0xbf353f80,0xbf7b3f35,0x3f0e3ec4,0x3f7bbf35,0xbf0ebec4
.long 0xbec43f80,0x3f6dbf35,0xbec43f80,0x3f6dbf35,0x3f0e3f35,0xbe48bf6d,0xbf0ebf35,0x3e483f6d
.long 0x3f808000,0xbf808000,0x3f808000,0xbf808000,0x3f0ebf35,0xbe483f6d,0xbf0e3f35,0x3e48bf6d
.long 0xbec4bf80,0x3f6d3f35,0xbec4bf80,0x3f6d3f35,0xbf7bbf35,0x3f0ebec4,0x3f7b3f35,0xbf0e3ec4
.long 0xbf358000,0xbf35bf80,0xbf358000,0xbf35bf80,0x3e483f35,0xbf55bec4,0xbe48bf35,0x3f553ec4
.long 0x3f6d3f80,0x3ec43f35,0x3f6d3f80,0x3ec43f35,0x3f553f35,0x3f7b3f6d,0xbf55bf35,0xbf7bbf6d
.long 0x80008000,0x80008000,0x80008000,0x80008000,0x3f7bbf80,0x3f55bf6d,0xbf7b3f80,0xbf553f6d
.long 0xbec48000,0xbf6d3f35,0xbec48000,0xbf6d3f35,0xbf553f80,0x3e483ec4,0x3f55bf80,0xbe48bec4
.long 0x3f358000,0x3f35bf80,0x3f358000,0x3f35bf80,0x3f0ebf80,0xbf7b3ec4,0xbf0e3f80,0x3f7bbec4
.long 0xbf6d8000,0x3ec43f35,0xbf6d8000,0x3ec43f35,0xbe483f80,0x3f0ebf6d,0x3e48bf80,0xbf0e3f6d
.long 0x3f808000,0xbf808000,0x3f808000,0xbf808000,0xbe48bf80,0x3f0e3f6d,0x3e483f80,0xbf0ebf6d
.long 0xbf6d8000,0x3ec4bf35,0xbf6d8000,0x3ec4bf35,0x3f0e3f80,0xbf7bbec4,0xbf0ebf80,0x3f7b3ec4
.long 0x3f358000,0x3f353f80,0x3f358000,0x3f353f80,0xbf55bf80,0x3e48bec4,0x3f553f80,0xbe483ec4
.long 0xbec48000,0xbf6dbf35,0xbec48000,0xbf6dbf35,0x3f7b3f80,0x3f553f6d,0xbf7bbf80,0xbf55bf6d
.long 0x80008000,0x80008000,0x80008000,0x80008000,0x3f0ebf35,0x3e48bec4,0xbf0e3f35,0xbe483ec4
.long 0xbf6d3f80,0xbec43f35,0xbf6d3f80,0xbec43f35,0x3f7bbf35,0x3f0ebf6d,0xbf7b3f35,0xbf0e3f6d
.long 0xbf358000,0xbf353f80,0xbf358000,0xbf353f80,0x3e483f35,0x3f55bf6d,0xbe48bf35,0xbf553f6d
.long 0x3ec4bf80,0xbf6d3f35,0x3ec4bf80,0xbf6d3f35,0xbf553f35,0x3f7bbec4,0x3f55bf35,0xbf7b3ec4
.long 0x3f808000,0xbf808000,0x3f808000,0xbf808000,0xbf55bf35,0x3f7b3ec4,0x3f553f35,0xbf7bbec4
.long 0x3ec43f80,0xbf6dbf35,0x3ec43f80,0xbf6dbf35,0x3e48bf35,0x3f553f6d,0xbe483f35,0xbf55bf6d
.long 0xbf358000,0xbf35bf80,0xbf358000,0xbf35bf80,0x3f7b3f35,0x3f0e3f6d,0xbf7bbf35,0xbf0ebf6d
.long 0xbf6dbf80,0xbec4bf35,0xbf6dbf80,0xbec4bf35,0x3f0e3f35,0x3e483ec4,0xbf0ebf35,0xbe48bec4
.size tab2, 20480
.p2align 8
.type tab3,@object
tab3:
.long 0x80003f80,0x80003f80,0x80003f80,0x80003f80,0x80003f80,0xbec43f6d,0xbf353f35,0xbf6d3ec4
.long 0x80003f80,0xbf353f35,0xbf800000,0xbf35bf35,0x80003f80,0xbf6d3ec4,0xbf35bf35,0x3ec4bf6d
.long 0x80003f80,0xbf800000,0x8000bf80,0x3f800000,0x80003f80,0xbf6dbec4,0x3f35bf35,0x3ec43f6d
.long 0x80003f80,0xbf35bf35,0x3f800000,0xbf353f35,0x80003f80,0xbec4bf6d,0x3f353f35,0xbf6dbec4
.long 0x80003f80,0x8000bf80,0x80003f80,0x8000bf80,0x80003f80,0x3ec4bf6d,0xbf353f35,0x3f6dbec4
.long 0x80003f80,0x3f35bf35,0xbf800000,0x3f353f35,0x80003f80,0x3f6dbec4,0xbf35bf35,0xbec43f6d
.long 0x80003f80,0x3f800000,0x8000bf80,0xbf800000,0x80003f80,0x3f6d3ec4,0x3f35bf35,0xbec4bf6d
.long 0x80003f80,0x3f353f35,0x3f800000,0x3f35bf35,0x80003f80,0x3ec43f6d,0x3f353f35,0x3f6d3ec4
.long 0x80003f80,0x80003f80,0x80003f80,0x80003f80,0xbf800000,0xbf6dbec4,0xbf35bf35,0xbec4bf6d
.long 0x8000bf80,0x3f35bf35,0x3f800000,0x3f353f35,0x3f800000,0x3ec43f6d,0xbf353f35,0xbf6dbec4
.long 0x80003f80,0xbf800000,0x8000bf80,0x3f800000,0xbf800000,0x3ec4bf6d,0x3f353f35,0xbf6d3ec4
.long 0x8000bf80,0x3f353f35,0xbf800000,0x3f35bf35,0x3f800000,0xbf6d3ec4,0x3f35bf35,0xbec43f6d
.long 0x80003f80,0x8000bf80,0x80003f80,0x8000bf80,0xbf800000,0x3f6d3ec4,0xbf35bf35,0x3ec43f6d
.long 0x8000bf80,0xbf353f35,0x3f800000,0xbf35bf35,0x3f800000,0xbec4bf6d,0xbf353f35,0x3f6d3ec4
.long 0x80003f80,0x3f800000,0x8000bf80,0xbf800000,0xbf800000,0xbec43f6d,0x3f353f35,0x3f6dbec4
.long 0x8000bf80,0xbf35bf35,0xbf800000,0xbf353f35,0x3f800000,0x3f6dbec4,0x3f35bf35,0x3ec4bf6d
.long 0x3f80,0x3f80,0x3f80,0x3f80,0xbf80,0xbec4bf6d,0xbf35bf35,0xbf6dbec4
.long 0x3f80,0x3f353f35,0x3f800000,0x3f35bf35,0xbf80,0xbf6dbec4,0xbf353f35,0x3ec43f6d
.long 0x3f80,0x3f800000,0xbf80,0xbf800000,0xbf80,0xbf6d3ec4,0x3f353f35,0x3ec4bf6d
.long 0x3f80,0x3f35bf35,0xbf800000,0x3f353f35,0xbf80,0xbec43f6d,0x3f35bf35,0xbf6d3ec4
.long 0x3f80,0xbf80,0x3f80,0xbf80,0xbf80,0x3ec43f6d,0xbf35bf35,0x3f6d3ec4
.long 0x3f80,0xbf35bf35,0x3f800000,0xbf353f35,0xbf80,0x3f6d3ec4,0xbf353f35,0xbec4bf6d
.long 0x3f80,0xbf800000,0xbf80,0x3f800000,0xbf80,0x3f6dbec4,0x3f353f35,0xbec43f6d
.long 0x3f80,0xbf353f35,0xbf800000,0xbf35bf35,0xbf80,0x3ec4bf6d,0x3f35bf35,0x3f6dbec4
.long 0x3f80,0x3f80,0x3f80,0x3f80,0xbf800000,0xbf6d3ec4,0xbf353f35,0xbec43f6d
.long 0xbf80,0xbf35bf35,0xbf800000,0xbf353f35,0x3f800000,0x3ec4bf6d,0xbf35bf35,0xbf6d3ec4
.long 0x3f80,0x3f800000,0xbf80,0xbf800000,0xbf800000,0x3ec43f6d,0x3f35bf35,0xbf6dbec4
.long 0xbf80,0xbf353f35,0x3f800000,0xbf35bf35,0x3f800000,0xbf6dbec4,0x3f353f35,0xbec4bf6d
.long 0x3f80,0xbf80,0x3f80,0xbf80,0xbf800000,0x3f6dbec4,0xbf353f35,0x3ec4bf6d
.long 0xbf80,0x3f353f35,0xbf800000,0x3f35bf35,0x3f800000,0xbec43f6d,0xbf35bf35,0x3f6dbec4
.long 0x3f80,0xbf800000,0xbf80,0x3f800000,0xbf800000,0xbec4bf6d,0x3f35bf35,0x3f6d3ec4
.long 0xbf80,0x3f35bf35,0x3f800000,0x3f353f35,0x3f800000,0x3f6d3ec4,0x3f353f35,0x3ec43f6d
.long 0x3f800000,0x3f800000,0x3f800000,0x3f800000,0x3f800000,0x3f6d3ec4,0x3f353f35,0x3ec43f6d
.long 0x3f800000,0x3f353f35,0x3f80,0xbf353f35,0x3f800000,0x3ec43f6d,0xbf353f35,0xbf6dbec4
.long 0x3f800000,0x3f80,0xbf800000,0xbf80,0x3f800000,0xbec43f6d,0xbf35bf35,0x3f6dbec4
.long 0x3f800000,0xbf353f35,0xbf80,0x3f353f35,0x3f800000,0xbf6d3ec4,0x3f35bf35,0xbec43f6d
.long 0x3f800000,0xbf800000,0x3f800000,0xbf800000,0x3f800000,0xbf6dbec4,0x3f353f35,0xbec4bf6d
.long 0x3f800000,0xbf35bf35,0x3f80,0x3f35bf35,0x3f800000,0xbec4bf6d,0xbf353f35,0x3f6d3ec4
.long 0x3f800000,0xbf80,0xbf800000,0x3f80,0x3f800000,0x3ec4bf6d,0xbf35bf35,0xbf6d3ec4
.long 0x3f800000,0x3f35bf35,0xbf80,0xbf35bf35,0x3f800000,0x3f6dbec4,0x3f35bf35,0x3ec4bf6d
.long 0x3f800000,0x3f800000,0x3f800000,0x3f800000,0x3f80,0xbec43f6d,0xbf353f35,0xbf6d3ec4
.long 0xbf800000,0xbf35bf35,0xbf80,0x3f35bf35,0xbf80,0x3f6dbec4,0x3f353f35,0xbec43f6d
.long 0x3f800000,0x3f80,0xbf800000,0xbf80,0x3f80,0xbf6dbec4,0x3f35bf35,0x3ec43f6d
.long 0xbf800000,0x3f35bf35,0x3f80,0xbf35bf35,0xbf80,0x3ec43f6d,0xbf35bf35,0x3f6d3ec4
.long 0x3f800000,0xbf800000,0x3f800000,0xbf800000,0x3f80,0x3ec4bf6d,0xbf353f35,0x3f6dbec4
.long 0xbf800000,0x3f353f35,0xbf80,0xbf353f35,0xbf80,0xbf6d3ec4,0x3f353f35,0x3ec4bf6d
.long 0x3f800000,0xbf80,0xbf800000,0x3f80,0x3f80,0x3f6d3ec4,0x3f35bf35,0xbec4bf6d
.long 0xbf800000,0xbf353f35,0x3f80,0x3f353f35,0xbf80,0xbec4bf6d,0xbf35bf35,0xbf6dbec4
.long 0xbf800000,0xbf800000,0xbf800000,0xbf800000,0x3f800000,0x3f6dbec4,0x3f35bf35,0x3ec4bf6d
.long 0xbf800000,0xbf353f35,0x80003f80,0x3f353f35,0x3f800000,0x3ec4bf6d,0xbf35bf35,0xbf6d3ec4
.long 0xbf800000,0x80003f80,0x3f800000,0x8000bf80,0x3f800000,0xbec4bf6d,0xbf353f35,0x3f6d3ec4
.long 0xbf800000,0x3f353f35,0x8000bf80,0xbf353f35,0x3f800000,0xbf6dbec4,0x3f353f35,0xbec4bf6d
.long 0xbf800000,0x3f800000,0xbf800000,0x3f800000,0x3f800000,0xbf6d3ec4,0x3f35bf35,0xbec43f6d
.long 0xbf800000,0x3f35bf35,0x80003f80,0xbf35bf35,0x3f800000,0xbec43f6d,0xbf35bf35,0x3f6dbec4
.long 0xbf800000,0x8000bf80,0x3f800000,0x80003f80,0x3f800000,0x3ec43f6d,0xbf353f35,0xbf6dbec4
.long 0xbf800000,0xbf35bf35,0x8000bf80,0x3f35bf35,0x3f800000,0x3f6d3ec4,0x3f353f35,0x3ec43f6d
.long 0xbf800000,0xbf800000,0xbf800000,0xbf800000,0x8000bf80,0xbec4bf6d,0xbf35bf35,0xbf6dbec4
.long 0x3f800000,0x3f35bf35,0x8000bf80,0xbf35bf35,0x80003f80,0x3f6d3ec4,0x3f35bf35,0xbec4bf6d
.long 0xbf800000,0x80003f80,0x3f800000,0x8000bf80,0x8000bf80,0xbf6d3ec4,0x3f353f35,0x3ec4bf6d
.long 0x3f800000,0xbf35bf35,0x80003f80,0x3f35bf35,0x80003f80,0x3ec4bf6d,0xbf353f35,0x3f6dbec4
.long 0xbf800000,0x3f800000,0xbf800000,0x3f800000,0x8000bf80,0x3ec43f6d,0xbf35bf35,0x3f6d3ec4
.long 0x3f800000,0xbf353f35,0x8000bf80,0x3f353f35,0x80003f80,0xbf6dbec4,0x3f35bf35,0x3ec43f6d
.long 0xbf800000,0x8000bf80,0x3f800000,0x80003f80,0x8000bf80,0x3f6dbec4,0x3f353f35,0xbec43f6d
.long 0x3f800000,0x3f353f35,0x80003f80,0xbf353f35,0x80003f80,0xbec43f6d,0xbf353f35,0xbf6d3ec4
.long 0x354ccccd,0x35cccccd,0x35cccccd,0x35cccccd,0x354ccccd,0x35cca461,0x35cc2b2e,0x35cb6163
.long 0x354ccccd,0x35cc2b2e,0x35ca4751,0x35c72430,0x354ccccd,0x35cb6163,0x35c72430,0x35c0243f
.long 0x354ccccd,0x35ca4751,0x35c2c6c0,0x35b67a67,0x354ccccd,0x35c8dd65,0x35bd35e5,0x35aa48f4
.long 0x354ccccd,0x35c72430,0x35b67a67,0x359bbb2c,0x354ccccd,0x35c51c60,0x35ae9ee7,0x358b04b5
.long 0x354ccccd,0x35c2c6c0,0x35a5afca,0x3570c1c0,0x354ccccd,0x35c0243f,0x359bbb2c,0x354823a7
.long 0x354ccccd,0x35bd35e5,0x3590d0c3,0x351cbf44,0x354ccccd,0x35b9fcdb,0x358501c8,0x34de5d30
.long 0x354ccccd,0x35b67a67,0x3570c1c0,0x348026af,0x354ccccd,0x35b2afeb,0x355603f2,0x3380a585
.long 0x354ccccd,0x35ae9ee7,0x3539f45b,0xb4008c21,0x354ccccd,0x35aa48f4,0x351cbf44,0xb49fd168
.long 0x35cccccd,0x35cccccd,0x35cccccd,0x35cccccd,0x35ccca46,0x35cc8da6,0x35cc0047,0x35cb2261
.long 0x35ccc2b2,0x35cbd057,0x35c99c4e,0x35c62a0f,0x35ccb610,0x35ca9556,0x35c5a5a8,0x35bdf888
.long 0x35cca461,0x35c8dd65,0x35c0243f,0x35b2afeb,0x35cc8da6,0x35c6a993,0x35b92313,0x35a47f35
.long 0x35cc71de,0x35c3fb3c,0x35b0b021,0x3593a17d,0x35cc510b,0x35c0d407,0x35a6dc49,0x35805d00
.long 0x35cc2b2e,0x35bd35e5,0x359bbb2c,0x355603f2,0x35cc0047,0x35b92313,0x358f6305,0x3527d2ae
.long 0x35cbd057,0x35b49e13,0x3581ec7b,0x34edcd1c,0x35cb9b60,0x35afa9af,0x3566e4e3,0x34881699
.long 0x35cb6163,0x35aa48f4,0x354823a7,0x3380a585,0x35cb2261,0x35a47f35,0x3527d2ae,0xb4109388
.long 0x35cade5d,0x359e5003,0x35063284,0xb4af8fe3,0x35ca9556,0x3597bf2e,0x34c70ca3,0xb509fd76
.long 0x35cccccd,0x35cccccd,0x35cccccd,0x35cccccd,0x35ccc2b2,0x35cc71de,0x35cbd057,0x35cade5d
.long 0x35cca461,0x35cb6163,0x35c8dd65,0x35c51c60,0x35cc71de,0x35c99c4e,0x35c3fb3c,0x35bba2a3
.long 0x35cc2b2e,0x35c72430,0x35bd35e5,0x35ae9ee7,0x35cbd057,0x35c3fb3c,0x35b49e13,0x359e5003
.long 0x35cb6163,0x35c0243f,0x35aa48f4,0x358b04b5,0x35cade5d,0x35bba2a3,0x359e5003,0x356a3450
.long 0x35ca4751,0x35b67a67,0x3590d0c3,0x3539f45b,0x35c99c4e,0x35b0b021,0x3581ec7b,0x35063284
.long 0x35c8dd65,0x35aa48f4,0x35638fc3,0x349fd168,0x35c80aaa,0x35a34a91,0x35411588,0x33c0e869
.long 0x35c72430,0x359bbb2c,0x351cbf44,0xb4008c21,0x35c62a0f,0x3593a17d,0x34edcd1c,0xb4af8fe3
.long 0x35c51c60,0x358b04b5,0x349fd168,0xb50dc501,0x35c3fb3c,0x3581ec7b,0x3420975e,0xb5411588
.long 0x35cccccd,0x35cccccd,0x35cccccd,0x35cccccd,0x35ccb610,0x35cc510b,0x35cb9b60,0x35ca9556
.long 0x35cc71de,0x35cade5d,0x35c80aaa,0x35c3fb3c,0x35cc0047,0x35c87681,0x35c2254b,0x35b92313
.long 0x35cb6163,0x35c51c60,0x35b9fcdb,0x35aa48f4,0x35ca9556,0x35c0d407,0x35afa9af,0x3597bf2e
.long 0x35c99c4e,0x35bba2a3,0x35a34a91,0x3581ec7b,0x35c87681,0x35b58e7a,0x35950468,0x35529394
.long 0x35c72430,0x35ae9ee7,0x358501c8,0x351cbf44,0x35c5a5a8,0x35a6dc49,0x3566e4e3,0x34c70ca3
.long 0x35c3fb3c,0x359e5003,0x35411588,0x3420975e,0x35c2254b,0x35950468,0x35190646,0xb3a0c8f3
.long 0x35c0243f,0x358b04b5,0x34de5d30,0xb49fd168,0x35bdf888,0x35805d00,0x34881699,0xb509fd76
.long 0x35bba2a3,0x356a3450,0x33c0e869,0xb5411588,0x35b92313,0x35529394,0xb3a0c8f3,0xb573ff99
.long 0x0,0x0,0x0,0x0,0x0,0x3380a585,0x34008c21,0x344092c2
.long 0x0,0x34008c21,0x348026af,0x34bf3d0b,0x0,0x344092c2,0x34bf3d0b,0x350dc501
.long 0x0,0x348026af,0x34fd2590,0x3539f45b,0x0,0x349fd168,0x351cbf44,0x35638fc3
.long 0x0,0x34bf3d0b,0x3539f45b,0x358501c8,0x0,0x34de5d30,0x355603f2,0x359663a6
.long 0x0,0x34fd2590,0x3570c1c0,0x35a5afca,0x0,0x350dc501,0x358501c8,0x35b2afeb
.long 0x0,0x351cbf44,0x3590d0c3,0x35bd35e5,0x0,0x352b7ba8,0x359bbb2c,0x35c51c60
.long 0x0,0x3539f45b,0x35a5afca,0x35ca4751,0x0,0x354823a7,0x35ae9ee7,0x35cca461
.long 0x0,0x355603f2,0x35b67a67,0x35cc2b2e,0x0,0x35638fc3,0x35bd35e5,0x35c8dd65
.long 0x0,0x0,0x0,0x0,0x3280ad75,0x33a0c8f3,0x34109388,0x34508986
.long 0x3300abdf,0x3420975e,0x34900327,0x34ced752,0x3340fdd6,0x34706739,0x34d69ce7,0x35190646
.long 0x3380a585,0x349fd168,0x350dc501,0x354823a7,0x33a0c8f3,0x34c70ca3,0x352f2067,0x3573ff99
.long 0x33c0e869,0x34edcd1c,0x354f1e05,0x358df1bd,0x33e1031c,0x3509fd76,0x356d7df6,0x359f9496
.long 0x34008c21,0x351cbf44,0x358501c8,0x35ae9ee7,0x34109388,0x352f2067,0x35923aee,0x35bad20d
.long 0x3420975e,0x35411588,0x359e5003,0x35c3fb3c,0x3430973e,0x35529394,0x35a928e5,0x35c9f44d
.long 0x344092c2,0x35638fc3,0x35b2afeb,0x35cca461,0x34508986,0x3573ff99,0x35bad20d,0x35cc0047
.long 0x34607b24,0x3581ec7b,0x35c17f0c,0x35c80aaa,0x34706739,0x35898908,0x35c6a993,0x35c0d407
.long 0x0,0x0,0x0,0x0,0x3300abdf,0x33c0e869,0x3420975e,0x34607b24
.long 0x3380a585,0x344092c2,0x349fd168,0x34de5d30,0x33c0e869,0x34900327,0x34edcd1c,0x35242590
.long 0x34008c21,0x34bf3d0b,0x351cbf44,0x355603f2,0x3420975e,0x34edcd1c,0x35411588,0x3581ec7b
.long 0x344092c2,0x350dc501,0x35638fc3,0x359663a6,0x34607b24,0x35242590,0x3581ec7b,0x35a804aa
.long 0x348026af,0x3539f45b,0x3590d0c3,0x35b67a67,0x34900327,0x354f1e05,0x359e5003,0x35c17f0c
.long 0x349fd168,0x35638fc3,0x35aa48f4,0x35c8dd65,0x34af8fe3,0x3577376d,0x35b49e13,0x35cc71de
.long 0x34bf3d0b,0x358501c8,0x35bd35e5,0x35cc2b2e,0x34ced752,0x358df1bd,0x35c3fb3c,0x35c80aaa
.long 0x34de5d30,0x359663a6,0x35c8dd65,0x35c0243f,0x34edcd1c,0x359e5003,0x35cbd057,0x35b49e13
.long 0x0,0x0,0x0,0x0,0x3340fdd6,0x33e1031c,0x3430973e,0x34706739
.long 0x33c0e869,0x34607b24,0x34af8fe3,0x34edcd1c,0x34109388,0x34a7b2b7,0x35026442,0x352f2067
.long 0x344092c2,0x34de5d30,0x352b7ba8,0x35638fc3,0x34706739,0x3509fd76,0x35529394,0x35898908
.long 0x34900327,0x35242590,0x3577376d,0x359e5003,0x34a7b2b7,0x353d8748,0x358c7cf5,0x35afa9af
.long 0x34bf3d0b,0x355603f2,0x359bbb2c,0x35bd35e5,0x34d69ce7,0x356d7df6,0x35a928e5,0x35c6a993
.long 0x34edcd1c,0x3581ec7b,0x35b49e13,0x35cbd057,0x35026442,0x358c7cf5,0x35bdf888,0x35cc8da6
.long 0x350dc501,0x359663a6,0x35c51c60,0x35c8dd65,0x35190646,0x359f9496,0x35c9f44d,0x35c0d407
.long 0x35242590,0x35a804aa,0x35cc71de,0x35b49e13,0x352f2067,0x35afa9af,0x35cc8da6,0x35a47f35
.long 0x35cccccd,0x354ccccd,0x0,0x0,0x35ca4751,0x3548dd65,0x348026af,0x341fd168
.long 0x35c2c6c0,0x353d35e5,0x34fd2590,0x349cbf44,0x35b67a67,0x352a48f4,0x3539f45b,0x34e38fc3
.long 0x35a5afca,0x3510d0c3,0x3570c1c0,0x3510d0c3,0x3590d0c3,0x34e38fc3,0x3590d0c3,0x352a48f4
.long 0x3570c1c0,0x349cbf44,0x35a5afca,0x353d35e5,0x3539f45b,0x341fd168,0x35b67a67,0x3548dd65
.long 0x34fd2590,0x0,0x35c2c6c0,0x354ccccd,0x348026af,0xb41fd168,0x35ca4751,0x3548dd65
.long 0x0,0xb49cbf44,0x35cccccd,0x353d35e5,0xb48026af,0xb4e38fc3,0x35ca4751,0x352a48f4
.long 0xb4fd2590,0xb510d0c3,0x35c2c6c0,0x3510d0c3,0xb539f45b,0xb52a48f4,0x35b67a67,0x34e38fc3
.long 0xb570c1c0,0xb53d35e5,0x35a5afca,0x349cbf44,0xb590d0c3,0xb548dd65,0x3590d0c3,0x341fd168
.long 0x35cccccd,0x0,0x0,0x0,0x35c9f44d,0x0,0x34881699,0x0
.long 0x35c17f0c,0x0,0x35063284,0x0,0x35b3a936,0x0,0x35449f04,0x0
.long 0x35a0d539,0x0,0x357d94b5,0x0,0x35898908,0x0,0x3597bf2e,0x0
.long 0x355cd4c0,0x0,0x35ac7c70,0x0,0x35207465,0x0,0x35bc6e97,0x0
.long 0x34bf3d0b,0x0,0x35c72430,0x0,0x33e1031c,0x0,0x35cc510b,0x0
.long 0xb420975e,0x0,0x35cbd057,0x0,0xb4d69ce7,0x0,0x35c5a5a8,0x0
.long 0xb52b7ba8,0x0,0x35b9fcdb,0x0,0xb566e4e3,0x0,0x35a928e5,0x0
.long 0xb58df1bd,0x0,0x3593a17d,0x0,0xb5a47f35,0x0,0x3573ff99,0x0
.long 0x35cccccd,0x0,0x0,0x0,0x35c99c4e,0x0,0x34900327,0x0
.long 0x35c0243f,0x0,0x350dc501,0x0,0x35b0b021,0x0,0x354f1e05,0x0
.long 0x359bbb2c,0x0,0x358501c8,0x0,0x3581ec7b,0x0,0x359e5003,0x0
.long 0x354823a7,0x0,0x35b2afeb,0x0,0x35063284,0x0,0x35c17f0c,0x0
.long 0x348026af,0x0,0x35ca4751,0x0,0xb300abdf,0x0,0x35ccc2b2,0x0
.long 0xb49fd168,0x0,0x35c8dd65,0x0,0xb5154980,0x0,0x35beb67b,0x0
.long 0xb55603f2,0x0,0x35ae9ee7,0x0,0xb58809f5,0x0,0x359916f7,0x0
.long 0xb5a0d539,0x0,0x357d94b5,0x0,0xb5b49e13,0x0,0x35411588,0x0
.long 0x35cccccd,0x0,0x0,0x0,0x35c93f55,0x0,0x3497ec27,0x0
.long 0x35beb67b,0x0,0x35154980,0x0,0x35ad8fd0,0x0,0x35596f08,0x0
.long 0x359663a6,0x0,0x358b04b5,0x0,0x3573ff99,0x0,0x35a47f35,0x0
.long 0x3532c0d3,0x0,0x35b844b9,0x0,0x34d69ce7,0x0,0x35c5a5a8,0x0
.long 0x34008c21,0x0,0x35cc2b2e,0x0,0xb430973e,0x0,0x35cb9b60,0x0
.long 0xb4edcd1c,0x0,0x35c3fb3c,0x0,0xb53d8748,0x0,0x35b58e7a,0x0
.long 0xb57d94b5,0x0,0x35a0d539,0x0,0xb59a6af9,0x0,0x35868788,0x0
.long 0xb5b0b021,0x0,0x354f1e05,0x0,0xb5c0d407,0x0,0x3509fd76,0x0
.long 0x80003f80,0x80003f80,0x80003f80,0x80003f80,0x80003f80,0xbf163f4f,0xbf733e9e,0xbf73be9e
.long 0x80003f80,0xbf733e9e,0xbf16bf4f,0x3f16bf4f,0x80003f80,0xbf73be9e,0x3f16bf4f,0x3f163f4f
.long 0x80003f80,0xbf16bf4f,0x3f733e9e,0xbf733e9e,0x80003f80,0x8000bf80,0x80003f80,0x8000bf80
.long 0x80003f80,0x3f16bf4f,0xbf733e9e,0x3f733e9e,0x80003f80,0x3f73be9e,0xbf16bf4f,0xbf163f4f
.long 0x80003f80,0x3f733e9e,0x3f16bf4f,0xbf16bf4f,0x80003f80,0x3f163f4f,0x3f733e9e,0x3f73be9e
.long 0x80003f80,0x80003f80,0x80003f80,0x80003f80,0x80003f80,0xbf163f4f,0xbf733e9e,0xbf73be9e
.long 0x80003f80,0xbf733e9e,0xbf16bf4f,0x3f16bf4f,0x80003f80,0xbf73be9e,0x3f16bf4f,0x3f163f4f
.long 0x80003f80,0xbf16bf4f,0x3f733e9e,0xbf733e9e,0x80003f80,0x8000bf80,0x80003f80,0x8000bf80
.long 0x80003f80,0x80003f80,0x80003f80,0x80003f80,0xbe203f7d,0xbf353f35,0xbf7d3e20,0xbf64bee8
.long 0xbe9e3f73,0xbf800000,0xbe9ebf73,0x3f4fbf16,0xbee83f64,0xbf35bf35,0x3f64bee8,0x3e203f7d
.long 0xbf163f4f,0x8000bf80,0x3f163f4f,0xbf73be9e,0xbf353f35,0x3f35bf35,0xbf353f35,0x3f35bf35
.long 0xbf4f3f16,0x3f800000,0xbf4fbf16,0x3e9e3f73,0xbf643ee8,0x3f353f35,0x3ee8bf64,0xbf7dbe20
.long 0xbf733e9e,0x80003f80,0x3f733e9e,0x3f16bf4f,0xbf7d3e20,0xbf353f35,0xbe203f7d,0x3ee83f64
.long 0xbf800000,0xbf800000,0xbf800000,0xbf800000,0xbf7dbe20,0xbf35bf35,0xbe20bf7d,0x3ee8bf64
.long 0xbf73be9e,0x8000bf80,0x3f73be9e,0x3f163f4f,0xbf64bee8,0x3f35bf35,0x3ee83f64,0xbf7d3e20
.long 0xbf4fbf16,0x3f800000,0xbf4f3f16,0x3e9ebf73,0xbf35bf35,0x3f353f35,0xbf35bf35,0x3f353f35
.long 0x80003f80,0x80003f80,0x80003f80,0x80003f80,0xbe9e3f73,0xbf4f3f16,0xbf800000,0xbf4fbf16
.long 0xbf163f4f,0xbf73be9e,0x8000bf80,0x3f73be9e,0xbf4f3f16,0xbe9ebf73,0x3f800000,0xbe9e3f73
.long 0xbf733e9e,0x3f16bf4f,0x80003f80,0xbf16bf4f,0xbf800000,0x3f800000,0xbf800000,0x3f800000
.long 0xbf73be9e,0x3f163f4f,0x8000bf80,0xbf163f4f,0xbf4fbf16,0xbe9e3f73,0x3f800000,0xbe9ebf73
.long 0xbf16bf4f,0xbf733e9e,0x80003f80,0x3f733e9e,0xbe9ebf73,0xbf4fbf16,0xbf800000,0xbf4f3f16
.long 0x8000bf80,0x8000bf80,0x8000bf80,0x8000bf80,0x3e9ebf73,0x3f4fbf16,0x3f800000,0x3f4f3f16
.long 0x3f16bf4f,0x3f733e9e,0x80003f80,0xbf733e9e,0x3f4fbf16,0x3e9e3f73,0xbf800000,0x3e9ebf73
.long 0x3f73be9e,0xbf163f4f,0x8000bf80,0x3f163f4f,0x3f800000,0xbf800000,0x3f800000,0xbf800000
.long 0x80003f80,0x80003f80,0x80003f80,0x80003f80,0xbee83f64,0xbf643ee8,0xbf7dbe20,0xbf35bf35
.long 0xbf4f3f16,0xbf4fbf16,0x3e9ebf73,0x3f800000,0xbf7d3e20,0x3e20bf7d,0x3f643ee8,0xbf353f35
.long 0xbf73be9e,0x3f73be9e,0xbf163f4f,0x8000bf80,0xbf35bf35,0x3f353f35,0xbf35bf35,0x3f353f35
.long 0xbe9ebf73,0xbe9e3f73,0x3f4fbf16,0xbf800000,0x3e20bf7d,0xbf7d3e20,0x3ee83f64,0x3f35bf35
.long 0x3f16bf4f,0xbf16bf4f,0xbf733e9e,0x80003f80,0x3f64bee8,0x3ee8bf64,0xbe20bf7d,0xbf35bf35
.long 0x3f800000,0x3f800000,0x3f800000,0x3f800000,0x3f643ee8,0x3ee83f64,0xbe203f7d,0xbf353f35
.long 0x3f163f4f,0xbf163f4f,0xbf73be9e,0x8000bf80,0x3e203f7d,0xbf7dbe20,0x3ee8bf64,0x3f353f35
.long 0xbe9e3f73,0xbe9ebf73,0x3f4f3f16,0xbf800000,0xbf353f35,0x3f35bf35,0xbf353f35,0x3f35bf35
.long 0x80003f80,0x80003f80,0x0,0x0,0xbf16bf4f,0x8000bf80,0x0,0x0
.long 0x3f733e9e,0x80003f80,0x0,0x0,0xbf733e9e,0x8000bf80,0x0,0x0
.long 0x3f16bf4f,0x80003f80,0x0,0x0,0x80003f80,0x8000bf80,0x0,0x0
.long 0xbf16bf4f,0x80003f80,0x0,0x0,0x3f733e9e,0x8000bf80,0x0,0x0
.long 0xbf733e9e,0x80003f80,0x0,0x0,0x3f16bf4f,0x8000bf80,0x0,0x0
.long 0x80003f80,0x80003f80,0x0,0x0,0xbf16bf4f,0x8000bf80,0x0,0x0
.long 0x3f733e9e,0x80003f80,0x0,0x0,0xbf733e9e,0x8000bf80,0x0,0x0
.long 0x3f16bf4f,0x80003f80,0x0,0x0,0x80003f80,0x8000bf80,0x0,0x0
.long 0x80003f80,0x0,0x0,0x0,0xbee8bf64,0x0,0x0,0x0
.long 0x3f4f3f16,0x0,0x0,0x0,0xbf7dbe20,0x0,0x0,0x0
.long 0x3f73be9e,0x0,0x0,0x0,0xbf353f35,0x0,0x0,0x0
.long 0x3e9ebf73,0x0,0x0,0x0,0x3e203f7d,0x0,0x0,0x0
.long 0xbf16bf4f,0x0,0x0,0x0,0x3f643ee8,0x0,0x0,0x0
.long 0xbf800000,0x0,0x0,0x0,0x3f64bee8,0x0,0x0,0x0
.long 0xbf163f4f,0x0,0x0,0x0,0x3e20bf7d,0x0,0x0,0x0
.long 0x3e9e3f73,0x0,0x0,0x0,0xbf35bf35,0x0,0x0,0x0
.long 0x80003f80,0x0,0x0,0x0,0xbe9ebf73,0x0,0x0,0x0
.long 0x3f163f4f,0x0,0x0,0x0,0xbf4fbf16,0x0,0x0,0x0
.long 0x3f733e9e,0x0,0x0,0x0,0xbf800000,0x0,0x0,0x0
.long 0x3f73be9e,0x0,0x0,0x0,0xbf4f3f16,0x0,0x0,0x0
.long 0x3f16bf4f,0x0,0x0,0x0,0xbe9e3f73,0x0,0x0,0x0
.long 0x8000bf80,0x0,0x0,0x0,0x3e9e3f73,0x0,0x0,0x0
.long 0xbf16bf4f,0x0,0x0,0x0,0x3f4f3f16,0x0,0x0,0x0
.long 0xbf73be9e,0x0,0x0,0x0,0x3f800000,0x0,0x0,0x0
.long 0x80003f80,0x0,0x0,0x0,0xbe20bf7d,0x0,0x0,0x0
.long 0x3e9e3f73,0x0,0x0,0x0,0xbee8bf64,0x0,0x0,0x0
.long 0x3f163f4f,0x0,0x0,0x0,0xbf35bf35,0x0,0x0,0x0
.long 0x3f4f3f16,0x0,0x0,0x0,0xbf64bee8,0x0,0x0,0x0
.long 0x3f733e9e,0x0,0x0,0x0,0xbf7dbe20,0x0,0x0,0x0
.long 0x3f800000,0x0,0x0,0x0,0xbf7d3e20,0x0,0x0,0x0
.long 0x3f73be9e,0x0,0x0,0x0,0xbf643ee8,0x0,0x0,0x0
.long 0x3f4fbf16,0x0,0x0,0x0,0xbf353f35,0x0,0x0,0x0
.long 0x80003f80,0x3f16bf4f,0xbf733e9e,0x3f733e9e,0x80003f80,0x3f73be9e,0xbf16bf4f,0xbf163f4f
.long 0x80003f80,0x3f733e9e,0x3f16bf4f,0xbf16bf4f,0x80003f80,0x3f163f4f,0x3f733e9e,0x3f73be9e
.long 0x80003f80,0x80003f80,0x80003f80,0x80003f80,0x80003f80,0xbf163f4f,0xbf733e9e,0xbf73be9e
.long 0x80003f80,0xbf733e9e,0xbf16bf4f,0x3f16bf4f,0x80003f80,0xbf73be9e,0x3f16bf4f,0x3f163f4f
.long 0x80003f80,0xbf16bf4f,0x3f733e9e,0xbf733e9e,0x80003f80,0x8000bf80,0x80003f80,0x8000bf80
.long 0x80003f80,0x3f16bf4f,0xbf733e9e,0x3f733e9e,0x80003f80,0x3f73be9e,0xbf16bf4f,0xbf163f4f
.long 0x80003f80,0x3f733e9e,0x3f16bf4f,0xbf16bf4f,0x80003f80,0x3f163f4f,0x3f733e9e,0x3f73be9e
.long 0x80003f80,0x80003f80,0x80003f80,0x80003f80,0x80003f80,0xbf163f4f,0xbf733e9e,0xbf73be9e
.long 0xbf16bf4f,0x80003f80,0x3f16bf4f,0xbf733e9e,0xbee8bf64,0xbf353f35,0x3f643ee8,0x3e20bf7d
.long 0xbe9ebf73,0xbf800000,0xbe9e3f73,0x3f4f3f16,0xbe20bf7d,0xbf35bf35,0xbf7dbe20,0xbf643ee8
.long 0x8000bf80,0x8000bf80,0x8000bf80,0x8000bf80,0x3e20bf7d,0x3f35bf35,0x3f7dbe20,0x3f643ee8
.long 0x3e9ebf73,0x3f800000,0x3e9e3f73,0xbf4f3f16,0x3ee8bf64,0x3f353f35,0xbf643ee8,0xbe20bf7d
.long 0x3f16bf4f,0x80003f80,0xbf16bf4f,0x3f733e9e,0x3f35bf35,0xbf353f35,0x3f35bf35,0xbf353f35
.long 0x3f4fbf16,0xbf800000,0x3f4f3f16,0xbe9ebf73,0x3f64bee8,0xbf35bf35,0xbee83f64,0x3f7d3e20
.long 0x3f73be9e,0x8000bf80,0xbf73be9e,0xbf163f4f,0x3f7dbe20,0x3f35bf35,0x3e20bf7d,0xbee8bf64
.long 0x3f800000,0x3f800000,0x3f800000,0x3f800000,0x3f7d3e20,0x3f353f35,0x3e203f7d,0xbee83f64
.long 0x3f733e9e,0xbf16bf4f,0x80003f80,0x3f16bf4f,0x3f4f3f16,0x3e9ebf73,0xbf800000,0x3e9e3f73
.long 0x3f163f4f,0x3f73be9e,0x8000bf80,0xbf73be9e,0x3e9e3f73,0x3f4f3f16,0x3f800000,0x3f4fbf16
.long 0x80003f80,0x80003f80,0x80003f80,0x80003f80,0xbe9e3f73,0xbf4f3f16,0xbf800000,0xbf4fbf16
.long 0xbf163f4f,0xbf73be9e,0x8000bf80,0x3f73be9e,0xbf4f3f16,0xbe9ebf73,0x3f800000,0xbe9e3f73
.long 0xbf733e9e,0x3f16bf4f,0x80003f80,0xbf16bf4f,0xbf800000,0x3f800000,0xbf800000,0x3f800000
.long 0xbf73be9e,0x3f163f4f,0x8000bf80,0xbf163f4f,0xbf4fbf16,0xbe9e3f73,0x3f800000,0xbe9ebf73
.long 0xbf16bf4f,0xbf733e9e,0x80003f80,0x3f733e9e,0xbe9ebf73,0xbf4fbf16,0xbf800000,0xbf4f3f16
.long 0x8000bf80,0x8000bf80,0x8000bf80,0x8000bf80,0x3e9ebf73,0x3f4fbf16,0x3f800000,0x3f4f3f16
.long 0xbf733e9e,0x3f733e9e,0xbf16bf4f,0x80003f80,0xbf7dbe20,0x3e203f7d,0x3f64bee8,0xbf35bf35
.long 0xbf4fbf16,0xbf4f3f16,0x3e9e3f73,0x3f800000,0xbee8bf64,0xbf64bee8,0xbf7d3e20,0xbf353f35
.long 0x8000bf80,0x8000bf80,0x8000bf80,0x8000bf80,0x3ee8bf64,0x3f64bee8,0x3f7d3e20,0x3f353f35
.long 0x3f4fbf16,0x3f4f3f16,0xbe9e3f73,0xbf800000,0x3f7dbe20,0xbe203f7d,0xbf64bee8,0x3f35bf35
.long 0x3f733e9e,0xbf733e9e,0x3f16bf4f,0x80003f80,0x3f353f35,0xbf35bf35,0x3f353f35,0xbf35bf35
.long 0x3e9e3f73,0x3e9ebf73,0xbf4f3f16,0x3f800000,0xbe203f7d,0x3f7dbe20,0xbee8bf64,0xbf353f35
.long 0xbf163f4f,0x3f163f4f,0x3f73be9e,0x8000bf80,0xbf643ee8,0xbee83f64,0x3e203f7d,0x3f353f35
.long 0xbf800000,0xbf800000,0xbf800000,0xbf800000,0xbf64bee8,0xbee8bf64,0x3e20bf7d,0x3f35bf35
.long 0xbf16bf4f,0x80003f80,0x0,0x0,0x3f733e9e,0x8000bf80,0x0,0x0
.long 0xbf733e9e,0x80003f80,0x0,0x0,0x3f16bf4f,0x8000bf80,0x0,0x0
.long 0x80003f80,0x80003f80,0x0,0x0,0xbf16bf4f,0x8000bf80,0x0,0x0
.long 0x3f733e9e,0x80003f80,0x0,0x0,0xbf733e9e,0x8000bf80,0x0,0x0
.long 0x3f16bf4f,0x80003f80,0x0,0x0,0x80003f80,0x8000bf80,0x0,0x0
.long 0xbf16bf4f,0x80003f80,0x0,0x0,0x3f733e9e,0x8000bf80,0x0,0x0
.long 0xbf733e9e,0x80003f80,0x0,0x0,0x3f16bf4f,0x8000bf80,0x0,0x0
.long 0x80003f80,0x80003f80,0x0,0x0,0xbf16bf4f,0x8000bf80,0x0,0x0
.long 0x3f733e9e,0x0,0x0,0x0,0xbf7d3e20,0x0,0x0,0x0
.long 0x3f4fbf16,0x0,0x0,0x0,0xbee83f64,0x0,0x0,0x0
.long 0x8000bf80,0x0,0x0,0x0,0x3ee83f64,0x0,0x0,0x0
.long 0xbf4fbf16,0x0,0x0,0x0,0x3f7d3e20,0x0,0x0,0x0
.long 0xbf733e9e,0x0,0x0,0x0,0x3f35bf35,0x0,0x0,0x0
.long 0xbe9e3f73,0x0,0x0,0x0,0xbe20bf7d,0x0,0x0,0x0
.long 0x3f163f4f,0x0,0x0,0x0,0xbf64bee8,0x0,0x0,0x0
.long 0x3f800000,0x0,0x0,0x0,0xbf643ee8,0x0,0x0,0x0
.long 0xbf733e9e,0x0,0x0,0x0,0x3f4fbf16,0x0,0x0,0x0
.long 0xbf163f4f,0x0,0x0,0x0,0x3e9ebf73,0x0,0x0,0x0
.long 0x80003f80,0x0,0x0,0x0,0xbe9ebf73,0x0,0x0,0x0
.long 0x3f163f4f,0x0,0x0,0x0,0xbf4fbf16,0x0,0x0,0x0
.long 0x3f733e9e,0x0,0x0,0x0,0xbf800000,0x0,0x0,0x0
.long 0x3f73be9e,0x0,0x0,0x0,0xbf4f3f16,0x0,0x0,0x0
.long 0x3f16bf4f,0x0,0x0,0x0,0xbe9e3f73,0x0,0x0,0x0
.long 0x8000bf80,0x0,0x0,0x0,0x3e9e3f73,0x0,0x0,0x0
.long 0x3f16bf4f,0x0,0x0,0x0,0xbee83f64,0x0,0x0,0x0
.long 0x3e9ebf73,0x0,0x0,0x0,0xbe203f7d,0x0,0x0,0x0
.long 0x8000bf80,0x0,0x0,0x0,0x3e203f7d,0x0,0x0,0x0
.long 0xbe9ebf73,0x0,0x0,0x0,0x3ee83f64,0x0,0x0,0x0
.long 0xbf16bf4f,0x0,0x0,0x0,0x3f353f35,0x0,0x0,0x0
.long 0xbf4fbf16,0x0,0x0,0x0,0x3f643ee8,0x0,0x0,0x0
.long 0xbf73be9e,0x0,0x0,0x0,0x3f7d3e20,0x0,0x0,0x0
.long 0xbf800000,0x0,0x0,0x0,0x3f7dbe20,0x0,0x0,0x0
.long 0x80003f80,0xbf733e9e,0xbf16bf4f,0x3f16bf4f,0x80003f80,0xbf73be9e,0x3f16bf4f,0x3f163f4f
.long 0x80003f80,0xbf16bf4f,0x3f733e9e,0xbf733e9e,0x80003f80,0x8000bf80,0x80003f80,0x8000bf80
.long 0x80003f80,0x3f16bf4f,0xbf733e9e,0x3f733e9e,0x80003f80,0x3f73be9e,0xbf16bf4f,0xbf163f4f
.long 0x80003f80,0x3f733e9e,0x3f16bf4f,0xbf16bf4f,0x80003f80,0x3f163f4f,0x3f733e9e,0x3f73be9e
.long 0x0,0x0,0x0,0x0,0x0,0x0,0x0,0x0
.long 0x0,0x0,0x0,0x0,0x0,0x0,0x0,0x0
.long 0x0,0x0,0x0,0x0,0x0,0x0,0x0,0x0
.long 0x0,0x0,0x0,0x0,0x0,0x0,0x0,0x0
.long 0x3f733e9e,0x80003f80,0xbf733e9e,0xbf16bf4f,0x3f643ee8,0xbf353f35,0xbee8bf64,0x3f7dbe20
.long 0x3f4f3f16,0xbf800000,0x3f4fbf16,0xbe9e3f73,0x3f353f35,0xbf35bf35,0x3f353f35,0xbf35bf35
.long 0x3f163f4f,0x8000bf80,0xbf163f4f,0x3f73be9e,0x3ee83f64,0x3f35bf35,0xbf64bee8,0xbe203f7d
.long 0x3e9e3f73,0x3f800000,0x3e9ebf73,0xbf4fbf16,0x3e203f7d,0x3f353f35,0x3f7d3e20,0x3f64bee8
.long 0x0,0x0,0x0,0x0,0x0,0x0,0x0,0x0
.long 0x0,0x0,0x0,0x0,0x0,0x0,0x0,0x0
.long 0x0,0x0,0x0,0x0,0x0,0x0,0x0,0x0
.long 0x0,0x0,0x0,0x0,0x0,0x0,0x0,0x0
.long 0x3f16bf4f,0x3f733e9e,0x80003f80,0xbf733e9e,0x3f4fbf16,0x3e9e3f73,0xbf800000,0x3e9ebf73
.long 0x3f73be9e,0xbf163f4f,0x8000bf80,0x3f163f4f,0x3f800000,0xbf800000,0x3f800000,0xbf800000
.long 0x3f733e9e,0xbf16bf4f,0x80003f80,0x3f16bf4f,0x3f4f3f16,0x3e9ebf73,0xbf800000,0x3e9e3f73
.long 0x3f163f4f,0x3f73be9e,0x8000bf80,0xbf73be9e,0x3e9e3f73,0x3f4f3f16,0x3f800000,0x3f4fbf16
.long 0x0,0x0,0x0,0x0,0x0,0x0,0x0,0x0
.long 0x0,0x0,0x0,0x0,0x0,0x0,0x0,0x0
.long 0x0,0x0,0x0,0x0,0x0,0x0,0x0,0x0
.long 0x0,0x0,0x0,0x0,0x0,0x0,0x0,0x0
.long 0xbf16bf4f,0x3f16bf4f,0x3f733e9e,0x80003f80,0xbe20bf7d,0x3f7d3e20,0xbee83f64,0xbf35bf35
.long 0x3e9ebf73,0x3e9e3f73,0xbf4fbf16,0x3f800000,0x3f35bf35,0xbf353f35,0x3f35bf35,0xbf353f35
.long 0x3f73be9e,0xbf73be9e,0x3f163f4f,0x8000bf80,0x3f7d3e20,0xbe20bf7d,0xbf643ee8,0x3f353f35
.long 0x3f4f3f16,0x3f4fbf16,0xbe9ebf73,0xbf800000,0x3ee83f64,0x3f643ee8,0x3f7dbe20,0x3f35bf35
.long 0x0,0x0,0x0,0x0,0x0,0x0,0x0,0x0
.long 0x0,0x0,0x0,0x0,0x0,0x0,0x0,0x0
.long 0x0,0x0,0x0,0x0,0x0,0x0,0x0,0x0
.long 0x0,0x0,0x0,0x0,0x0,0x0,0x0,0x0
.long 0x3f733e9e,0x80003f80,0x0,0x0,0xbf733e9e,0x8000bf80,0x0,0x0
.long 0x3f16bf4f,0x80003f80,0x0,0x0,0x80003f80,0x8000bf80,0x0,0x0
.long 0xbf16bf4f,0x80003f80,0x0,0x0,0x3f733e9e,0x8000bf80,0x0,0x0
.long 0xbf733e9e,0x80003f80,0x0,0x0,0x3f16bf4f,0x8000bf80,0x0,0x0
.long 0x0,0x0,0x0,0x0,0x0,0x0,0x0,0x0
.long 0x0,0x0,0x0,0x0,0x0,0x0,0x0,0x0
.long 0x0,0x0,0x0,0x0,0x0,0x0,0x0,0x0
.long 0x0,0x0,0x0,0x0,0x0,0x0,0x0,0x0
.long 0x3f16bf4f,0x0,0x0,0x0,0xbe203f7d,0x0,0x0,0x0
.long 0xbe9ebf73,0x0,0x0,0x0,0x3f353f35,0x0,0x0,0x0
.long 0xbf73be9e,0x0,0x0,0x0,0x3f7dbe20,0x0,0x0,0x0
.long 0xbf4f3f16,0x0,0x0,0x0,0x3ee8bf64,0x0,0x0,0x0
.long 0x0,0x0,0x0,0x0,0x0,0x0,0x0,0x0
.long 0x0,0x0,0x0,0x0,0x0,0x0,0x0,0x0
.long 0x0,0x0,0x0,0x0,0x0,0x0,0x0,0x0
.long 0x0,0x0,0x0,0x0,0x0,0x0,0x0,0x0
.long 0xbf16bf4f,0x0,0x0,0x0,0x3f4f3f16,0x0,0x0,0x0
.long 0xbf73be9e,0x0,0x0,0x0,0x3f800000,0x0,0x0,0x0
.long 0xbf733e9e,0x0,0x0,0x0,0x3f4fbf16,0x0,0x0,0x0
.long 0xbf163f4f,0x0,0x0,0x0,0x3e9ebf73,0x0,0x0,0x0
.long 0x0,0x0,0x0,0x0,0x0,0x0,0x0,0x0
.long 0x0,0x0,0x0,0x0,0x0,0x0,0x0,0x0
.long 0x0,0x0,0x0,0x0,0x0,0x0,0x0,0x0
.long 0x0,0x0,0x0,0x0,0x0,0x0,0x0,0x0
.long 0xbf733e9e,0x0,0x0,0x0,0x3f64bee8,0x0,0x0,0x0
.long 0xbf4f3f16,0x0,0x0,0x0,0x3f35bf35,0x0,0x0,0x0
.long 0xbf163f4f,0x0,0x0,0x0,0x3ee8bf64,0x0,0x0,0x0
.long 0xbe9e3f73,0x0,0x0,0x0,0x3e20bf7d,0x0,0x0,0x0
.long 0x0,0x0,0x0,0x0,0x0,0x0,0x0,0x0
.long 0x0,0x0,0x0,0x0,0x0,0x0,0x0,0x0
.long 0x0,0x0,0x0,0x0,0x0,0x0,0x0,0x0
.long 0x0,0x0,0x0,0x0,0x0,0x0,0x0,0x0
.long 0x0,0x0,0x0,0x0,0x0,0x0,0x0,0x0
.long 0x0,0x0,0x0,0x0,0x0,0x0,0x0,0x0
.long 0x0,0x0,0x0,0x0,0x0,0x0,0x0,0x0
.long 0x0,0x0,0x0,0x0,0x0,0x0,0x0,0x0
.long 0x0,0x0,0x0,0x0,0x0,0x0,0x0,0x0
.long 0x0,0x0,0x0,0x0,0x0,0x0,0x0,0x0
.long 0x0,0x0,0x0,0x0,0x0,0x0,0x0,0x0
.long 0x0,0x0,0x0,0x0,0x0,0x0,0x0,0x0
.long 0x0,0x0,0x0,0x0,0x0,0x0,0x0,0x0
.long 0x0,0x0,0x0,0x0,0x0,0x0,0x0,0x0
.long 0x0,0x0,0x0,0x0,0x0,0x0,0x0,0x0
.long 0x0,0x0,0x0,0x0,0x0,0x0,0x0,0x0
.long 0x0,0x0,0x0,0x0,0x0,0x0,0x0,0x0
.long 0x0,0x0,0x0,0x0,0x0,0x0,0x0,0x0
.long 0x0,0x0,0x0,0x0,0x0,0x0,0x0,0x0
.long 0x0,0x0,0x0,0x0,0x0,0x0,0x0,0x0
.long 0x0,0x0,0x0,0x0,0x0,0x0,0x0,0x0
.long 0x0,0x0,0x0,0x0,0x0,0x0,0x0,0x0
.long 0x0,0x0,0x0,0x0,0x0,0x0,0x0,0x0
.long 0x0,0x0,0x0,0x0,0x0,0x0,0x0,0x0
.long 0x0,0x0,0x0,0x0,0x0,0x0,0x0,0x0
.long 0x0,0x0,0x0,0x0,0x0,0x0,0x0,0x0
.long 0x0,0x0,0x0,0x0,0x0,0x0,0x0,0x0
.long 0x0,0x0,0x0,0x0,0x0,0x0,0x0,0x0
.long 0x0,0x0,0x0,0x0,0x0,0x0,0x0,0x0
.long 0x0,0x0,0x0,0x0,0x0,0x0,0x0,0x0
.long 0x0,0x0,0x0,0x0,0x0,0x0,0x0,0x0
.long 0x0,0x0,0x0,0x0,0x0,0x0,0x0,0x0
.long 0x0,0x0,0x0,0x0,0x0,0x0,0x0,0x0
.long 0x0,0x0,0x0,0x0,0x0,0x0,0x0,0x0
.long 0x0,0x0,0x0,0x0,0x0,0x0,0x0,0x0
.long 0x0,0x0,0x0,0x0,0x0,0x0,0x0,0x0
.size tab3, 12288
pf_tab_end:
```
